```python
import torch

def _softmax(x, axis=-1):
    return torch.softmax(x, dim=axis)

def _gelu(x):
    return torch.nn.functional.gelu(x, approximate='tanh')

def _silu(x):
    return torch.nn.functional.silu(x)

def _sigmoid(x):
    return torch.sigmoid(x)

def _layernorm(x, axis=-1, eps=1e-05):
    m = x.mean(dim=axis, keepdim=True)
    v = x.var(dim=axis, keepdim=True, unbiased=False)
    return (x - m) / torch.sqrt(v + eps)

def _scatter_add(tgt, idx, src, axis=0):
    return tgt.clone().index_add_(axis, idx, src)

def _segment_sum(src, seg, n):
    out = torch.zeros((n,) + src.shape[1:], dtype=src.dtype)
    return out.index_add_(0, seg, src)

def _pad(x, pw):
    flat = tuple((v for pair in reversed(pw) for v in pair))
    return torch.nn.functional.pad(x, flat)
kernel_name = 'gated_mix__memory_aug_recurrent_mem_tr__glu_gated_geglu__prompt'

def setup_inputs():

    _w = lambda a: (lambda t: t.to(torch.bfloat16) if t.is_floating_point() else t)(torch.as_tensor(a))

    def _A_setup():
        B, S, Dm = (1, 2048, 640)
        H, Dh = (32, 192)
        M, seg = (8, 32)
        seg = min(seg, S)
        S = S // seg * seg
        return {'x': _w((lambda *s: torch.randn(*s, dtype=torch.bfloat16) * 0.05)(B, S, Dm)), 'mem0': _w((lambda *s: torch.randn(*s, dtype=torch.bfloat16) * 0.4)(B, M, Dm)), 'Wq': _w((lambda *s: torch.randn(*s, dtype=torch.bfloat16) * 6.4)(Dm, H, Dh) * Dm ** (-0.5)), 'Wk': _w((lambda *s: torch.randn(*s, dtype=torch.bfloat16) * 6.4)(Dm, H, Dh) * Dm ** (-0.5)), 'Wv': _w((lambda *s: torch.randn(*s, dtype=torch.bfloat16) * 0.4)(Dm, H, Dh) * Dm ** (-0.5)), 'Wo': _w((lambda *s: torch.randn(*s, dtype=torch.bfloat16) * 0.4)(H, Dh, Dm) * (H * Dh) ** (-0.5)), 'seg_len': seg}
    _A_in = _A_setup()

    def _B_setup():
        B, S, Dm, Df = (1, 2048, 640, 1536)
        return {'x': _w((lambda *s: torch.randn(*s, dtype=torch.bfloat16) * 0.05)(B, S, Dm)), 'w_gate': _w((lambda *s: torch.randn(*s, dtype=torch.bfloat16) * 1.6)(Dm, Df) * Dm ** (-0.5)), 'w_up': _w((lambda *s: torch.randn(*s, dtype=torch.bfloat16) * 1.6)(Dm, Df) * Dm ** (-0.5)), 'w_down': _w((lambda *s: torch.randn(*s, dtype=torch.bfloat16) * 1.6)(Df, Dm) * Df ** (-0.5))}
    _B_in = _B_setup()
    return {'A_x': _A_in['x'], 'A_mem0': _A_in['mem0'], 'A_Wq': _A_in['Wq'], 'A_Wk': _A_in['Wk'], 'A_Wv': _A_in['Wv'], 'A_Wo': _A_in['Wo'], 'A_seg_len': _A_in['seg_len'], 'B_x': _B_in['x'], 'B_w_gate': _B_in['w_gate'], 'B_w_up': _B_in['w_up'], 'B_w_down': _B_in['w_down'], 'gate_w': _w((lambda *s: torch.randn(*s, dtype=torch.bfloat16) * 0.05)(640) * 16.0)}

def reference(A_x, A_mem0, A_Wq, A_Wk, A_Wv, A_Wo, A_seg_len, B_x, B_w_gate, B_w_up, B_w_down, gate_w):

    def _A_ref(x, mem0, Wq, Wk, Wv, Wo, seg_len):
        B, S, Dm = x.shape
        H, Dh = (Wq.shape[1], Wq.shape[2])
        M = mem0.shape[1]
        scale = Dh ** (-0.5)
        n_seg = S // seg_len
        L = M + seg_len
        idx = torch.arange(L)
        mask = (idx[:, None] < M) | (idx[:, None] >= idx[None, :])
        mem = mem0
        outs = []
        for s in range(n_seg):
            xs = x[:, s * seg_len:(s + 1) * seg_len, :].clone()
            h = torch.concatenate([mem, xs], axis=1)
            q = torch.einsum('btd,dhe->bhte', h, Wq)
            k = torch.einsum('btd,dhe->bhte', h, Wk)
            v = torch.einsum('btd,dhe->bhte', h, Wv)
            scores = torch.einsum('bhqe,bhke->bhqk', q, k) * scale
            scores = torch.where(mask[None, None], scores, -1000000000.0)
            p = _softmax(scores, axis=-1)
            o = torch.einsum('bhqk,bhke->bhqe', p, v)
            o = torch.einsum('bhte,hed->btd', o, Wo)
            mem = o[:, :M, :].clone()
            outs.append(o[:, M:, :])
        return torch.concatenate(outs, axis=1)

    def _B_ref(x, w_gate, w_up, w_down):
        g = torch.einsum('bsd,df->bsf', x, w_gate)
        u = torch.einsum('bsd,df->bsf', x, w_up)
        h = _gelu(g) * u
        return torch.einsum('bsf,fd->bsd', h, w_down)
    x = A_x
    g = _sigmoid((x * gate_w).sum(-1, keepdims=True))
    a = _A_ref(x, A_mem0, A_Wq, A_Wk, A_Wv, A_Wo, A_seg_len)
    b = _B_ref(x, B_w_gate, B_w_up, B_w_down)
    return g * a + (1 - g) * b
```

```asm
; @launch grid=(256,1,1) block=(512,1,1) lds=143360
.amdgcn_target "amdgcn-amd-amdhsa--gfx950"
.text
.globl gated_mix__memory_aug_recurrent_mem_tr__glu_gated_geglu__prompt_kernel
.p2align 8
.type gated_mix__memory_aug_recurrent_mem_tr__glu_gated_geglu__prompt_kernel,@function
gated_mix__memory_aug_recurrent_mem_tr__glu_gated_geglu__prompt_kernel:
    s_cmp_ge_u32 s2, 256
    s_cbranch_scc1 Lexit
    s_load_dwordx16 s[16:31], s[0:1], 0
    s_load_dwordx8 s[32:39], s[0:1], 64
    s_load_dwordx4 s[40:43], s[0:1], 96
    s_load_dwordx2 s[44:45], s[0:1], 112
    v_lshrrev_b32 v1, 6, v0
    s_getreg_b32 s49, hwreg(HW_REG_XCC_ID)
    v_readfirstlane_b32 s48, v1
    s_and_b32 s49, s49, 15
    s_min_u32 s49, s49, 10
    s_cmp_lt_u32 s49, 8
    s_cselect_b32 s49, s49, 10
    s_mov_b32 s54, 1048576
    s_mov_b32 s55, 0
    s_mov_b32 s97, 0
    s_mov_b32 s79, 0
    s_mov_b64 s[98:99], 0
    s_mov_b64 s[100:101], 0
    s_mov_b32 s53, 0
    s_mov_b32 s70, 0x00ff00ff
    s_mov_b32 s71, 0x00ff00ff
    s_mov_b32 s74, 0xff00ff00
    s_mov_b32 s75, 0xff00ff00
    s_mov_b32 s72, -1
    s_mov_b32 s73, 0
    s_mov_b32 s80, 0x05040100
    s_mov_b32 s81, 0x07060302
    s_mov_b32 s68, 0x3dd53b95
    s_waitcnt lgkmcnt(0)
    s_mov_b32 s4, s44
    s_mov_b32 s5, s45
    s_mov_b32 s6, 268435456
    s_mov_b32 s7, 0x20000
    s_mov_b32 s8, s42
    s_mov_b32 s9, s43
    s_mov_b32 s10, 256
    s_mov_b32 s11, 0x20000
    s_cmp_lg_u32 s48, 0
    s_cbranch_scc1 Le_1
    s_mov_b64 exec, 1
    v_mov_b32 v2, 1
    s_lshl_b32 s69, s49, 2
    s_and_b32 s76, s49, 12
    s_cmp_eq_u32 s76, 4
    s_cselect_b32 s76, 144, 0
    s_add_u32 s69, s69, s76
    v_mov_b32 v3, s69
    buffer_atomic_add v2, v3, s[8:11], 0 offen sc0 sc1
    s_mov_b64 exec, -1
Le_1:
    s_cmp_lg_u32 s48, 1
    s_cbranch_scc1 Le_5
    s_mov_b64 exec, 1
    v_mov_b32 v2, 0
    v_mov_b32 v3, 0
    v_mov_b32 v4, 0
    v_mov_b32 v5, 0
    s_lshl_b32 s69, s2, 4
    s_add_u32 s69, s69, 152043520
    buffer_store_dwordx4 v[2:5], v2, s[4:7], s69 offen sc1
    s_mov_b64 exec, -1
Le_5:
    s_waitcnt vmcnt(0)
    s_cmp_lg_u32 s48, 0
    s_cbranch_scc1 Le_3
    s_mov_b64 exec, 1
    v_readfirstlane_b32 s69, v2
    s_cmp_ge_u32 s49, 8
    s_cselect_b32 s69, 32, s69
    s_cmp_lt_u32 s69, 32
    s_cbranch_scc1 Le_6
    v_mov_b32 v2, 1
    v_mov_b32 v3, 36
    buffer_atomic_add v2, v3, s[8:11], 0 offen sc0 sc1
    s_waitcnt vmcnt(0)
    v_add_u32 v2, 32, v2
Le_6:
    v_mov_b32 v4, 0
    s_or_b32 s69, s69, s49
    s_cmp_lg_u32 s69, 0
    s_cbranch_scc1 Le_8
    s_lshr_b32 s69, s2, 6
    s_lshl_b32 s69, s69, 14
    s_and_b32 s76, s2, 63
    s_lshl_b32 s76, s76, 7
    s_add_u32 s69, s69, s76
    s_add_u32 s69, s69, 169803776
    s_add_u32 s76, s69, 8192
    s_mov_b32 s77, -1
    s_mov_b32 s78, -1
    v_mov_b32 v5, 0
    s_memtime s[98:99]
    s_waitcnt lgkmcnt(0)
    buffer_atomic_add v5, v4, s[4:7], s69 offen sc0 sc1
    s_waitcnt vmcnt(0)
    s_memtime s[100:101]
    s_waitcnt lgkmcnt(0)
    s_sub_u32 s98, s100, s98
    s_min_u32 s77, s77, s98
    v_mov_b32 v5, 0
    s_memtime s[98:99]
    s_waitcnt lgkmcnt(0)
    buffer_atomic_add v5, v4, s[4:7], s76 offen sc0 sc1
    s_waitcnt vmcnt(0)
    s_memtime s[100:101]
    s_waitcnt lgkmcnt(0)
    s_sub_u32 s98, s100, s98
    s_min_u32 s78, s78, s98
    v_mov_b32 v5, 0
    s_memtime s[98:99]
    s_waitcnt lgkmcnt(0)
    buffer_atomic_add v5, v4, s[4:7], s69 offen sc0 sc1
    s_waitcnt vmcnt(0)
    s_memtime s[100:101]
    s_waitcnt lgkmcnt(0)
    s_sub_u32 s98, s100, s98
    s_min_u32 s77, s77, s98
    v_mov_b32 v5, 0
    s_memtime s[98:99]
    s_waitcnt lgkmcnt(0)
    buffer_atomic_add v5, v4, s[4:7], s76 offen sc0 sc1
    s_waitcnt vmcnt(0)
    s_memtime s[100:101]
    s_waitcnt lgkmcnt(0)
    s_sub_u32 s98, s100, s98
    s_min_u32 s78, s78, s98
    s_mov_b64 s[98:99], 0
    s_mov_b64 s[100:101], 0
    s_cmp_lt_u32 s78, s77
    s_cselect_b32 s77, 0x15, 0x0a
    v_mov_b32 v4, s77
    v_mov_b32 v5, 136
    buffer_store_dword v4, v5, s[8:11], 0 offen sc1
    s_waitcnt vmcnt(0)
Le_8:
    v_mov_b32 v3, 0
    ds_write_b32 v3, v2
    s_mov_b64 exec, -1
    s_waitcnt lgkmcnt(0)
Le_3:
    s_barrier
    v_mov_b32 v3, 0
    ds_read_b32 v2, v3
    s_mov_b32 s3, 0
    s_waitcnt lgkmcnt(0)
    v_readfirstlane_b32 s50, v2
    s_barrier
    s_cmp_lt_u32 s50, 32
    s_cbranch_scc1 Le_7
    s_cmp_lg_u32 s48, 0
    s_cbranch_scc1 Larr_9
    s_cmp_lg_u32 s3, 0
    s_cbranch_scc1 Larr_9
    s_mov_b64 exec, 1
    v_mov_b32 v4, 1
    v_mov_b32 v5, 32
    buffer_atomic_add v4, v5, s[8:11], 0 offen sc1
    s_mov_b64 exec, -1
Larr_9:
    s_mov_b32 s3, 1
    v_and_b32 v4, 63, v0
    v_lshlrev_b32 v3, 2, v4
Lreg_10:
    buffer_load_dword v2, v3, s[8:11], 0 offen sc0 sc1
    s_waitcnt vmcnt(0)
    v_readlane_b32 s69, v2, 8
    v_readlane_b32 s76, v2, 8
    s_add_u32 s69, s69, s76
    s_cmp_ge_u32 s69, 512
    s_cbranch_scc1 Lregd_11
    s_sleep 24
    s_sub_u32 s54, s54, 1
    s_cbranch_scc0 Lreg_10
    s_mov_b32 s54, 0
Lregd_11:
    v_readlane_b32 s79, v2, 34
    v_cmp_ne_u32 vcc, 32, v2
    s_and_b32 s79, s79, 1
    s_and_b32 s69, vcc_lo, 0xf
    s_and_b32 s76, vcc_hi, 0xf00
    s_or_b32 s69, s69, s76
    s_cselect_b32 s53, 1, 0
    s_sub_u32 s76, s50, 32
    s_mov_b32 s49, 0
    s_mov_b32 s50, 0
    v_readlane_b32 s69, v2, 0
    s_min_u32 s69, s69, 32
    s_sub_u32 s77, 32, s69
    s_add_u32 s69, s69, s76
    s_cmp_lt_u32 s76, s77
    s_cselect_b32 s49, 0, s49
    s_cselect_b32 s50, s69, s50
    s_sub_u32 s76, s76, s77
    v_readlane_b32 s69, v2, 1
    s_min_u32 s69, s69, 32
    s_sub_u32 s77, 32, s69
    s_add_u32 s69, s69, s76
    s_cmp_lt_u32 s76, s77
    s_cselect_b32 s49, 1, s49
    s_cselect_b32 s50, s69, s50
    s_sub_u32 s76, s76, s77
    v_readlane_b32 s69, v2, 2
    s_min_u32 s69, s69, 32
    s_sub_u32 s77, 32, s69
    s_add_u32 s69, s69, s76
    s_cmp_lt_u32 s76, s77
    s_cselect_b32 s49, 2, s49
    s_cselect_b32 s50, s69, s50
    s_sub_u32 s76, s76, s77
    v_readlane_b32 s69, v2, 3
    s_min_u32 s69, s69, 32
    s_sub_u32 s77, 32, s69
    s_add_u32 s69, s69, s76
    s_cmp_lt_u32 s76, s77
    s_cselect_b32 s49, 3, s49
    s_cselect_b32 s50, s69, s50
    s_sub_u32 s76, s76, s77
    v_readlane_b32 s69, v2, 40
    s_min_u32 s69, s69, 32
    s_sub_u32 s77, 32, s69
    s_add_u32 s69, s69, s76
    s_cmp_lt_u32 s76, s77
    s_cselect_b32 s49, 4, s49
    s_cselect_b32 s50, s69, s50
    s_sub_u32 s76, s76, s77
    v_readlane_b32 s69, v2, 41
    s_min_u32 s69, s69, 32
    s_sub_u32 s77, 32, s69
    s_add_u32 s69, s69, s76
    s_cmp_lt_u32 s76, s77
    s_cselect_b32 s49, 5, s49
    s_cselect_b32 s50, s69, s50
    s_sub_u32 s76, s76, s77
    v_readlane_b32 s69, v2, 42
    s_min_u32 s69, s69, 32
    s_sub_u32 s77, 32, s69
    s_add_u32 s69, s69, s76
    s_cmp_lt_u32 s76, s77
    s_cselect_b32 s49, 6, s49
    s_cselect_b32 s50, s69, s50
    s_sub_u32 s76, s76, s77
    v_readlane_b32 s69, v2, 43
    s_min_u32 s69, s69, 32
    s_sub_u32 s77, 32, s69
    s_add_u32 s69, s69, s76
    s_cmp_lt_u32 s76, s77
    s_cselect_b32 s49, 7, s49
    s_cselect_b32 s50, s69, s50
    s_sub_u32 s76, s76, s77
Le_7:
    s_lshr_b32 s69, s50, 4
    s_lshr_b32 s76, s49, 2
    s_and_b32 s49, s49, 3
    s_lshl_b32 s49, s49, 1
    s_add_u32 s49, s49, s69
    s_and_b32 s50, s50, 15
    s_lshl_b32 s76, s76, 4
    s_add_u32 s50, s50, s76
    s_cmp_ge_u32 s50, 16
    s_cbranch_scc1 Lworker
    s_lshr_b32 s51, s50, 2
    s_lshl_b32 s69, s49, 2
    s_add_u32 s51, s51, s69
    s_and_b32 s52, s50, 3
    s_setprio 2
    s_cmp_eq_u32 s48, 3
    s_cbranch_scc1 Lrole_v_12
    s_cmp_eq_u32 s48, 7
    s_cbranch_scc1 Lrole_w7_13
    s_cmp_ge_u32 s48, 4
    s_cbranch_scc1 Lrole_att_14
    v_and_b32 v1, 63, v0
    v_and_b32 v2, 15, v0
    v_bfe_u32 v3, v0, 4, 2
    v_mov_b32 v0, 0xfffe0000
    v_lshlrev_b32 v226, 4, v1
    v_and_b32 v4, 2, v2
    v_cmp_eq_u32 vcc, 2, v4
    v_mov_b32 v229, 0x44444444
    v_mov_b32 v4, 0xeeeeeeee
    s_nop 1
    v_cndmask_b32 v229, v229, v4, vcc
    v_add_u32 v227, 4096, v226
    v_add_u32 v228, 8192, v226
    s_mul_i32 s77, s52, 3
    s_add_u32 s77, s77, s48
    s_cmp_ge_u32 s77, 6
    s_cselect_b32 s12, s22, s20
    s_cselect_b32 s13, s23, s21
    s_cselect_b32 s76, 6, 0
    s_lshl_b32 s78, s77, 9
    s_sub_u32 s77, s77, s76
    s_mov_b32 s14, 7864320
    s_mov_b32 s15, 0x20000
    s_lshl_b32 s77, s77, 6
    v_lshlrev_b32 v230, 7, v3
    v_lshl_add_u32 v230, v2, 2, v230
    v_add_u32 v230, s78, v230
    v_lshlrev_b32 v4, 1, v2
    v_and_b32 v5, 0x13, v4
    v_and_b32 v6, 4, v4
    v_lshl_add_u32 v5, v6, 1, v5
    v_and_b32 v6, 8, v4
    v_lshrrev_b32 v6, 1, v6
    v_add_u32 v5, v5, v6
    v_lshlrev_b32 v6, 1, v5
    s_mul_i32 s69, s51, 384
    s_add_u32 s69, s69, s77
    s_min_u32 s66, s48, 4
    s_mul_i32 s66, s66, 20480
    s_add_u32 s66, s66, 38912
    v_lshrrev_b32 v168, 2, v1
    s_mov_b32 s76, 12288
    v_mul_lo_u32 v168, v168, s76
    v_and_b32 v169, 3, v1
    v_lshl_add_u32 v168, v169, 4, v168
    v_lshrrev_b32 v169, 1, v3
    v_lshlrev_b32 v169, 10, v169
    v_and_b32 v170, 1, v3
    v_lshl_add_u32 v169, v170, 8, v169
    v_add_u32 v169, v169, v6
    v_add_u32 v169, s66, v169
    s_add_u32 m0, s66, 0
    s_add_u32 s76, s69, 0
    buffer_load_dwordx4 v168, s[12:15], s76 offen lds
    s_add_u32 m0, s66, 1024
    s_add_u32 s76, s69, 196608
    buffer_load_dwordx4 v168, s[12:15], s76 offen lds
    s_add_u32 m0, s66, 2048
    s_add_u32 s76, s69, 393216
    buffer_load_dwordx4 v168, s[12:15], s76 offen lds
    s_add_u32 m0, s66, 3072
    s_add_u32 s76, s69, 589824
    buffer_load_dwordx4 v168, s[12:15], s76 offen lds
    s_add_u32 m0, s66, 4096
    s_add_u32 s76, s69, 786432
    buffer_load_dwordx4 v168, s[12:15], s76 offen lds
    s_add_u32 m0, s66, 5120
    s_add_u32 s76, s69, 983040
    buffer_load_dwordx4 v168, s[12:15], s76 offen lds
    s_add_u32 m0, s66, 6144
    s_add_u32 s76, s69, 1179648
    buffer_load_dwordx4 v168, s[12:15], s76 offen lds
    s_add_u32 m0, s66, 7168
    s_add_u32 s76, s69, 1376256
    buffer_load_dwordx4 v168, s[12:15], s76 offen lds
    s_add_u32 m0, s66, 8192
    s_add_u32 s76, s69, 1572864
    buffer_load_dwordx4 v168, s[12:15], s76 offen lds
    s_add_u32 m0, s66, 9216
    s_add_u32 s76, s69, 1769472
    buffer_load_dwordx4 v168, s[12:15], s76 offen lds
    s_add_u32 m0, s66, 10240
    s_add_u32 s76, s69, 1966080
    buffer_load_dwordx4 v168, s[12:15], s76 offen lds
    s_add_u32 m0, s66, 11264
    s_add_u32 s76, s69, 2162688
    buffer_load_dwordx4 v168, s[12:15], s76 offen lds
    s_add_u32 m0, s66, 12288
    s_add_u32 s76, s69, 2359296
    buffer_load_dwordx4 v168, s[12:15], s76 offen lds
    s_add_u32 m0, s66, 13312
    s_add_u32 s76, s69, 2555904
    buffer_load_dwordx4 v168, s[12:15], s76 offen lds
    s_add_u32 m0, s66, 14336
    s_add_u32 s76, s69, 2752512
    buffer_load_dwordx4 v168, s[12:15], s76 offen lds
    s_add_u32 m0, s66, 15360
    s_add_u32 s76, s69, 2949120
    buffer_load_dwordx4 v168, s[12:15], s76 offen lds
    s_add_u32 m0, s66, 16384
    s_add_u32 s76, s69, 3145728
    buffer_load_dwordx4 v168, s[12:15], s76 offen lds
    s_add_u32 m0, s66, 17408
    s_add_u32 s76, s69, 3342336
    buffer_load_dwordx4 v168, s[12:15], s76 offen lds
    s_add_u32 m0, s66, 18432
    s_add_u32 s76, s69, 3538944
    buffer_load_dwordx4 v168, s[12:15], s76 offen lds
    s_add_u32 m0, s66, 19456
    s_add_u32 s76, s69, 3735552
    buffer_load_dwordx4 v168, s[12:15], s76 offen lds
    s_waitcnt vmcnt(16)
    v_add_u32 v170, 0, v169
    v_add_u32 v171, 2048, v169
    ds_read2_b32 v[172:173], v170 offset0:0 offset1:16
    ds_read2_b32 v[174:175], v170 offset0:128 offset1:144
    ds_read2_b32 v[176:177], v170 offset0:32 offset1:48
    ds_read2_b32 v[178:179], v170 offset0:160 offset1:176
    ds_read2_b32 v[180:181], v171 offset0:0 offset1:16
    ds_read2_b32 v[182:183], v171 offset0:128 offset1:144
    ds_read2_b32 v[184:185], v171 offset0:32 offset1:48
    ds_read2_b32 v[186:187], v171 offset0:160 offset1:176
    s_waitcnt lgkmcnt(0)
    s_add_u32 m0, s66, 0
    s_add_u32 s76, s69, 3932160
    buffer_load_dwordx4 v168, s[12:15], s76 offen lds
    s_add_u32 m0, s66, 1024
    s_add_u32 s76, s69, 4128768
    buffer_load_dwordx4 v168, s[12:15], s76 offen lds
    s_add_u32 m0, s66, 2048
    s_add_u32 s76, s69, 4325376
    buffer_load_dwordx4 v168, s[12:15], s76 offen lds
    s_add_u32 m0, s66, 3072
    s_add_u32 s76, s69, 4521984
    buffer_load_dwordx4 v168, s[12:15], s76 offen lds
    v_perm_b32 v8, v173, v172, s80
    v_perm_b32 v88, v173, v172, s81
    v_perm_b32 v9, v175, v174, s80
    v_perm_b32 v89, v175, v174, s81
    v_perm_b32 v10, v177, v176, s80
    v_perm_b32 v90, v177, v176, s81
    v_perm_b32 v11, v179, v178, s80
    v_perm_b32 v91, v179, v178, s81
    v_perm_b32 v12, v181, v180, s80
    v_perm_b32 v92, v181, v180, s81
    v_perm_b32 v13, v183, v182, s80
    v_perm_b32 v93, v183, v182, s81
    v_perm_b32 v14, v185, v184, s80
    v_perm_b32 v94, v185, v184, s81
    v_perm_b32 v15, v187, v186, s80
    v_perm_b32 v95, v187, v186, s81
    s_waitcnt vmcnt(16)
    v_add_u32 v170, 4096, v169
    v_add_u32 v171, 6144, v169
    ds_read2_b32 v[172:173], v170 offset0:0 offset1:16
    ds_read2_b32 v[174:175], v170 offset0:128 offset1:144
    ds_read2_b32 v[176:177], v170 offset0:32 offset1:48
    ds_read2_b32 v[178:179], v170 offset0:160 offset1:176
    ds_read2_b32 v[180:181], v171 offset0:0 offset1:16
    ds_read2_b32 v[182:183], v171 offset0:128 offset1:144
    ds_read2_b32 v[184:185], v171 offset0:32 offset1:48
    ds_read2_b32 v[186:187], v171 offset0:160 offset1:176
    s_waitcnt lgkmcnt(0)
    s_add_u32 m0, s66, 4096
    s_add_u32 s76, s69, 4718592
    buffer_load_dwordx4 v168, s[12:15], s76 offen lds
    s_add_u32 m0, s66, 5120
    s_add_u32 s76, s69, 4915200
    buffer_load_dwordx4 v168, s[12:15], s76 offen lds
    s_add_u32 m0, s66, 6144
    s_add_u32 s76, s69, 5111808
    buffer_load_dwordx4 v168, s[12:15], s76 offen lds
    s_add_u32 m0, s66, 7168
    s_add_u32 s76, s69, 5308416
    buffer_load_dwordx4 v168, s[12:15], s76 offen lds
    v_perm_b32 v16, v173, v172, s80
    v_perm_b32 v96, v173, v172, s81
    v_perm_b32 v17, v175, v174, s80
    v_perm_b32 v97, v175, v174, s81
    v_perm_b32 v18, v177, v176, s80
    v_perm_b32 v98, v177, v176, s81
    v_perm_b32 v19, v179, v178, s80
    v_perm_b32 v99, v179, v178, s81
    v_perm_b32 v20, v181, v180, s80
    v_perm_b32 v100, v181, v180, s81
    v_perm_b32 v21, v183, v182, s80
    v_perm_b32 v101, v183, v182, s81
    v_perm_b32 v22, v185, v184, s80
    v_perm_b32 v102, v185, v184, s81
    v_perm_b32 v23, v187, v186, s80
    v_perm_b32 v103, v187, v186, s81
    s_waitcnt vmcnt(16)
    v_add_u32 v170, 8192, v169
    v_add_u32 v171, 10240, v169
    ds_read2_b32 v[172:173], v170 offset0:0 offset1:16
    ds_read2_b32 v[174:175], v170 offset0:128 offset1:144
    ds_read2_b32 v[176:177], v170 offset0:32 offset1:48
    ds_read2_b32 v[178:179], v170 offset0:160 offset1:176
    ds_read2_b32 v[180:181], v171 offset0:0 offset1:16
    ds_read2_b32 v[182:183], v171 offset0:128 offset1:144
    ds_read2_b32 v[184:185], v171 offset0:32 offset1:48
    ds_read2_b32 v[186:187], v171 offset0:160 offset1:176
    s_waitcnt lgkmcnt(0)
    s_add_u32 m0, s66, 8192
    s_add_u32 s76, s69, 5505024
    buffer_load_dwordx4 v168, s[12:15], s76 offen lds
    s_add_u32 m0, s66, 9216
    s_add_u32 s76, s69, 5701632
    buffer_load_dwordx4 v168, s[12:15], s76 offen lds
    s_add_u32 m0, s66, 10240
    s_add_u32 s76, s69, 5898240
    buffer_load_dwordx4 v168, s[12:15], s76 offen lds
    s_add_u32 m0, s66, 11264
    s_add_u32 s76, s69, 6094848
    buffer_load_dwordx4 v168, s[12:15], s76 offen lds
    v_perm_b32 v24, v173, v172, s80
    v_perm_b32 v104, v173, v172, s81
    v_perm_b32 v25, v175, v174, s80
    v_perm_b32 v105, v175, v174, s81
    v_perm_b32 v26, v177, v176, s80
    v_perm_b32 v106, v177, v176, s81
    v_perm_b32 v27, v179, v178, s80
    v_perm_b32 v107, v179, v178, s81
    v_perm_b32 v28, v181, v180, s80
    v_perm_b32 v108, v181, v180, s81
    v_perm_b32 v29, v183, v182, s80
    v_perm_b32 v109, v183, v182, s81
    v_perm_b32 v30, v185, v184, s80
    v_perm_b32 v110, v185, v184, s81
    v_perm_b32 v31, v187, v186, s80
    v_perm_b32 v111, v187, v186, s81
    s_waitcnt vmcnt(16)
    v_add_u32 v170, 12288, v169
    v_add_u32 v171, 14336, v169
    ds_read2_b32 v[172:173], v170 offset0:0 offset1:16
    ds_read2_b32 v[174:175], v170 offset0:128 offset1:144
    ds_read2_b32 v[176:177], v170 offset0:32 offset1:48
    ds_read2_b32 v[178:179], v170 offset0:160 offset1:176
    ds_read2_b32 v[180:181], v171 offset0:0 offset1:16
    ds_read2_b32 v[182:183], v171 offset0:128 offset1:144
    ds_read2_b32 v[184:185], v171 offset0:32 offset1:48
    ds_read2_b32 v[186:187], v171 offset0:160 offset1:176
    s_waitcnt lgkmcnt(0)
    s_add_u32 m0, s66, 12288
    s_add_u32 s76, s69, 6291456
    buffer_load_dwordx4 v168, s[12:15], s76 offen lds
    s_add_u32 m0, s66, 13312
    s_add_u32 s76, s69, 6488064
    buffer_load_dwordx4 v168, s[12:15], s76 offen lds
    s_add_u32 m0, s66, 14336
    s_add_u32 s76, s69, 6684672
    buffer_load_dwordx4 v168, s[12:15], s76 offen lds
    s_add_u32 m0, s66, 15360
    s_add_u32 s76, s69, 6881280
    buffer_load_dwordx4 v168, s[12:15], s76 offen lds
    v_perm_b32 v32, v173, v172, s80
    v_perm_b32 v112, v173, v172, s81
    v_perm_b32 v33, v175, v174, s80
    v_perm_b32 v113, v175, v174, s81
    v_perm_b32 v34, v177, v176, s80
    v_perm_b32 v114, v177, v176, s81
    v_perm_b32 v35, v179, v178, s80
    v_perm_b32 v115, v179, v178, s81
    v_perm_b32 v36, v181, v180, s80
    v_perm_b32 v116, v181, v180, s81
    v_perm_b32 v37, v183, v182, s80
    v_perm_b32 v117, v183, v182, s81
    v_perm_b32 v38, v185, v184, s80
    v_perm_b32 v118, v185, v184, s81
    v_perm_b32 v39, v187, v186, s80
    v_perm_b32 v119, v187, v186, s81
    s_waitcnt vmcnt(16)
    v_add_u32 v170, 16384, v169
    v_add_u32 v171, 18432, v169
    ds_read2_b32 v[172:173], v170 offset0:0 offset1:16
    ds_read2_b32 v[174:175], v170 offset0:128 offset1:144
    ds_read2_b32 v[176:177], v170 offset0:32 offset1:48
    ds_read2_b32 v[178:179], v170 offset0:160 offset1:176
    ds_read2_b32 v[180:181], v171 offset0:0 offset1:16
    ds_read2_b32 v[182:183], v171 offset0:128 offset1:144
    ds_read2_b32 v[184:185], v171 offset0:32 offset1:48
    ds_read2_b32 v[186:187], v171 offset0:160 offset1:176
    s_waitcnt lgkmcnt(0)
    s_add_u32 m0, s66, 16384
    s_add_u32 s76, s69, 7077888
    buffer_load_dwordx4 v168, s[12:15], s76 offen lds
    s_add_u32 m0, s66, 17408
    s_add_u32 s76, s69, 7274496
    buffer_load_dwordx4 v168, s[12:15], s76 offen lds
    s_add_u32 m0, s66, 18432
    s_add_u32 s76, s69, 7471104
    buffer_load_dwordx4 v168, s[12:15], s76 offen lds
    s_add_u32 m0, s66, 19456
    s_add_u32 s76, s69, 7667712
    buffer_load_dwordx4 v168, s[12:15], s76 offen lds
    v_perm_b32 v40, v173, v172, s80
    v_perm_b32 v120, v173, v172, s81
    v_perm_b32 v41, v175, v174, s80
    v_perm_b32 v121, v175, v174, s81
    v_perm_b32 v42, v177, v176, s80
    v_perm_b32 v122, v177, v176, s81
    v_perm_b32 v43, v179, v178, s80
    v_perm_b32 v123, v179, v178, s81
    v_perm_b32 v44, v181, v180, s80
    v_perm_b32 v124, v181, v180, s81
    v_perm_b32 v45, v183, v182, s80
    v_perm_b32 v125, v183, v182, s81
    v_perm_b32 v46, v185, v184, s80
    v_perm_b32 v126, v185, v184, s81
    v_perm_b32 v47, v187, v186, s80
    v_perm_b32 v127, v187, v186, s81
    s_waitcnt vmcnt(16)
    v_add_u32 v170, 0, v169
    v_add_u32 v171, 2048, v169
    ds_read2_b32 v[172:173], v170 offset0:0 offset1:16
    ds_read2_b32 v[174:175], v170 offset0:128 offset1:144
    ds_read2_b32 v[176:177], v170 offset0:32 offset1:48
    ds_read2_b32 v[178:179], v170 offset0:160 offset1:176
    ds_read2_b32 v[180:181], v171 offset0:0 offset1:16
    ds_read2_b32 v[182:183], v171 offset0:128 offset1:144
    ds_read2_b32 v[184:185], v171 offset0:32 offset1:48
    ds_read2_b32 v[186:187], v171 offset0:160 offset1:176
    s_waitcnt lgkmcnt(0)
    v_perm_b32 v48, v173, v172, s80
    v_perm_b32 v128, v173, v172, s81
    v_perm_b32 v49, v175, v174, s80
    v_perm_b32 v129, v175, v174, s81
    v_perm_b32 v50, v177, v176, s80
    v_perm_b32 v130, v177, v176, s81
    v_perm_b32 v51, v179, v178, s80
    v_perm_b32 v131, v179, v178, s81
    v_perm_b32 v52, v181, v180, s80
    v_perm_b32 v132, v181, v180, s81
    v_perm_b32 v53, v183, v182, s80
    v_perm_b32 v133, v183, v182, s81
    v_perm_b32 v54, v185, v184, s80
    v_perm_b32 v134, v185, v184, s81
    v_perm_b32 v55, v187, v186, s80
    v_perm_b32 v135, v187, v186, s81
    s_waitcnt vmcnt(12)
    v_add_u32 v170, 4096, v169
    v_add_u32 v171, 6144, v169
    ds_read2_b32 v[172:173], v170 offset0:0 offset1:16
    ds_read2_b32 v[174:175], v170 offset0:128 offset1:144
    ds_read2_b32 v[176:177], v170 offset0:32 offset1:48
    ds_read2_b32 v[178:179], v170 offset0:160 offset1:176
    ds_read2_b32 v[180:181], v171 offset0:0 offset1:16
    ds_read2_b32 v[182:183], v171 offset0:128 offset1:144
    ds_read2_b32 v[184:185], v171 offset0:32 offset1:48
    ds_read2_b32 v[186:187], v171 offset0:160 offset1:176
    s_waitcnt lgkmcnt(0)
    v_perm_b32 v56, v173, v172, s80
    v_perm_b32 v136, v173, v172, s81
    v_perm_b32 v57, v175, v174, s80
    v_perm_b32 v137, v175, v174, s81
    v_perm_b32 v58, v177, v176, s80
    v_perm_b32 v138, v177, v176, s81
    v_perm_b32 v59, v179, v178, s80
    v_perm_b32 v139, v179, v178, s81
    v_perm_b32 v60, v181, v180, s80
    v_perm_b32 v140, v181, v180, s81
    v_perm_b32 v61, v183, v182, s80
    v_perm_b32 v141, v183, v182, s81
    v_perm_b32 v62, v185, v184, s80
    v_perm_b32 v142, v185, v184, s81
    v_perm_b32 v63, v187, v186, s80
    v_perm_b32 v143, v187, v186, s81
    s_waitcnt vmcnt(8)
    v_add_u32 v170, 8192, v169
    v_add_u32 v171, 10240, v169
    ds_read2_b32 v[172:173], v170 offset0:0 offset1:16
    ds_read2_b32 v[174:175], v170 offset0:128 offset1:144
    ds_read2_b32 v[176:177], v170 offset0:32 offset1:48
    ds_read2_b32 v[178:179], v170 offset0:160 offset1:176
    ds_read2_b32 v[180:181], v171 offset0:0 offset1:16
    ds_read2_b32 v[182:183], v171 offset0:128 offset1:144
    ds_read2_b32 v[184:185], v171 offset0:32 offset1:48
    ds_read2_b32 v[186:187], v171 offset0:160 offset1:176
    s_waitcnt lgkmcnt(0)
    v_perm_b32 v64, v173, v172, s80
    v_perm_b32 v144, v173, v172, s81
    v_perm_b32 v65, v175, v174, s80
    v_perm_b32 v145, v175, v174, s81
    v_perm_b32 v66, v177, v176, s80
    v_perm_b32 v146, v177, v176, s81
    v_perm_b32 v67, v179, v178, s80
    v_perm_b32 v147, v179, v178, s81
    v_perm_b32 v68, v181, v180, s80
    v_perm_b32 v148, v181, v180, s81
    v_perm_b32 v69, v183, v182, s80
    v_perm_b32 v149, v183, v182, s81
    v_perm_b32 v70, v185, v184, s80
    v_perm_b32 v150, v185, v184, s81
    v_perm_b32 v71, v187, v186, s80
    v_perm_b32 v151, v187, v186, s81
    s_waitcnt vmcnt(4)
    v_add_u32 v170, 12288, v169
    v_add_u32 v171, 14336, v169
    ds_read2_b32 v[172:173], v170 offset0:0 offset1:16
    ds_read2_b32 v[174:175], v170 offset0:128 offset1:144
    ds_read2_b32 v[176:177], v170 offset0:32 offset1:48
    ds_read2_b32 v[178:179], v170 offset0:160 offset1:176
    ds_read2_b32 v[180:181], v171 offset0:0 offset1:16
    ds_read2_b32 v[182:183], v171 offset0:128 offset1:144
    ds_read2_b32 v[184:185], v171 offset0:32 offset1:48
    ds_read2_b32 v[186:187], v171 offset0:160 offset1:176
    s_waitcnt lgkmcnt(0)
    v_perm_b32 v72, v173, v172, s80
    v_perm_b32 v152, v173, v172, s81
    v_perm_b32 v73, v175, v174, s80
    v_perm_b32 v153, v175, v174, s81
    v_perm_b32 v74, v177, v176, s80
    v_perm_b32 v154, v177, v176, s81
    v_perm_b32 v75, v179, v178, s80
    v_perm_b32 v155, v179, v178, s81
    v_perm_b32 v76, v181, v180, s80
    v_perm_b32 v156, v181, v180, s81
    v_perm_b32 v77, v183, v182, s80
    v_perm_b32 v157, v183, v182, s81
    v_perm_b32 v78, v185, v184, s80
    v_perm_b32 v158, v185, v184, s81
    v_perm_b32 v79, v187, v186, s80
    v_perm_b32 v159, v187, v186, s81
    s_waitcnt vmcnt(0)
    v_add_u32 v170, 16384, v169
    v_add_u32 v171, 18432, v169
    ds_read2_b32 v[172:173], v170 offset0:0 offset1:16
    ds_read2_b32 v[174:175], v170 offset0:128 offset1:144
    ds_read2_b32 v[176:177], v170 offset0:32 offset1:48
    ds_read2_b32 v[178:179], v170 offset0:160 offset1:176
    ds_read2_b32 v[180:181], v171 offset0:0 offset1:16
    ds_read2_b32 v[182:183], v171 offset0:128 offset1:144
    ds_read2_b32 v[184:185], v171 offset0:32 offset1:48
    ds_read2_b32 v[186:187], v171 offset0:160 offset1:176
    s_waitcnt lgkmcnt(0)
    v_perm_b32 v80, v173, v172, s80
    v_perm_b32 v160, v173, v172, s81
    v_perm_b32 v81, v175, v174, s80
    v_perm_b32 v161, v175, v174, s81
    v_perm_b32 v82, v177, v176, s80
    v_perm_b32 v162, v177, v176, s81
    v_perm_b32 v83, v179, v178, s80
    v_perm_b32 v163, v179, v178, s81
    v_perm_b32 v84, v181, v180, s80
    v_perm_b32 v164, v181, v180, s81
    v_perm_b32 v85, v183, v182, s80
    v_perm_b32 v165, v183, v182, s81
    v_perm_b32 v86, v185, v184, s80
    v_perm_b32 v166, v185, v184, s81
    v_perm_b32 v87, v187, v186, s80
    v_perm_b32 v167, v187, v186, s81
    s_and_b32 s69, s49, 1
    s_lshl_b32 s69, s69, 4
    s_add_u32 s69, s69, s50
    s_lshl_b32 s76, s48, 5
    s_add_u32 s69, s69, s76
    s_lshr_b32 s67, s69, 1
    s_and_b32 s77, s69, 1
    s_lshl_b32 s69, s67, 8
    s_lshl_b32 s78, s77, 4
    s_add_u32 s69, s69, s78
    s_lshl_b32 s76, s67, 14
    s_lshl_b32 s78, s77, 7
    s_add_u32 s76, s76, s78
    v_lshlrev_b32 v220, 8, v3
    v_lshrrev_b32 v4, 3, v2
    v_lshl_add_u32 v220, v4, 10, v220
    v_and_b32 v4, 7, v2
    v_lshl_add_u32 v220, v4, 4, v220
    v_add_u32 v220, s76, v220
    v_add_u32 v221, 4096, v220
    v_bfe_u32 v4, v2, 2, 1
    v_lshlrev_b32 v231, 5, v4
    v_and_b32 v4, 3, v2
    v_lshl_add_u32 v231, v4, 6, v231
    v_lshl_add_u32 v231, v3, 3, v231
    v_add_u32 v231, s69, v231
    s_mov_b32 s46, 0x00ff00ff
    s_mov_b32 s47, 0
    s_nop 0
    v_mov_b32 v232, -1
    v_mov_b32 v233, -1
    v_mov_b32 v216, 0
    v_mov_b32 v4, 0x3f80
    v_cmp_eq_u32 vcc, 0, v2
    s_nop 1
    v_cndmask_b32 v216, v216, v4, vcc
    v_mov_b32 v4, 0x3f800000
    v_cmp_eq_u32 vcc, 1, v2
    s_nop 1
    v_cndmask_b32 v216, v216, v4, vcc
    v_mov_b32 v217, 0
    v_mov_b32 v4, 0x3f80
    v_cmp_eq_u32 vcc, 2, v2
    s_nop 1
    v_cndmask_b32 v217, v217, v4, vcc
    v_mov_b32 v4, 0x3f800000
    v_cmp_eq_u32 vcc, 3, v2
    s_nop 1
    v_cndmask_b32 v217, v217, v4, vcc
    v_mov_b32 v218, 0
    v_mov_b32 v4, 0x3f80
    v_cmp_eq_u32 vcc, 4, v2
    s_nop 1
    v_cndmask_b32 v218, v218, v4, vcc
    v_mov_b32 v4, 0x3f800000
    v_cmp_eq_u32 vcc, 5, v2
    s_nop 1
    v_cndmask_b32 v218, v218, v4, vcc
    v_mov_b32 v219, 0
    v_mov_b32 v4, 0x3f80
    v_cmp_eq_u32 vcc, 6, v2
    s_nop 1
    v_cndmask_b32 v219, v219, v4, vcc
    v_mov_b32 v4, 0x3f800000
    v_cmp_eq_u32 vcc, 7, v2
    s_nop 1
    v_cndmask_b32 v219, v219, v4, vcc
    v_mov_b32 v208, 0
    v_mov_b32 v209, 0
    v_mov_b32 v210, 0
    v_mov_b32 v211, 0
    v_mov_b32 v212, 0
    v_mov_b32 v213, 0
    v_mov_b32 v214, 0
    v_mov_b32 v215, 0
    s_setprio 2
    s_barrier
    s_cmp_lg_u32 s48, 0
    s_cbranch_scc1 Lp0_15
    v_lshlrev_b32 v5, 2, v1
Lreg_16:
    buffer_load_dword v4, v5, s[8:11], 0 offen sc0 sc1
    s_waitcnt vmcnt(0)
    v_readlane_b32 s69, v4, 8
    v_readlane_b32 s76, v4, 32
    s_add_u32 s69, s69, s76
    s_cmp_ge_u32 s69, 640
    s_cbranch_scc1 Lregd_17
    s_sleep 24
    s_sub_u32 s54, s54, 1
    s_cbranch_scc0 Lreg_16
    s_mov_b32 s54, 0
Lregd_17:
    v_readlane_b32 s79, v4, 34
    v_cmp_ne_u32 vcc, 32, v4
    s_and_b32 s79, s79, 1
    s_and_b32 s69, vcc_lo, 0xf
    s_and_b32 s76, vcc_hi, 0xf00
    s_or_b32 s69, s69, s76
    s_cselect_b32 s53, 1, 0
    s_lshl_b32 s79, s79, 1
    s_or_b32 s79, s79, s53
    v_mov_b32 v4, s79
    v_mov_b32 v5, 34880
    ds_write_b32 v5, v4
    s_waitcnt lgkmcnt(0)
Lp0_15:
    s_barrier
    v_mov_b32 v5, 34880
    ds_read_b32 v4, v5
    s_waitcnt lgkmcnt(0)
    v_readfirstlane_b32 s79, v4
    s_and_b32 s53, s79, 1
    s_lshr_b32 s79, s79, 1
    s_and_b32 s69, s55, 3
    s_add_u32 s76, s55, 1
    s_and_b32 s76, s76, 3
    s_xor_b32 s77, s69, 2
    s_lshr_b32 s78, s49, 1
    s_mul_i32 s78, s78, 10240
    s_add_u32 s78, s78, 106954752
    s_mul_i32 s56, s76, 81920
    s_add_u32 s56, s56, s78
    s_mul_i32 s57, s77, 81920
    s_add_u32 s57, s57, s78
    s_mul_i32 s78, s51, 9216
    s_add_u32 s78, s78, 107282432
    s_mul_i32 s58, s69, 294912
    s_add_u32 s58, s58, s78
    s_mul_i32 s59, s77, 294912
    s_add_u32 s59, s59, s78
    s_and_b32 s69, s97, 255
    s_mul_i32 s76, s69, 86
    s_lshr_b32 s76, s76, 8
    s_mul_i32 s62, s69, 655360
    s_mul_i32 s77, s76, 131072
    s_add_u32 s62, s62, s77
    s_add_u32 s62, s62, 167772160
    s_xor_b32 s76, s79, s76
    s_and_b32 s76, s76, 1
    s_lshl_b32 s76, s76, 13
    s_add_u32 s62, s62, s76
    s_lshl_b32 s78, s51, 8
    s_add_u32 s60, s62, s78
    s_lshl_b32 s95, s97, 8
    s_and_b32 s95, s95, 0x10000
    s_xor_b32 s94, s95, 0x10000
    s_mul_i32 s63, s55, 393216
    s_add_u32 s63, s63, 75497472
    s_barrier
    s_barrier
Lqk_18:
    s_barrier
    ds_read_b128 v[168:171], v226 offset:0
    ds_read_b128 v[172:175], v226 offset:1024
    ds_read_b128 v[176:179], v226 offset:2048
    ds_read_b128 v[180:183], v226 offset:3072
    ds_read_b128 v[184:187], v226 offset:4096
    ds_read_b128 v[188:191], v226 offset:5120
    ds_read_b128 v[192:195], v226 offset:6144
    ds_read_b128 v[196:199], v226 offset:7168
    ds_read_b128 v[200:203], v226 offset:8192
    ds_read_b128 v[204:207], v226 offset:9216
    s_waitcnt lgkmcnt(9)
    v_smfmac_f32_16x16x64_bf16 v[208:211], v[168:171], v[8:15], v229
    v_smfmac_f32_16x16x64_bf16 v[212:215], v[168:171], v[88:95], v229
    s_waitcnt lgkmcnt(8)
    v_smfmac_f32_16x16x64_bf16 v[208:211], v[172:175], v[16:23], v229
    v_smfmac_f32_16x16x64_bf16 v[212:215], v[172:175], v[96:103], v229
    s_waitcnt lgkmcnt(7)
    v_smfmac_f32_16x16x64_bf16 v[208:211], v[176:179], v[24:31], v229
    v_smfmac_f32_16x16x64_bf16 v[212:215], v[176:179], v[104:111], v229
    s_waitcnt lgkmcnt(6)
    v_smfmac_f32_16x16x64_bf16 v[208:211], v[180:183], v[32:39], v229
    v_smfmac_f32_16x16x64_bf16 v[212:215], v[180:183], v[112:119], v229
    s_waitcnt lgkmcnt(5)
    v_smfmac_f32_16x16x64_bf16 v[208:211], v[184:187], v[40:47], v229
    v_smfmac_f32_16x16x64_bf16 v[212:215], v[184:187], v[120:127], v229
    s_waitcnt lgkmcnt(4)
    v_smfmac_f32_16x16x64_bf16 v[208:211], v[188:191], v[48:55], v229
    v_smfmac_f32_16x16x64_bf16 v[212:215], v[188:191], v[128:135], v229
    s_waitcnt lgkmcnt(3)
    v_smfmac_f32_16x16x64_bf16 v[208:211], v[192:195], v[56:63], v229
    v_smfmac_f32_16x16x64_bf16 v[212:215], v[192:195], v[136:143], v229
    s_waitcnt lgkmcnt(2)
    v_smfmac_f32_16x16x64_bf16 v[208:211], v[196:199], v[64:71], v229
    v_smfmac_f32_16x16x64_bf16 v[212:215], v[196:199], v[144:151], v229
    s_waitcnt lgkmcnt(1)
    v_smfmac_f32_16x16x64_bf16 v[208:211], v[200:203], v[72:79], v229
    v_smfmac_f32_16x16x64_bf16 v[212:215], v[200:203], v[152:159], v229
    s_waitcnt lgkmcnt(0)
    v_smfmac_f32_16x16x64_bf16 v[208:211], v[204:207], v[80:87], v229
    v_smfmac_f32_16x16x64_bf16 v[212:215], v[204:207], v[160:167], v229
    s_nop 7
    v_pk_add_f32 v[208:209], v[208:209], v[210:211]
    v_pk_add_f32 v[214:215], v[212:213], v[214:215]
    v_cvt_pk_bf16_f32 v208, v208, v214
    v_cvt_pk_bf16_f32 v212, v209, v215
    v_min_u32 v208, -2, v208
    v_min_u32 v212, -2, v212
    s_cmp_lg_u32 s53, 0
    s_cbranch_scc1 Lslow_20
    buffer_store_dword v208, v230, s[4:7], s58 offen
    buffer_store_dword v212, v230, s[4:7], s58 offen offset:64
Lback_21:
    s_barrier
    v_mov_b32 v208, 0
    v_mov_b32 v209, 0
    v_mov_b32 v210, 0
    v_mov_b32 v211, 0
    v_mov_b32 v212, 0
    v_mov_b32 v213, 0
    v_mov_b32 v214, 0
    v_mov_b32 v215, 0
    s_barrier
    s_cmp_lg_u32 s53, 0
    s_cbranch_scc1 Lslow_22
    buffer_store_dword v232, v230, s[4:7], s59 offen
    buffer_store_dword v232, v230, s[4:7], s59 offen offset:64
Lback_23:
    s_cmp_ge_u32 s67, 40
    s_cbranch_scc1 Lqar_24
    s_mov_b64 exec, s[46:47]
    s_cmp_lg_u32 s53, 0
    s_cbranch_scc1 Lslow_25
    buffer_store_dwordx2 v[232:233], v231, s[4:7], s57 offen
Lback_26:
    s_mov_b64 exec, -1
Lqar_24:
    s_barrier
    s_cmp_eq_u32 s55, 63
    s_cbranch_scc1 Lqkend_19
    s_cmp_ge_u32 s67, 40
    s_cbranch_scc1 Lqnr_33
    s_bitcmp1_b32 s97, 8
    s_cbranch_scc1 LpC_32_in
LpC_31_in:
    s_sleep 13
LpC_31:
    buffer_load_dwordx4 v[168:171], v220, s[4:7], s62 offen offset:0 sc1
    buffer_load_dwordx4 v[172:175], v220, s[4:7], s62 offen offset:2048 sc1
    buffer_load_dwordx4 v[176:179], v221, s[4:7], s62 offen offset:0 sc1
    buffer_load_dwordx4 v[180:183], v221, s[4:7], s62 offen offset:2048 sc1
    s_mov_b64 exec, -1
    s_waitcnt vmcnt(3)
    v_mfma_f32_16x16x32_bf16 v[222:225], v[216:219], v[168:171], 0
    v_or3_b32 v4, v168, v169, v170
    v_or3_b32 v4, v4, v171, v171
    s_waitcnt vmcnt(2)
    v_mfma_f32_16x16x32_bf16 v[222:225], v[216:219], v[172:175], v[222:225]
    v_or3_b32 v4, v4, v172, v173
    v_or3_b32 v4, v4, v174, v175
    s_waitcnt vmcnt(1)
    v_mfma_f32_16x16x32_bf16 v[222:225], v[216:219], v[176:179], v[222:225]
    v_or3_b32 v4, v4, v176, v177
    v_or3_b32 v4, v4, v178, v179
    s_waitcnt vmcnt(0)
    v_mfma_f32_16x16x32_bf16 v[222:225], v[216:219], v[180:183], v[222:225]
    v_or3_b32 v4, v4, v180, v181
    v_or3_b32 v4, v4, v182, v183
    v_and_b32 v4, 1, v4
    v_cmp_ne_u32 vcc, 0, v4
    s_cbranch_vccnz LpCr_34
LpCb_35:
    s_nop 2
    v_add_f32_dpp v222, v222, v222 row_ror:8 row_mask:0xf bank_mask:0xf
    v_add_f32_dpp v223, v223, v223 row_ror:8 row_mask:0xf bank_mask:0xf
    v_add_f32_dpp v224, v224, v224 row_ror:8 row_mask:0xf bank_mask:0xf
    v_add_f32_dpp v225, v225, v225 row_ror:8 row_mask:0xf bank_mask:0xf
    v_cvt_pk_bf16_f32 v222, v222, v223
    v_cvt_pk_bf16_f32 v223, v224, v225
    s_mov_b64 exec, s[46:47]
    v_min_u32 v222, -2, v222
    v_min_u32 v223, -2, v223
    s_cmp_lg_u32 s53, 0
    s_cbranch_scc1 Lslow_36
    buffer_store_dwordx2 v[222:223], v231, s[4:7], s56 offen
Lback_37:
    s_branch LpCfin_28
LpC_32_in:
    s_sleep 13
LpC_32:
    buffer_load_dwordx4 v[168:171], v220, s[4:7], s62 offen offset:0 sc1
    buffer_load_dwordx4 v[172:175], v220, s[4:7], s62 offen offset:2048 sc1
    buffer_load_dwordx4 v[176:179], v221, s[4:7], s62 offen offset:0 sc1
    buffer_load_dwordx4 v[180:183], v221, s[4:7], s62 offen offset:2048 sc1
    s_mov_b64 exec, -1
    s_waitcnt vmcnt(3)
    v_mfma_f32_16x16x32_bf16 v[222:225], v[216:219], v[168:171], 0
    v_bitop3_b32 v4, v168, v169, v170 bitop3:0x80
    v_bitop3_b32 v4, v4, v171, v171 bitop3:0x80
    s_waitcnt vmcnt(2)
    v_mfma_f32_16x16x32_bf16 v[222:225], v[216:219], v[172:175], v[222:225]
    v_bitop3_b32 v4, v4, v172, v173 bitop3:0x80
    v_bitop3_b32 v4, v4, v174, v175 bitop3:0x80
    s_waitcnt vmcnt(1)
    v_mfma_f32_16x16x32_bf16 v[222:225], v[216:219], v[176:179], v[222:225]
    v_bitop3_b32 v4, v4, v176, v177 bitop3:0x80
    v_bitop3_b32 v4, v4, v178, v179 bitop3:0x80
    s_waitcnt vmcnt(0)
    v_mfma_f32_16x16x32_bf16 v[222:225], v[216:219], v[180:183], v[222:225]
    v_bitop3_b32 v4, v4, v180, v181 bitop3:0x80
    v_bitop3_b32 v4, v4, v182, v183 bitop3:0x80
    v_and_b32 v4, 1, v4
    v_cmp_ne_u32 vcc, 1, v4
    s_cbranch_vccnz LpCr_38
LpCb_39:
    s_nop 2
    v_add_f32_dpp v222, v222, v222 row_ror:8 row_mask:0xf bank_mask:0xf
    v_add_f32_dpp v223, v223, v223 row_ror:8 row_mask:0xf bank_mask:0xf
    v_add_f32_dpp v224, v224, v224 row_ror:8 row_mask:0xf bank_mask:0xf
    v_add_f32_dpp v225, v225, v225 row_ror:8 row_mask:0xf bank_mask:0xf
    v_cvt_pk_bf16_f32 v222, v222, v223
    v_cvt_pk_bf16_f32 v223, v224, v225
    s_mov_b64 exec, s[46:47]
    v_min_u32 v222, -2, v222
    v_min_u32 v223, -2, v223
    s_cmp_lg_u32 s53, 0
    s_cbranch_scc1 Lslow_40
    buffer_store_dwordx2 v[222:223], v231, s[4:7], s56 offen
Lback_41:
    s_branch LpCfin_28
Lqnr_33:
    s_waitcnt vmcnt(0)
LpCfin_28:
    s_mov_b64 exec, -1
    s_barrier
    s_add_u32 s55, s55, 1
    s_add_u32 s97, s97, 1
    s_and_b32 s69, s97, 255
    s_xor_b32 s76, s97, 265
    s_cmp_eq_u32 s69, 9
    s_cselect_b32 s97, s76, s97
    s_and_b32 s69, s55, 3
    s_add_u32 s76, s55, 1
    s_and_b32 s76, s76, 3
    s_xor_b32 s77, s69, 2
    s_lshr_b32 s78, s49, 1
    s_mul_i32 s78, s78, 10240
    s_add_u32 s78, s78, 106954752
    s_mul_i32 s56, s76, 81920
    s_add_u32 s56, s56, s78
    s_mul_i32 s57, s77, 81920
    s_add_u32 s57, s57, s78
    s_mul_i32 s78, s51, 9216
    s_add_u32 s78, s78, 107282432
    s_mul_i32 s58, s69, 294912
    s_add_u32 s58, s58, s78
    s_mul_i32 s59, s77, 294912
    s_add_u32 s59, s59, s78
    s_and_b32 s69, s97, 255
    s_mul_i32 s76, s69, 86
    s_lshr_b32 s76, s76, 8
    s_mul_i32 s62, s69, 655360
    s_mul_i32 s77, s76, 131072
    s_add_u32 s62, s62, s77
    s_add_u32 s62, s62, 167772160
    s_xor_b32 s76, s79, s76
    s_and_b32 s76, s76, 1
    s_lshl_b32 s76, s76, 13
    s_add_u32 s62, s62, s76
    s_lshl_b32 s78, s51, 8
    s_add_u32 s60, s62, s78
    s_lshl_b32 s95, s97, 8
    s_and_b32 s95, s95, 0x10000
    s_xor_b32 s94, s95, 0x10000
    s_mul_i32 s63, s55, 393216
    s_add_u32 s63, s63, 75497472
    s_waitcnt lgkmcnt(0)
    s_branch Lqk_18
Lqkend_19:
    s_barrier
    s_endpgm
Lslow_20:
    buffer_store_dword v208, v230, s[4:7], s58 offen sc1
    buffer_store_dword v212, v230, s[4:7], s58 offen offset:64 sc1
    s_branch Lback_21
Lslow_22:
    buffer_store_dword v232, v230, s[4:7], s59 offen sc1
    buffer_store_dword v232, v230, s[4:7], s59 offen offset:64 sc1
    s_branch Lback_23
Lslow_25:
    buffer_store_dwordx2 v[232:233], v231, s[4:7], s57 offen sc1
    s_branch Lback_26
Lslow_36:
    buffer_store_dwordx2 v[222:223], v231, s[4:7], s56 offen sc1
    s_branch Lback_37
Lslow_40:
    buffer_store_dwordx2 v[222:223], v231, s[4:7], s56 offen sc1
    s_branch Lback_41
LpCr_34:
    s_mov_b64 exec, vcc
    s_sub_u32 s54, s54, 1
    s_cbranch_scc0 LpC_31
    s_mov_b32 s54, 0
    s_mov_b64 exec, -1
    s_branch LpCb_35
LpCr_38:
    s_mov_b64 exec, vcc
    s_sub_u32 s54, s54, 1
    s_cbranch_scc0 LpC_32
    s_mov_b32 s54, 0
    s_mov_b64 exec, -1
    s_branch LpCb_39
Lrole_v_12:
    v_and_b32 v1, 63, v0
    v_and_b32 v2, 15, v0
    v_bfe_u32 v3, v0, 4, 2
    v_mov_b32 v0, 0xfffe0000
    v_lshrrev_b32 v5, 3, v1
    v_lshlrev_b32 v245, 4, v5
    v_and_b32 v5, 7, v1
    v_lshl_add_u32 v245, v5, 8, v245
    s_lshr_b32 s69, s52, 1
    s_mul_i32 s69, s69, 192
    s_mul_i32 s76, s51, 6
    s_add_u32 s69, s69, s76
    s_lshl_b32 s69, s69, 10
    s_and_b32 s76, s52, 1
    s_lshl_b32 s76, s76, 7
    s_add_u32 s69, s69, s76
    v_add_u32 v245, s69, v245
    v_lshlrev_b32 v238, 8, v3
    v_bfe_u32 v4, v2, 1, 1
    v_lshl_add_u32 v238, v4, 7, v238
    v_lshrrev_b32 v4, 2, v2
    v_lshl_add_u32 v238, v4, 5, v238
    v_and_b32 v4, 1, v2
    v_lshl_add_u32 v238, v4, 4, v238
    v_and_b32 v4, 2, v2
    v_cmp_eq_u32 vcc, 2, v4
    v_mov_b32 v239, 0x44444444
    v_mov_b32 v4, 0xeeeeeeee
    s_nop 1
    v_cndmask_b32 v239, v239, v4, vcc
    v_lshlrev_b32 v242, 4, v1
    v_mov_b32 v243, -1
    s_mul_i32 s69, s52, 768
    s_add_u32 s69, s69, 6144
    v_lshlrev_b32 v240, 5, v2
    v_lshl_add_u32 v240, v3, 2, v240
    v_add_u32 v240, s69, v240
    s_mov_b32 s12, s24
    s_mov_b32 s13, s25
    s_mov_b32 s14, 7864320
    s_mov_b32 s15, 0x20000
    s_mul_i32 s69, s51, 384
    s_mul_i32 s76, s52, 96
    s_add_u32 s69, s69, s76
    v_lshlrev_b32 v6, 2, v2
    s_min_u32 s66, s48, 4
    s_mul_i32 s66, s66, 20480
    s_add_u32 s66, s66, 38912
    v_lshrrev_b32 v168, 2, v1
    s_mov_b32 s76, 12288
    v_mul_lo_u32 v168, v168, s76
    v_and_b32 v169, 3, v1
    v_lshl_add_u32 v168, v169, 4, v168
    v_lshrrev_b32 v169, 1, v3
    v_lshlrev_b32 v169, 10, v169
    v_and_b32 v170, 1, v3
    v_lshl_add_u32 v169, v170, 8, v169
    v_add_u32 v169, v169, v6
    v_add_u32 v169, s66, v169
    s_add_u32 m0, s66, 0
    s_add_u32 s76, s69, 0
    buffer_load_dwordx4 v168, s[12:15], s76 offen lds
    s_add_u32 m0, s66, 1024
    s_add_u32 s76, s69, 196608
    buffer_load_dwordx4 v168, s[12:15], s76 offen lds
    s_add_u32 m0, s66, 2048
    s_add_u32 s76, s69, 393216
    buffer_load_dwordx4 v168, s[12:15], s76 offen lds
    s_add_u32 m0, s66, 3072
    s_add_u32 s76, s69, 589824
    buffer_load_dwordx4 v168, s[12:15], s76 offen lds
    s_add_u32 m0, s66, 4096
    s_add_u32 s76, s69, 786432
    buffer_load_dwordx4 v168, s[12:15], s76 offen lds
    s_add_u32 m0, s66, 5120
    s_add_u32 s76, s69, 983040
    buffer_load_dwordx4 v168, s[12:15], s76 offen lds
    s_add_u32 m0, s66, 6144
    s_add_u32 s76, s69, 1179648
    buffer_load_dwordx4 v168, s[12:15], s76 offen lds
    s_add_u32 m0, s66, 7168
    s_add_u32 s76, s69, 1376256
    buffer_load_dwordx4 v168, s[12:15], s76 offen lds
    s_add_u32 m0, s66, 8192
    s_add_u32 s76, s69, 1572864
    buffer_load_dwordx4 v168, s[12:15], s76 offen lds
    s_add_u32 m0, s66, 9216
    s_add_u32 s76, s69, 1769472
    buffer_load_dwordx4 v168, s[12:15], s76 offen lds
    s_add_u32 m0, s66, 10240
    s_add_u32 s76, s69, 1966080
    buffer_load_dwordx4 v168, s[12:15], s76 offen lds
    s_add_u32 m0, s66, 11264
    s_add_u32 s76, s69, 2162688
    buffer_load_dwordx4 v168, s[12:15], s76 offen lds
    s_add_u32 m0, s66, 12288
    s_add_u32 s76, s69, 2359296
    buffer_load_dwordx4 v168, s[12:15], s76 offen lds
    s_add_u32 m0, s66, 13312
    s_add_u32 s76, s69, 2555904
    buffer_load_dwordx4 v168, s[12:15], s76 offen lds
    s_add_u32 m0, s66, 14336
    s_add_u32 s76, s69, 2752512
    buffer_load_dwordx4 v168, s[12:15], s76 offen lds
    s_add_u32 m0, s66, 15360
    s_add_u32 s76, s69, 2949120
    buffer_load_dwordx4 v168, s[12:15], s76 offen lds
    s_add_u32 m0, s66, 16384
    s_add_u32 s76, s69, 3145728
    buffer_load_dwordx4 v168, s[12:15], s76 offen lds
    s_add_u32 m0, s66, 17408
    s_add_u32 s76, s69, 3342336
    buffer_load_dwordx4 v168, s[12:15], s76 offen lds
    s_add_u32 m0, s66, 18432
    s_add_u32 s76, s69, 3538944
    buffer_load_dwordx4 v168, s[12:15], s76 offen lds
    s_add_u32 m0, s66, 19456
    s_add_u32 s76, s69, 3735552
    buffer_load_dwordx4 v168, s[12:15], s76 offen lds
    s_waitcnt vmcnt(16)
    v_add_u32 v170, 0, v169
    v_add_u32 v171, 2048, v169
    ds_read2_b32 v[172:173], v170 offset0:0 offset1:16
    ds_read2_b32 v[174:175], v170 offset0:128 offset1:144
    ds_read2_b32 v[176:177], v170 offset0:32 offset1:48
    ds_read2_b32 v[178:179], v170 offset0:160 offset1:176
    ds_read2_b32 v[180:181], v171 offset0:0 offset1:16
    ds_read2_b32 v[182:183], v171 offset0:128 offset1:144
    ds_read2_b32 v[184:185], v171 offset0:32 offset1:48
    ds_read2_b32 v[186:187], v171 offset0:160 offset1:176
    s_waitcnt lgkmcnt(0)
    s_add_u32 m0, s66, 0
    s_add_u32 s76, s69, 3932160
    buffer_load_dwordx4 v168, s[12:15], s76 offen lds
    s_add_u32 m0, s66, 1024
    s_add_u32 s76, s69, 4128768
    buffer_load_dwordx4 v168, s[12:15], s76 offen lds
    s_add_u32 m0, s66, 2048
    s_add_u32 s76, s69, 4325376
    buffer_load_dwordx4 v168, s[12:15], s76 offen lds
    s_add_u32 m0, s66, 3072
    s_add_u32 s76, s69, 4521984
    buffer_load_dwordx4 v168, s[12:15], s76 offen lds
    v_perm_b32 v8, v173, v172, s80
    v_perm_b32 v88, v173, v172, s81
    v_perm_b32 v9, v175, v174, s80
    v_perm_b32 v89, v175, v174, s81
    v_perm_b32 v10, v177, v176, s80
    v_perm_b32 v90, v177, v176, s81
    v_perm_b32 v11, v179, v178, s80
    v_perm_b32 v91, v179, v178, s81
    v_perm_b32 v12, v181, v180, s80
    v_perm_b32 v92, v181, v180, s81
    v_perm_b32 v13, v183, v182, s80
    v_perm_b32 v93, v183, v182, s81
    v_perm_b32 v14, v185, v184, s80
    v_perm_b32 v94, v185, v184, s81
    v_perm_b32 v15, v187, v186, s80
    v_perm_b32 v95, v187, v186, s81
    s_waitcnt vmcnt(16)
    v_add_u32 v170, 4096, v169
    v_add_u32 v171, 6144, v169
    ds_read2_b32 v[172:173], v170 offset0:0 offset1:16
    ds_read2_b32 v[174:175], v170 offset0:128 offset1:144
    ds_read2_b32 v[176:177], v170 offset0:32 offset1:48
    ds_read2_b32 v[178:179], v170 offset0:160 offset1:176
    ds_read2_b32 v[180:181], v171 offset0:0 offset1:16
    ds_read2_b32 v[182:183], v171 offset0:128 offset1:144
    ds_read2_b32 v[184:185], v171 offset0:32 offset1:48
    ds_read2_b32 v[186:187], v171 offset0:160 offset1:176
    s_waitcnt lgkmcnt(0)
    s_add_u32 m0, s66, 4096
    s_add_u32 s76, s69, 4718592
    buffer_load_dwordx4 v168, s[12:15], s76 offen lds
    s_add_u32 m0, s66, 5120
    s_add_u32 s76, s69, 4915200
    buffer_load_dwordx4 v168, s[12:15], s76 offen lds
    s_add_u32 m0, s66, 6144
    s_add_u32 s76, s69, 5111808
    buffer_load_dwordx4 v168, s[12:15], s76 offen lds
    s_add_u32 m0, s66, 7168
    s_add_u32 s76, s69, 5308416
    buffer_load_dwordx4 v168, s[12:15], s76 offen lds
    v_perm_b32 v16, v173, v172, s80
    v_perm_b32 v96, v173, v172, s81
    v_perm_b32 v17, v175, v174, s80
    v_perm_b32 v97, v175, v174, s81
    v_perm_b32 v18, v177, v176, s80
    v_perm_b32 v98, v177, v176, s81
    v_perm_b32 v19, v179, v178, s80
    v_perm_b32 v99, v179, v178, s81
    v_perm_b32 v20, v181, v180, s80
    v_perm_b32 v100, v181, v180, s81
    v_perm_b32 v21, v183, v182, s80
    v_perm_b32 v101, v183, v182, s81
    v_perm_b32 v22, v185, v184, s80
    v_perm_b32 v102, v185, v184, s81
    v_perm_b32 v23, v187, v186, s80
    v_perm_b32 v103, v187, v186, s81
    s_waitcnt vmcnt(16)
    v_add_u32 v170, 8192, v169
    v_add_u32 v171, 10240, v169
    ds_read2_b32 v[172:173], v170 offset0:0 offset1:16
    ds_read2_b32 v[174:175], v170 offset0:128 offset1:144
    ds_read2_b32 v[176:177], v170 offset0:32 offset1:48
    ds_read2_b32 v[178:179], v170 offset0:160 offset1:176
    ds_read2_b32 v[180:181], v171 offset0:0 offset1:16
    ds_read2_b32 v[182:183], v171 offset0:128 offset1:144
    ds_read2_b32 v[184:185], v171 offset0:32 offset1:48
    ds_read2_b32 v[186:187], v171 offset0:160 offset1:176
    s_waitcnt lgkmcnt(0)
    s_add_u32 m0, s66, 8192
    s_add_u32 s76, s69, 5505024
    buffer_load_dwordx4 v168, s[12:15], s76 offen lds
    s_add_u32 m0, s66, 9216
    s_add_u32 s76, s69, 5701632
    buffer_load_dwordx4 v168, s[12:15], s76 offen lds
    s_add_u32 m0, s66, 10240
    s_add_u32 s76, s69, 5898240
    buffer_load_dwordx4 v168, s[12:15], s76 offen lds
    s_add_u32 m0, s66, 11264
    s_add_u32 s76, s69, 6094848
    buffer_load_dwordx4 v168, s[12:15], s76 offen lds
    v_perm_b32 v24, v173, v172, s80
    v_perm_b32 v104, v173, v172, s81
    v_perm_b32 v25, v175, v174, s80
    v_perm_b32 v105, v175, v174, s81
    v_perm_b32 v26, v177, v176, s80
    v_perm_b32 v106, v177, v176, s81
    v_perm_b32 v27, v179, v178, s80
    v_perm_b32 v107, v179, v178, s81
    v_perm_b32 v28, v181, v180, s80
    v_perm_b32 v108, v181, v180, s81
    v_perm_b32 v29, v183, v182, s80
    v_perm_b32 v109, v183, v182, s81
    v_perm_b32 v30, v185, v184, s80
    v_perm_b32 v110, v185, v184, s81
    v_perm_b32 v31, v187, v186, s80
    v_perm_b32 v111, v187, v186, s81
    s_waitcnt vmcnt(16)
    v_add_u32 v170, 12288, v169
    v_add_u32 v171, 14336, v169
    ds_read2_b32 v[172:173], v170 offset0:0 offset1:16
    ds_read2_b32 v[174:175], v170 offset0:128 offset1:144
    ds_read2_b32 v[176:177], v170 offset0:32 offset1:48
    ds_read2_b32 v[178:179], v170 offset0:160 offset1:176
    ds_read2_b32 v[180:181], v171 offset0:0 offset1:16
    ds_read2_b32 v[182:183], v171 offset0:128 offset1:144
    ds_read2_b32 v[184:185], v171 offset0:32 offset1:48
    ds_read2_b32 v[186:187], v171 offset0:160 offset1:176
    s_waitcnt lgkmcnt(0)
    s_add_u32 m0, s66, 12288
    s_add_u32 s76, s69, 6291456
    buffer_load_dwordx4 v168, s[12:15], s76 offen lds
    s_add_u32 m0, s66, 13312
    s_add_u32 s76, s69, 6488064
    buffer_load_dwordx4 v168, s[12:15], s76 offen lds
    s_add_u32 m0, s66, 14336
    s_add_u32 s76, s69, 6684672
    buffer_load_dwordx4 v168, s[12:15], s76 offen lds
    s_add_u32 m0, s66, 15360
    s_add_u32 s76, s69, 6881280
    buffer_load_dwordx4 v168, s[12:15], s76 offen lds
    v_perm_b32 v32, v173, v172, s80
    v_perm_b32 v112, v173, v172, s81
    v_perm_b32 v33, v175, v174, s80
    v_perm_b32 v113, v175, v174, s81
    v_perm_b32 v34, v177, v176, s80
    v_perm_b32 v114, v177, v176, s81
    v_perm_b32 v35, v179, v178, s80
    v_perm_b32 v115, v179, v178, s81
    v_perm_b32 v36, v181, v180, s80
    v_perm_b32 v116, v181, v180, s81
    v_perm_b32 v37, v183, v182, s80
    v_perm_b32 v117, v183, v182, s81
    v_perm_b32 v38, v185, v184, s80
    v_perm_b32 v118, v185, v184, s81
    v_perm_b32 v39, v187, v186, s80
    v_perm_b32 v119, v187, v186, s81
    s_waitcnt vmcnt(16)
    v_add_u32 v170, 16384, v169
    v_add_u32 v171, 18432, v169
    ds_read2_b32 v[172:173], v170 offset0:0 offset1:16
    ds_read2_b32 v[174:175], v170 offset0:128 offset1:144
    ds_read2_b32 v[176:177], v170 offset0:32 offset1:48
    ds_read2_b32 v[178:179], v170 offset0:160 offset1:176
    ds_read2_b32 v[180:181], v171 offset0:0 offset1:16
    ds_read2_b32 v[182:183], v171 offset0:128 offset1:144
    ds_read2_b32 v[184:185], v171 offset0:32 offset1:48
    ds_read2_b32 v[186:187], v171 offset0:160 offset1:176
    s_waitcnt lgkmcnt(0)
    s_add_u32 m0, s66, 16384
    s_add_u32 s76, s69, 7077888
    buffer_load_dwordx4 v168, s[12:15], s76 offen lds
    s_add_u32 m0, s66, 17408
    s_add_u32 s76, s69, 7274496
    buffer_load_dwordx4 v168, s[12:15], s76 offen lds
    s_add_u32 m0, s66, 18432
    s_add_u32 s76, s69, 7471104
    buffer_load_dwordx4 v168, s[12:15], s76 offen lds
    s_add_u32 m0, s66, 19456
    s_add_u32 s76, s69, 7667712
    buffer_load_dwordx4 v168, s[12:15], s76 offen lds
    v_perm_b32 v40, v173, v172, s80
    v_perm_b32 v120, v173, v172, s81
    v_perm_b32 v41, v175, v174, s80
    v_perm_b32 v121, v175, v174, s81
    v_perm_b32 v42, v177, v176, s80
    v_perm_b32 v122, v177, v176, s81
    v_perm_b32 v43, v179, v178, s80
    v_perm_b32 v123, v179, v178, s81
    v_perm_b32 v44, v181, v180, s80
    v_perm_b32 v124, v181, v180, s81
    v_perm_b32 v45, v183, v182, s80
    v_perm_b32 v125, v183, v182, s81
    v_perm_b32 v46, v185, v184, s80
    v_perm_b32 v126, v185, v184, s81
    v_perm_b32 v47, v187, v186, s80
    v_perm_b32 v127, v187, v186, s81
    s_waitcnt vmcnt(16)
    v_add_u32 v170, 0, v169
    v_add_u32 v171, 2048, v169
    ds_read2_b32 v[172:173], v170 offset0:0 offset1:16
    ds_read2_b32 v[174:175], v170 offset0:128 offset1:144
    ds_read2_b32 v[176:177], v170 offset0:32 offset1:48
    ds_read2_b32 v[178:179], v170 offset0:160 offset1:176
    ds_read2_b32 v[180:181], v171 offset0:0 offset1:16
    ds_read2_b32 v[182:183], v171 offset0:128 offset1:144
    ds_read2_b32 v[184:185], v171 offset0:32 offset1:48
    ds_read2_b32 v[186:187], v171 offset0:160 offset1:176
    s_waitcnt lgkmcnt(0)
    v_perm_b32 v48, v173, v172, s80
    v_perm_b32 v128, v173, v172, s81
    v_perm_b32 v49, v175, v174, s80
    v_perm_b32 v129, v175, v174, s81
    v_perm_b32 v50, v177, v176, s80
    v_perm_b32 v130, v177, v176, s81
    v_perm_b32 v51, v179, v178, s80
    v_perm_b32 v131, v179, v178, s81
    v_perm_b32 v52, v181, v180, s80
    v_perm_b32 v132, v181, v180, s81
    v_perm_b32 v53, v183, v182, s80
    v_perm_b32 v133, v183, v182, s81
    v_perm_b32 v54, v185, v184, s80
    v_perm_b32 v134, v185, v184, s81
    v_perm_b32 v55, v187, v186, s80
    v_perm_b32 v135, v187, v186, s81
    s_waitcnt vmcnt(12)
    v_add_u32 v170, 4096, v169
    v_add_u32 v171, 6144, v169
    ds_read2_b32 v[172:173], v170 offset0:0 offset1:16
    ds_read2_b32 v[174:175], v170 offset0:128 offset1:144
    ds_read2_b32 v[176:177], v170 offset0:32 offset1:48
    ds_read2_b32 v[178:179], v170 offset0:160 offset1:176
    ds_read2_b32 v[180:181], v171 offset0:0 offset1:16
    ds_read2_b32 v[182:183], v171 offset0:128 offset1:144
    ds_read2_b32 v[184:185], v171 offset0:32 offset1:48
    ds_read2_b32 v[186:187], v171 offset0:160 offset1:176
    s_waitcnt lgkmcnt(0)
    v_perm_b32 v56, v173, v172, s80
    v_perm_b32 v136, v173, v172, s81
    v_perm_b32 v57, v175, v174, s80
    v_perm_b32 v137, v175, v174, s81
    v_perm_b32 v58, v177, v176, s80
    v_perm_b32 v138, v177, v176, s81
    v_perm_b32 v59, v179, v178, s80
    v_perm_b32 v139, v179, v178, s81
    v_perm_b32 v60, v181, v180, s80
    v_perm_b32 v140, v181, v180, s81
    v_perm_b32 v61, v183, v182, s80
    v_perm_b32 v141, v183, v182, s81
    v_perm_b32 v62, v185, v184, s80
    v_perm_b32 v142, v185, v184, s81
    v_perm_b32 v63, v187, v186, s80
    v_perm_b32 v143, v187, v186, s81
    s_waitcnt vmcnt(8)
    v_add_u32 v170, 8192, v169
    v_add_u32 v171, 10240, v169
    ds_read2_b32 v[172:173], v170 offset0:0 offset1:16
    ds_read2_b32 v[174:175], v170 offset0:128 offset1:144
    ds_read2_b32 v[176:177], v170 offset0:32 offset1:48
    ds_read2_b32 v[178:179], v170 offset0:160 offset1:176
    ds_read2_b32 v[180:181], v171 offset0:0 offset1:16
    ds_read2_b32 v[182:183], v171 offset0:128 offset1:144
    ds_read2_b32 v[184:185], v171 offset0:32 offset1:48
    ds_read2_b32 v[186:187], v171 offset0:160 offset1:176
    s_waitcnt lgkmcnt(0)
    v_perm_b32 v64, v173, v172, s80
    v_perm_b32 v144, v173, v172, s81
    v_perm_b32 v65, v175, v174, s80
    v_perm_b32 v145, v175, v174, s81
    v_perm_b32 v66, v177, v176, s80
    v_perm_b32 v146, v177, v176, s81
    v_perm_b32 v67, v179, v178, s80
    v_perm_b32 v147, v179, v178, s81
    v_perm_b32 v68, v181, v180, s80
    v_perm_b32 v148, v181, v180, s81
    v_perm_b32 v69, v183, v182, s80
    v_perm_b32 v149, v183, v182, s81
    v_perm_b32 v70, v185, v184, s80
    v_perm_b32 v150, v185, v184, s81
    v_perm_b32 v71, v187, v186, s80
    v_perm_b32 v151, v187, v186, s81
    s_waitcnt vmcnt(4)
    v_add_u32 v170, 12288, v169
    v_add_u32 v171, 14336, v169
    ds_read2_b32 v[172:173], v170 offset0:0 offset1:16
    ds_read2_b32 v[174:175], v170 offset0:128 offset1:144
    ds_read2_b32 v[176:177], v170 offset0:32 offset1:48
    ds_read2_b32 v[178:179], v170 offset0:160 offset1:176
    ds_read2_b32 v[180:181], v171 offset0:0 offset1:16
    ds_read2_b32 v[182:183], v171 offset0:128 offset1:144
    ds_read2_b32 v[184:185], v171 offset0:32 offset1:48
    ds_read2_b32 v[186:187], v171 offset0:160 offset1:176
    s_waitcnt lgkmcnt(0)
    v_perm_b32 v72, v173, v172, s80
    v_perm_b32 v152, v173, v172, s81
    v_perm_b32 v73, v175, v174, s80
    v_perm_b32 v153, v175, v174, s81
    v_perm_b32 v74, v177, v176, s80
    v_perm_b32 v154, v177, v176, s81
    v_perm_b32 v75, v179, v178, s80
    v_perm_b32 v155, v179, v178, s81
    v_perm_b32 v76, v181, v180, s80
    v_perm_b32 v156, v181, v180, s81
    v_perm_b32 v77, v183, v182, s80
    v_perm_b32 v157, v183, v182, s81
    v_perm_b32 v78, v185, v184, s80
    v_perm_b32 v158, v185, v184, s81
    v_perm_b32 v79, v187, v186, s80
    v_perm_b32 v159, v187, v186, s81
    s_waitcnt vmcnt(0)
    v_add_u32 v170, 16384, v169
    v_add_u32 v171, 18432, v169
    ds_read2_b32 v[172:173], v170 offset0:0 offset1:16
    ds_read2_b32 v[174:175], v170 offset0:128 offset1:144
    ds_read2_b32 v[176:177], v170 offset0:32 offset1:48
    ds_read2_b32 v[178:179], v170 offset0:160 offset1:176
    ds_read2_b32 v[180:181], v171 offset0:0 offset1:16
    ds_read2_b32 v[182:183], v171 offset0:128 offset1:144
    ds_read2_b32 v[184:185], v171 offset0:32 offset1:48
    ds_read2_b32 v[186:187], v171 offset0:160 offset1:176
    s_waitcnt lgkmcnt(0)
    v_perm_b32 v80, v173, v172, s80
    v_perm_b32 v160, v173, v172, s81
    v_perm_b32 v81, v175, v174, s80
    v_perm_b32 v161, v175, v174, s81
    v_perm_b32 v82, v177, v176, s80
    v_perm_b32 v162, v177, v176, s81
    v_perm_b32 v83, v179, v178, s80
    v_perm_b32 v163, v179, v178, s81
    v_perm_b32 v84, v181, v180, s80
    v_perm_b32 v164, v181, v180, s81
    v_perm_b32 v85, v183, v182, s80
    v_perm_b32 v165, v183, v182, s81
    v_perm_b32 v86, v185, v184, s80
    v_perm_b32 v166, v185, v184, s81
    v_perm_b32 v87, v187, v186, s80
    v_perm_b32 v167, v187, v186, s81
    v_lshrrev_b32 v244, 3, v2
    v_lshlrev_b32 v244, 14, v244
    v_bfe_u32 v4, v2, 2, 1
    v_lshl_add_u32 v244, v4, 6, v244
    v_lshl_add_u32 v244, v3, 4, v244
    v_and_b32 v4, 3, v2
    v_lshl_add_u32 v244, v4, 2, v244
    s_mul_i32 s69, s52, 163840
    s_add_u32 s69, s69, 131072
    v_add_u32 v244, s69, v244
    s_sub_u32 s69, s48, 3
    s_lshl_b32 s69, s69, 11
    v_lshlrev_b32 v241, 4, v1
    v_add_u32 v241, s69, v241
    v_mov_b32 v216, 0
    v_mov_b32 v217, 0
    v_mov_b32 v218, 0
    v_mov_b32 v219, 0
    v_mov_b32 v220, 0
    v_mov_b32 v221, 0
    v_mov_b32 v222, 0
    v_mov_b32 v223, 0
    s_setprio 2
    s_barrier
    s_cmp_lg_u32 s48, 0
    s_cbranch_scc1 Lp0_42
    v_lshlrev_b32 v5, 2, v1
Lreg_43:
    buffer_load_dword v4, v5, s[8:11], 0 offen sc0 sc1
    s_waitcnt vmcnt(0)
    v_readlane_b32 s69, v4, 8
    v_readlane_b32 s76, v4, 32
    s_add_u32 s69, s69, s76
    s_cmp_ge_u32 s69, 640
    s_cbranch_scc1 Lregd_44
    s_sleep 24
    s_sub_u32 s54, s54, 1
    s_cbranch_scc0 Lreg_43
    s_mov_b32 s54, 0
Lregd_44:
    v_readlane_b32 s79, v4, 34
    v_cmp_ne_u32 vcc, 32, v4
    s_and_b32 s79, s79, 1
    s_and_b32 s69, vcc_lo, 0xf
    s_and_b32 s76, vcc_hi, 0xf00
    s_or_b32 s69, s69, s76
    s_cselect_b32 s53, 1, 0
    s_lshl_b32 s79, s79, 1
    s_or_b32 s79, s79, s53
    v_mov_b32 v4, s79
    v_mov_b32 v5, 34880
    ds_write_b32 v5, v4
    s_waitcnt lgkmcnt(0)
Lp0_42:
    s_barrier
    v_mov_b32 v5, 34880
    ds_read_b32 v4, v5
    s_waitcnt lgkmcnt(0)
    v_readfirstlane_b32 s79, v4
    s_and_b32 s53, s79, 1
    s_lshr_b32 s79, s79, 1
    s_and_b32 s69, s55, 3
    s_add_u32 s76, s55, 1
    s_and_b32 s76, s76, 3
    s_xor_b32 s77, s69, 2
    s_lshr_b32 s78, s49, 1
    s_mul_i32 s78, s78, 10240
    s_add_u32 s78, s78, 106954752
    s_mul_i32 s56, s76, 81920
    s_add_u32 s56, s56, s78
    s_mul_i32 s57, s77, 81920
    s_add_u32 s57, s57, s78
    s_mul_i32 s78, s51, 9216
    s_add_u32 s78, s78, 107282432
    s_mul_i32 s58, s69, 294912
    s_add_u32 s58, s58, s78
    s_mul_i32 s59, s77, 294912
    s_add_u32 s59, s59, s78
    s_and_b32 s69, s97, 255
    s_mul_i32 s76, s69, 86
    s_lshr_b32 s76, s76, 8
    s_mul_i32 s62, s69, 655360
    s_mul_i32 s77, s76, 131072
    s_add_u32 s62, s62, s77
    s_add_u32 s62, s62, 167772160
    s_xor_b32 s76, s79, s76
    s_and_b32 s76, s76, 1
    s_lshl_b32 s76, s76, 13
    s_add_u32 s62, s62, s76
    s_lshl_b32 s78, s51, 8
    s_add_u32 s60, s62, s78
    s_lshl_b32 s95, s97, 8
    s_and_b32 s95, s95, 0x10000
    s_xor_b32 s94, s95, 0x10000
    s_mul_i32 s63, s55, 393216
    s_add_u32 s63, s63, 75497472
    s_and_b32 s69, s55, 7
    s_cbranch_scc1 Lwts_47
    s_lshr_b32 s69, s55, 3
    s_mul_i32 s69, s69, 48
    s_lshl_b32 s76, s49, 9
    s_add_u32 s69, s69, s76
    s_and_b32 s76, s51, 3
    s_lshl_b32 s76, s76, 2
    s_add_u32 s69, s69, s76
    s_add_u32 s69, s69, 152043552
    v_lshlrev_b32 v5, 4, v1
    s_mov_b64 exec, 1
Lwt_45:
    buffer_load_dword v4, v5, s[4:7], s69 offen sc1
    s_waitcnt vmcnt(0)
    v_cmp_eq_u32 vcc, 0, v4
    s_cbranch_vccz Lwtok_46
    s_sleep 2
    s_sub_u32 s54, s54, 1
    s_cbranch_scc0 Lwt_45
    s_mov_b32 s54, 0
Lwtok_46:
    s_mov_b64 exec, -1
Lwts_47:
    s_mov_b32 s78, 0
    s_lshl_b32 s69, s51, 6
    s_add_u32 s69, s69, s78
    s_mul_i32 s64, s69, 12288
    s_add_u32 s65, s64, 50331648
    s_mul_i32 s69, s78, 86
    s_lshr_b32 s69, s69, 8
    s_mul_i32 s69, s69, 3
    s_sub_u32 s69, s78, s69
    s_mul_i32 s66, s69, 27648
    s_add_u32 s66, s66, 38912
    s_add_u32 s77, s52, 0
    s_and_b32 s77, s77, 3
    s_mul_i32 s77, s77, 3072
    s_add_u32 s76, s66, s77
    s_add_u32 m0, s76, 12288
    s_add_u32 s76, s64, s77
    s_add_u32 s76, s76, 50331648
    buffer_load_dwordx4 v242, s[4:7], s76 offen offset:0 sc1 lds
    buffer_load_dwordx4 v242, s[4:7], s76 offen offset:1024 sc1 lds
    buffer_load_dwordx4 v242, s[4:7], s76 offen offset:2048 sc1 lds
    s_add_u32 s77, s52, 1
    s_and_b32 s77, s77, 3
    s_mul_i32 s77, s77, 3072
    s_add_u32 s76, s66, s77
    s_add_u32 m0, s76, 12288
    s_add_u32 s76, s64, s77
    s_add_u32 s76, s76, 50331648
    buffer_load_dwordx4 v242, s[4:7], s76 offen offset:0 sc1 lds
    buffer_load_dwordx4 v242, s[4:7], s76 offen offset:1024 sc1 lds
    buffer_load_dwordx4 v242, s[4:7], s76 offen offset:2048 sc1 lds
    s_add_u32 s77, s52, 2
    s_and_b32 s77, s77, 3
    s_mul_i32 s77, s77, 3072
    s_add_u32 s76, s66, s77
    s_add_u32 m0, s76, 12288
    s_add_u32 s76, s64, s77
    s_add_u32 s76, s76, 50331648
    buffer_load_dwordx4 v242, s[4:7], s76 offen offset:0 sc1 lds
    buffer_load_dwordx4 v242, s[4:7], s76 offen offset:1024 sc1 lds
    buffer_load_dwordx4 v242, s[4:7], s76 offen offset:2048 sc1 lds
    s_add_u32 s77, s52, 3
    s_and_b32 s77, s77, 3
    s_mul_i32 s77, s77, 3072
    s_add_u32 s76, s66, s77
    s_add_u32 m0, s76, 12288
    s_add_u32 s76, s64, s77
    s_add_u32 s76, s76, 50331648
    buffer_load_dwordx4 v242, s[4:7], s76 offen offset:0 sc1 lds
    buffer_load_dwordx4 v242, s[4:7], s76 offen offset:1024 sc1 lds
    buffer_load_dwordx4 v242, s[4:7], s76 offen offset:2048 sc1 lds
    s_mov_b32 s78, 1
    s_lshl_b32 s69, s51, 6
    s_add_u32 s69, s69, s78
    s_mul_i32 s64, s69, 12288
    s_add_u32 s65, s64, 50331648
    s_mul_i32 s69, s78, 86
    s_lshr_b32 s69, s69, 8
    s_mul_i32 s69, s69, 3
    s_sub_u32 s69, s78, s69
    s_mul_i32 s66, s69, 27648
    s_add_u32 s66, s66, 38912
    s_add_u32 s77, s52, 0
    s_and_b32 s77, s77, 3
    s_mul_i32 s77, s77, 3072
    s_add_u32 s76, s66, s77
    s_add_u32 m0, s76, 12288
    s_add_u32 s76, s64, s77
    s_add_u32 s76, s76, 50331648
    buffer_load_dwordx4 v242, s[4:7], s76 offen offset:0 sc1 lds
    buffer_load_dwordx4 v242, s[4:7], s76 offen offset:1024 sc1 lds
    buffer_load_dwordx4 v242, s[4:7], s76 offen offset:2048 sc1 lds
    s_add_u32 s77, s52, 1
    s_and_b32 s77, s77, 3
    s_mul_i32 s77, s77, 3072
    s_add_u32 s76, s66, s77
    s_add_u32 m0, s76, 12288
    s_add_u32 s76, s64, s77
    s_add_u32 s76, s76, 50331648
    buffer_load_dwordx4 v242, s[4:7], s76 offen offset:0 sc1 lds
    buffer_load_dwordx4 v242, s[4:7], s76 offen offset:1024 sc1 lds
    buffer_load_dwordx4 v242, s[4:7], s76 offen offset:2048 sc1 lds
    s_add_u32 s77, s52, 2
    s_and_b32 s77, s77, 3
    s_mul_i32 s77, s77, 3072
    s_add_u32 s76, s66, s77
    s_add_u32 m0, s76, 12288
    s_add_u32 s76, s64, s77
    s_add_u32 s76, s76, 50331648
    buffer_load_dwordx4 v242, s[4:7], s76 offen offset:0 sc1 lds
    buffer_load_dwordx4 v242, s[4:7], s76 offen offset:1024 sc1 lds
    buffer_load_dwordx4 v242, s[4:7], s76 offen offset:2048 sc1 lds
    s_add_u32 s77, s52, 3
    s_and_b32 s77, s77, 3
    s_mul_i32 s77, s77, 3072
    s_add_u32 s76, s66, s77
    s_add_u32 m0, s76, 12288
    s_add_u32 s76, s64, s77
    s_add_u32 s76, s76, 50331648
    buffer_load_dwordx4 v242, s[4:7], s76 offen offset:0 sc1 lds
    buffer_load_dwordx4 v242, s[4:7], s76 offen offset:1024 sc1 lds
    buffer_load_dwordx4 v242, s[4:7], s76 offen offset:2048 sc1 lds
    s_mov_b32 s78, 2
    s_lshl_b32 s69, s51, 6
    s_add_u32 s69, s69, s78
    s_mul_i32 s64, s69, 12288
    s_add_u32 s65, s64, 50331648
    s_mul_i32 s69, s78, 86
    s_lshr_b32 s69, s69, 8
    s_mul_i32 s69, s69, 3
    s_sub_u32 s69, s78, s69
    s_mul_i32 s66, s69, 27648
    s_add_u32 s66, s66, 38912
    s_add_u32 s77, s52, 0
    s_and_b32 s77, s77, 3
    s_mul_i32 s77, s77, 3072
    s_add_u32 s76, s66, s77
    s_add_u32 m0, s76, 12288
    s_add_u32 s76, s64, s77
    s_add_u32 s76, s76, 50331648
    buffer_load_dwordx4 v242, s[4:7], s76 offen offset:0 sc1 lds
    buffer_load_dwordx4 v242, s[4:7], s76 offen offset:1024 sc1 lds
    buffer_load_dwordx4 v242, s[4:7], s76 offen offset:2048 sc1 lds
    s_waitcnt vmcnt(15)
    s_barrier
    s_lshr_b32 s96, s49, 1
    s_mul_i32 s96, s96, 10240
    s_add_u32 s96, s96, 106954752
    s_barrier
    buffer_load_dwordx4 v[224:227], v241, s[4:7], s96 offen sc1
    buffer_load_dwordx4 v[228:231], v241, s[4:7], s96 offen offset:1024 sc1
    s_waitcnt vmcnt(0)
    ds_write_b128 v241, v[224:227] offset:0
    ds_write_b128 v241, v[228:231] offset:1024
    v_max3_u32 v4, v224, v225, v226
    v_max3_u32 v5, v227, v228, v229
    v_max3_u32 v4, v4, v230, v231
    v_max_u32 v4, v4, v5
    v_cmp_eq_u32 vcc, -1, v4
    s_cbranch_vccnz Lp_50
    s_waitcnt lgkmcnt(0)
    s_barrier
Lpok_51:
Lv_48:
    ds_read_b128 v[168:171], v242 offset:0
    ds_read_b128 v[172:175], v242 offset:1024
    ds_read_b128 v[176:179], v242 offset:2048
    ds_read_b128 v[180:183], v242 offset:3072
    ds_read_b128 v[184:187], v242 offset:4096
    ds_read_b128 v[188:191], v242 offset:5120
    ds_read_b128 v[192:195], v242 offset:6144
    ds_read_b128 v[196:199], v242 offset:7168
    ds_read_b128 v[200:203], v242 offset:8192
    ds_read_b128 v[204:207], v242 offset:9216
    s_waitcnt lgkmcnt(9)
    v_smfmac_f32_16x16x64_bf16 v[216:219], v[168:171], v[8:15], v239
    v_smfmac_f32_16x16x64_bf16 v[220:223], v[168:171], v[88:95], v239
    s_waitcnt lgkmcnt(8)
    v_smfmac_f32_16x16x64_bf16 v[216:219], v[172:175], v[16:23], v239
    v_smfmac_f32_16x16x64_bf16 v[220:223], v[172:175], v[96:103], v239
    s_waitcnt lgkmcnt(7)
    v_smfmac_f32_16x16x64_bf16 v[216:219], v[176:179], v[24:31], v239
    v_smfmac_f32_16x16x64_bf16 v[220:223], v[176:179], v[104:111], v239
    s_waitcnt lgkmcnt(6)
    v_smfmac_f32_16x16x64_bf16 v[216:219], v[180:183], v[32:39], v239
    v_smfmac_f32_16x16x64_bf16 v[220:223], v[180:183], v[112:119], v239
    s_waitcnt lgkmcnt(5)
    v_smfmac_f32_16x16x64_bf16 v[216:219], v[184:187], v[40:47], v239
    v_smfmac_f32_16x16x64_bf16 v[220:223], v[184:187], v[120:127], v239
    s_waitcnt lgkmcnt(4)
    v_smfmac_f32_16x16x64_bf16 v[216:219], v[188:191], v[48:55], v239
    v_smfmac_f32_16x16x64_bf16 v[220:223], v[188:191], v[128:135], v239
    s_barrier
    s_waitcnt lgkmcnt(3)
    v_smfmac_f32_16x16x64_bf16 v[216:219], v[192:195], v[56:63], v239
    v_smfmac_f32_16x16x64_bf16 v[220:223], v[192:195], v[136:143], v239
    s_waitcnt lgkmcnt(2)
    v_smfmac_f32_16x16x64_bf16 v[216:219], v[196:199], v[64:71], v239
    v_smfmac_f32_16x16x64_bf16 v[220:223], v[196:199], v[144:151], v239
    s_waitcnt lgkmcnt(1)
    v_smfmac_f32_16x16x64_bf16 v[216:219], v[200:203], v[72:79], v239
    v_smfmac_f32_16x16x64_bf16 v[220:223], v[200:203], v[152:159], v239
    s_waitcnt lgkmcnt(0)
    v_smfmac_f32_16x16x64_bf16 v[216:219], v[204:207], v[80:87], v239
    v_smfmac_f32_16x16x64_bf16 v[220:223], v[204:207], v[160:167], v239
    s_nop 7
    v_pk_add_f32 v[216:217], v[216:217], v[218:219]
    v_pk_add_f32 v[220:221], v[220:221], v[222:223]
    v_cvt_pk_bf16_f32 v216, v216, v217
    v_cvt_pk_bf16_f32 v220, v220, v221
    v_min_u32 v216, -2, v216
    v_min_u32 v220, -2, v220
    s_cmp_lg_u32 s53, 0
    s_cbranch_scc1 Lslow_52
    buffer_store_dword v216, v240, s[4:7], s58 offen
    buffer_store_dword v220, v240, s[4:7], s58 offen offset:16
Lback_53:
    s_waitcnt vmcnt(2)
    ds_read_b128 v[168:171], v242 offset:22528
    ds_read_b128 v[172:175], v242 offset:23552
    ds_read_b128 v[176:179], v242 offset:24576
    ds_read_b128 v[180:183], v242 offset:25600
    ds_read_b128 v[184:187], v242 offset:26624
    ds_read_b128 v[188:191], v242 offset:27648
    ds_read_b128 v[192:195], v242 offset:28672
    ds_read_b128 v[196:199], v242 offset:29696
    ds_read_b128 v[200:203], v242 offset:30720
    ds_read_b128 v[204:207], v242 offset:31744
    ds_read_b128 v[208:211], v242 offset:32768
    ds_read_b128 v[212:215], v242 offset:33792
    v_mov_b32 v216, 0
    v_mov_b32 v217, 0
    v_mov_b32 v218, 0
    v_mov_b32 v219, 0
    v_mov_b32 v220, 0
    v_mov_b32 v221, 0
    v_mov_b32 v222, 0
    v_mov_b32 v223, 0
    s_barrier
    s_cmp_lg_u32 s53, 0
    s_cbranch_scc1 Lslow_54
    buffer_store_dword v243, v240, s[4:7], s59 offen
    buffer_store_dword v243, v240, s[4:7], s59 offen offset:16
Lback_55:
    s_sleep 2
    s_add_u32 s78, s55, 2
    s_cmp_ge_u32 s78, 64
    s_cbranch_scc1 Lsg_57
    s_lshl_b32 s69, s51, 6
    s_add_u32 s69, s69, s78
    s_mul_i32 s64, s69, 12288
    s_add_u32 s65, s64, 50331648
    s_mul_i32 s69, s78, 86
    s_lshr_b32 s69, s69, 8
    s_mul_i32 s69, s69, 3
    s_sub_u32 s69, s78, s69
    s_mul_i32 s66, s69, 27648
    s_add_u32 s66, s66, 38912
    s_add_u32 s77, s52, 1
    s_and_b32 s77, s77, 3
    s_mul_i32 s77, s77, 3072
    s_add_u32 s76, s66, s77
    s_add_u32 m0, s76, 12288
    s_add_u32 s76, s64, s77
    s_add_u32 s76, s76, 50331648
    buffer_load_dwordx4 v242, s[4:7], s76 offen offset:0 sc1 lds
    buffer_load_dwordx4 v242, s[4:7], s76 offen offset:1024 sc1 lds
    buffer_load_dwordx4 v242, s[4:7], s76 offen offset:2048 sc1 lds
    s_add_u32 s77, s52, 2
    s_and_b32 s77, s77, 3
    s_mul_i32 s77, s77, 3072
    s_add_u32 s76, s66, s77
    s_add_u32 m0, s76, 12288
    s_add_u32 s76, s64, s77
    s_add_u32 s76, s76, 50331648
    buffer_load_dwordx4 v242, s[4:7], s76 offen offset:0 sc1 lds
    buffer_load_dwordx4 v242, s[4:7], s76 offen offset:1024 sc1 lds
    buffer_load_dwordx4 v242, s[4:7], s76 offen offset:2048 sc1 lds
    s_add_u32 s77, s52, 3
    s_and_b32 s77, s77, 3
    s_mul_i32 s77, s77, 3072
    s_add_u32 s76, s66, s77
    s_add_u32 m0, s76, 12288
    s_add_u32 s76, s64, s77
    s_add_u32 s76, s76, 50331648
    buffer_load_dwordx4 v242, s[4:7], s76 offen offset:0 sc1 lds
    buffer_load_dwordx4 v242, s[4:7], s76 offen offset:1024 sc1 lds
    buffer_load_dwordx4 v242, s[4:7], s76 offen offset:2048 sc1 lds
Lsg_57:
    s_add_u32 s78, s55, 3
    s_cmp_ge_u32 s78, 64
    s_cbranch_scc1 Lsg_56
    s_and_b32 s69, s78, 7
    s_cbranch_scc1 Lwts_60
    s_lshr_b32 s69, s78, 3
    s_mul_i32 s69, s69, 48
    s_lshl_b32 s76, s49, 9
    s_add_u32 s69, s69, s76
    s_and_b32 s76, s51, 3
    s_lshl_b32 s76, s76, 2
    s_add_u32 s69, s69, s76
    s_add_u32 s69, s69, 152043552
    v_lshlrev_b32 v5, 4, v1
    s_mov_b64 exec, 1
Lwt_58:
    buffer_load_dword v4, v5, s[4:7], s69 offen sc1
    s_waitcnt vmcnt(0)
    v_cmp_eq_u32 vcc, 0, v4
    s_cbranch_vccz Lwtok_59
    s_sleep 2
    s_sub_u32 s54, s54, 1
    s_cbranch_scc0 Lwt_58
    s_mov_b32 s54, 0
Lwtok_59:
    s_mov_b64 exec, -1
Lwts_60:
    s_lshl_b32 s69, s51, 6
    s_add_u32 s69, s69, s78
    s_mul_i32 s64, s69, 12288
    s_add_u32 s65, s64, 50331648
    s_mul_i32 s69, s78, 86
    s_lshr_b32 s69, s69, 8
    s_mul_i32 s69, s69, 3
    s_sub_u32 s69, s78, s69
    s_mul_i32 s66, s69, 27648
    s_add_u32 s66, s66, 38912
    s_add_u32 s77, s52, 0
    s_and_b32 s77, s77, 3
    s_mul_i32 s77, s77, 3072
    s_add_u32 s76, s66, s77
    s_add_u32 m0, s76, 12288
    s_add_u32 s76, s64, s77
    s_add_u32 s76, s76, 50331648
    buffer_load_dwordx4 v242, s[4:7], s76 offen offset:0 sc1 lds
    buffer_load_dwordx4 v242, s[4:7], s76 offen offset:1024 sc1 lds
    buffer_load_dwordx4 v242, s[4:7], s76 offen offset:2048 sc1 lds
Lsg_56:
    s_waitcnt lgkmcnt(0)
    s_cmp_eq_u32 s55, 0
    s_cbranch_scc1 Lvn0_61
    s_sub_u32 s69, s63, 393216
    s_add_u32 s76, s69, 4096
    ds_read_b128 v[224:227], v242 offset:35840
    ds_read_b128 v[228:231], v242 offset:36864
    ds_read_b128 v[232:235], v242 offset:37888
    s_waitcnt lgkmcnt(2)
    buffer_store_dwordx4 v[224:227], v245, s[4:7], s69 offen offset:0 sc1
    s_waitcnt lgkmcnt(1)
    buffer_store_dwordx4 v[228:231], v245, s[4:7], s69 offen offset:2048 sc1
    s_waitcnt lgkmcnt(0)
    buffer_store_dwordx4 v[232:235], v245, s[4:7], s76 offen offset:0 sc1
Lvn0_61:
    s_cmp_lt_u32 s55, 58
    s_cbranch_scc1 Lvnq_62
    s_waitcnt vmcnt(0)
    s_lshl_b32 s69, s49, 4
    s_add_u32 s69, s69, s50
    s_lshl_b32 s69, s69, 7
    s_add_u32 s69, s69, 152174592
    s_add_u32 s76, s55, 0
    v_mov_b32 v4, s76
    v_mov_b32 v5, 0
    s_mov_b64 exec, 1
    buffer_store_dword v4, v5, s[4:7], s69 offen sc1
    s_mov_b64 exec, -1
Lvnq_62:
    s_waitcnt lgkmcnt(0)
    s_barrier
    ds_read_b128 v[224:227], v238 offset:10240
    ds_read_b128 v[228:231], v238 offset:11264
    ds_read_b128 v[232:235], v238 offset:12288
    v_lshlrev_b32 v4, 3, v3
    ds_read_b64 v[236:237], v4 offset:34816
    s_cmp_eq_u32 s55, 63
    s_cbranch_scc1 Lvend_49
    s_waitcnt lgkmcnt(3)
    v_smfmac_f32_16x16x64_bf16 v[216:219], v[224:227], v[168:175], v239
    v_smfmac_f32_16x16x64_bf16 v[220:223], v[224:227], v[192:199], v239
    s_waitcnt lgkmcnt(2)
    v_smfmac_f32_16x16x64_bf16 v[216:219], v[228:231], v[176:183], v239
    v_smfmac_f32_16x16x64_bf16 v[220:223], v[228:231], v[200:207], v239
    s_waitcnt lgkmcnt(1)
    v_smfmac_f32_16x16x64_bf16 v[216:219], v[232:235], v[184:191], v239
    v_smfmac_f32_16x16x64_bf16 v[220:223], v[232:235], v[208:215], v239
    s_waitcnt lgkmcnt(0)
    s_nop 5
    v_pk_add_f32 v[216:217], v[216:217], v[218:219]
    v_pk_add_f32 v[222:223], v[220:221], v[222:223]
    v_pk_mul_f32 v[216:217], v[216:217], v[236:237]
    v_pk_mul_f32 v[222:223], v[222:223], v[236:237]
    v_add_u32 v216, s94, v216
    v_add_u32 v217, s94, v217
    v_and_or_b32 v216, v216, v0, s95
    v_and_or_b32 v217, v217, v0, s95
    v_cvt_pk_bf16_f32 v216, v216, v222
    v_cvt_pk_bf16_f32 v220, v217, v223
    buffer_store_dword v216, v244, s[4:7], s60 offen offset:0 sc1
    buffer_store_dword v220, v244, s[4:7], s60 offen offset:128 sc1
    v_mov_b32 v216, 0
    v_mov_b32 v217, 0
    v_mov_b32 v218, 0
    v_mov_b32 v219, 0
    v_mov_b32 v220, 0
    v_mov_b32 v221, 0
    v_mov_b32 v222, 0
    v_mov_b32 v223, 0
    s_mov_b32 s96, s56
    s_add_u32 s55, s55, 1
    s_add_u32 s97, s97, 1
    s_and_b32 s69, s97, 255
    s_xor_b32 s76, s97, 265
    s_cmp_eq_u32 s69, 9
    s_cselect_b32 s97, s76, s97
    s_and_b32 s69, s55, 3
    s_add_u32 s76, s55, 1
    s_and_b32 s76, s76, 3
    s_xor_b32 s77, s69, 2
    s_lshr_b32 s78, s49, 1
    s_mul_i32 s78, s78, 10240
    s_add_u32 s78, s78, 106954752
    s_mul_i32 s56, s76, 81920
    s_add_u32 s56, s56, s78
    s_mul_i32 s57, s77, 81920
    s_add_u32 s57, s57, s78
    s_mul_i32 s78, s51, 9216
    s_add_u32 s78, s78, 107282432
    s_mul_i32 s58, s69, 294912
    s_add_u32 s58, s58, s78
    s_mul_i32 s59, s77, 294912
    s_add_u32 s59, s59, s78
    s_and_b32 s69, s97, 255
    s_mul_i32 s76, s69, 86
    s_lshr_b32 s76, s76, 8
    s_mul_i32 s62, s69, 655360
    s_mul_i32 s77, s76, 131072
    s_add_u32 s62, s62, s77
    s_add_u32 s62, s62, 167772160
    s_xor_b32 s76, s79, s76
    s_and_b32 s76, s76, 1
    s_lshl_b32 s76, s76, 13
    s_add_u32 s62, s62, s76
    s_lshl_b32 s78, s51, 8
    s_add_u32 s60, s62, s78
    s_lshl_b32 s95, s97, 8
    s_and_b32 s95, s95, 0x10000
    s_xor_b32 s94, s95, 0x10000
    s_mul_i32 s63, s55, 393216
    s_add_u32 s63, s63, 75497472
    s_barrier
    buffer_load_dwordx4 v[224:227], v241, s[4:7], s96 offen sc1
    buffer_load_dwordx4 v[228:231], v241, s[4:7], s96 offen offset:1024 sc1
    s_sleep 1
    buffer_load_dwordx4 v[246:249], v241, s[4:7], s96 offen sc1
    buffer_load_dwordx4 v[250:253], v241, s[4:7], s96 offen offset:1024 sc1
    s_waitcnt vmcnt(2)
    ds_write_b128 v241, v[224:227] offset:0
    ds_write_b128 v241, v[228:231] offset:1024
    v_max3_u32 v4, v224, v225, v226
    v_max3_u32 v5, v227, v228, v229
    v_max3_u32 v4, v4, v230, v231
    v_max_u32 v4, v4, v5
    v_cmp_eq_u32 vcc, -1, v4
    s_cbranch_vccnz Lp_63
    s_waitcnt lgkmcnt(0)
    s_barrier
Lpok_64:
    s_branch Lv_48
Lvend_49:
    s_waitcnt lgkmcnt(0)
    s_barrier
    s_sub_u32 s69, s63, 0
    s_add_u32 s76, s69, 4096
    ds_read_b128 v[224:227], v242 offset:35840
    ds_read_b128 v[228:231], v242 offset:36864
    ds_read_b128 v[232:235], v242 offset:37888
    s_waitcnt lgkmcnt(2)
    buffer_store_dwordx4 v[224:227], v245, s[4:7], s69 offen offset:0 sc1
    s_waitcnt lgkmcnt(1)
    buffer_store_dwordx4 v[228:231], v245, s[4:7], s69 offen offset:2048 sc1
    s_waitcnt lgkmcnt(0)
    buffer_store_dwordx4 v[232:235], v245, s[4:7], s76 offen offset:0 sc1
    s_waitcnt vmcnt(0)
    s_lshl_b32 s69, s49, 4
    s_add_u32 s69, s69, s50
    s_lshl_b32 s69, s69, 7
    s_add_u32 s69, s69, 152174592
    s_add_u32 s76, s55, 1
    v_mov_b32 v4, s76
    v_mov_b32 v5, 0
    s_mov_b64 exec, 1
    buffer_store_dword v4, v5, s[4:7], s69 offen sc1
    s_mov_b64 exec, -1
    s_endpgm
Lslow_52:
    buffer_store_dword v216, v240, s[4:7], s58 offen sc1
    buffer_store_dword v220, v240, s[4:7], s58 offen offset:16 sc1
    s_branch Lback_53
Lslow_54:
    buffer_store_dword v243, v240, s[4:7], s59 offen sc1
    buffer_store_dword v243, v240, s[4:7], s59 offen offset:16 sc1
    s_branch Lback_55
Lp_50:
    s_mov_b64 exec, vcc
    buffer_load_dwordx4 v[224:227], v241, s[4:7], s96 offen sc1
    buffer_load_dwordx4 v[228:231], v241, s[4:7], s96 offen offset:1024 sc1
    s_waitcnt vmcnt(0)
    ds_write_b128 v241, v[224:227] offset:0
    ds_write_b128 v241, v[228:231] offset:1024
    v_max3_u32 v4, v224, v225, v226
    v_max3_u32 v5, v227, v228, v229
    v_max3_u32 v4, v4, v230, v231
    v_max_u32 v4, v4, v5
    v_cmp_eq_u32 vcc, -1, v4
    s_cbranch_vccnz Lpn_65
    s_mov_b64 exec, -1
    s_waitcnt lgkmcnt(0)
    s_barrier
    s_branch Lpok_51
Lpn_65:
    s_sub_u32 s54, s54, 1
    s_cbranch_scc0 Lp_50
    s_mov_b32 s54, 0
    s_mov_b64 exec, -1
    s_waitcnt lgkmcnt(0)
    s_barrier
    s_branch Lpok_51
Lp_63:
    s_mov_b64 exec, vcc
    buffer_load_dwordx4 v[224:227], v241, s[4:7], s96 offen sc1
    buffer_load_dwordx4 v[228:231], v241, s[4:7], s96 offen offset:1024 sc1
    s_waitcnt vmcnt(2)
    ds_write_b128 v241, v[246:249] offset:0
    ds_write_b128 v241, v[250:253] offset:1024
    v_max3_u32 v4, v246, v247, v248
    v_max3_u32 v5, v249, v250, v251
    v_max3_u32 v4, v4, v252, v253
    v_max_u32 v4, v4, v5
    v_cmp_eq_u32 vcc, -1, v4
    s_cbranch_vccnz Lpn_66
    s_mov_b64 exec, -1
    s_waitcnt lgkmcnt(0)
    s_barrier
    s_branch Lpok_64
Lpn_66:
    s_mov_b64 exec, vcc
    buffer_load_dwordx4 v[246:249], v241, s[4:7], s96 offen sc1
    buffer_load_dwordx4 v[250:253], v241, s[4:7], s96 offen offset:1024 sc1
    s_waitcnt vmcnt(2)
    ds_write_b128 v241, v[224:227] offset:0
    ds_write_b128 v241, v[228:231] offset:1024
    v_max3_u32 v4, v224, v225, v226
    v_max3_u32 v5, v227, v228, v229
    v_max3_u32 v4, v4, v230, v231
    v_max_u32 v4, v4, v5
    v_cmp_eq_u32 vcc, -1, v4
    s_cbranch_vccnz Lpn_67
    s_mov_b64 exec, -1
    s_waitcnt lgkmcnt(0)
    s_barrier
    s_branch Lpok_64
Lpn_67:
    s_sub_u32 s54, s54, 1
    s_cbranch_scc0 Lp_63
    s_mov_b32 s54, 0
    s_mov_b64 exec, -1
    s_waitcnt lgkmcnt(0)
    s_barrier
    s_branch Lpok_64
Lrole_w7_13:
    v_and_b32 v1, 63, v0
    v_and_b32 v2, 15, v0
    v_bfe_u32 v3, v0, 4, 2
    v_mov_b32 v0, 0xfffe0000
    v_lshlrev_b32 v194, 8, v3
    v_bfe_u32 v4, v2, 1, 1
    v_lshl_add_u32 v194, v4, 7, v194
    v_lshrrev_b32 v4, 2, v2
    v_lshl_add_u32 v194, v4, 5, v194
    v_and_b32 v4, 1, v2
    v_lshl_add_u32 v194, v4, 4, v194
    v_and_b32 v4, 2, v2
    v_cmp_eq_u32 vcc, 2, v4
    v_mov_b32 v195, 0x44444444
    v_mov_b32 v4, 0xeeeeeeee
    s_nop 1
    v_cndmask_b32 v195, v195, v4, vcc
    v_lshlrev_b32 v198, 4, v1
    v_and_b32 v4, 7, v1
    v_lshlrev_b32 v199, 4, v4
    v_lshrrev_b32 v4, 5, v1
    v_lshl_add_u32 v199, v4, 10, v199
    v_bfe_u32 v4, v1, 3, 2
    v_lshl_add_u32 v199, v4, 8, v199
    s_lshr_b32 s69, s52, 1
    s_mul_i32 s69, s69, 6144
    s_and_b32 s76, s52, 1
    s_lshl_b32 s76, s76, 7
    s_add_u32 s69, s69, s76
    v_add_u32 v199, s69, v199
    v_mov_b32 v188, -1
    v_mov_b32 v189, -1
    v_mov_b32 v190, -1
    v_mov_b32 v191, -1
    s_mul_i32 s69, s52, 768
    s_add_u32 s69, s69, 6656
    v_lshlrev_b32 v196, 4, v2
    v_lshl_add_u32 v196, v3, 2, v196
    v_add_u32 v196, s69, v196
    s_mul_i32 s69, s52, 2560
    v_lshlrev_b32 v201, 4, v1
    v_add_u32 v201, s69, v201
    v_lshrrev_b32 v200, 3, v2
    v_lshlrev_b32 v200, 14, v200
    v_bfe_u32 v4, v2, 2, 1
    v_lshl_add_u32 v200, v4, 6, v200
    v_lshl_add_u32 v200, v3, 4, v200
    v_and_b32 v4, 3, v2
    v_lshl_add_u32 v200, v4, 2, v200
    s_mul_i32 s69, s52, 163840
    s_add_u32 s69, s69, 98304
    v_add_u32 v200, s69, v200
    s_mov_b32 s12, s24
    s_mov_b32 s13, s25
    s_mov_b32 s14, 7864320
    s_mov_b32 s15, 0x20000
    s_mul_i32 s69, s51, 384
    s_mul_i32 s76, s52, 96
    s_add_u32 s69, s69, s76
    s_add_u32 s69, s69, 32
    v_and_b32 v4, 14, v2
    v_lshlrev_b32 v6, 1, v4
    v_add_u32 v6, 32, v6
    v_and_b32 v4, 1, v2
    v_cmp_eq_u32 vcc, 1, v4
    v_mov_b32 v184, s80
    v_mov_b32 v4, s81
    s_nop 1
    v_cndmask_b32 v184, v184, v4, vcc
    s_setprio 3
    s_min_u32 s66, s48, 4
    s_mul_i32 s66, s66, 20480
    s_add_u32 s66, s66, 38912
    v_lshrrev_b32 v144, 2, v1
    s_mov_b32 s76, 12288
    v_mul_lo_u32 v144, v144, s76
    v_and_b32 v145, 3, v1
    v_lshl_add_u32 v144, v145, 4, v144
    v_lshrrev_b32 v145, 1, v3
    v_lshlrev_b32 v145, 10, v145
    v_and_b32 v146, 1, v3
    v_lshl_add_u32 v145, v146, 8, v145
    v_add_u32 v145, v145, v6
    v_add_u32 v145, s66, v145
    s_add_u32 m0, s66, 0
    s_add_u32 s76, s69, 0
    buffer_load_dwordx4 v144, s[12:15], s76 offen lds
    s_add_u32 m0, s66, 1024
    s_add_u32 s76, s69, 196608
    buffer_load_dwordx4 v144, s[12:15], s76 offen lds
    s_add_u32 m0, s66, 2048
    s_add_u32 s76, s69, 393216
    buffer_load_dwordx4 v144, s[12:15], s76 offen lds
    s_add_u32 m0, s66, 3072
    s_add_u32 s76, s69, 589824
    buffer_load_dwordx4 v144, s[12:15], s76 offen lds
    s_add_u32 m0, s66, 4096
    s_add_u32 s76, s69, 786432
    buffer_load_dwordx4 v144, s[12:15], s76 offen lds
    s_add_u32 m0, s66, 5120
    s_add_u32 s76, s69, 983040
    buffer_load_dwordx4 v144, s[12:15], s76 offen lds
    s_add_u32 m0, s66, 6144
    s_add_u32 s76, s69, 1179648
    buffer_load_dwordx4 v144, s[12:15], s76 offen lds
    s_add_u32 m0, s66, 7168
    s_add_u32 s76, s69, 1376256
    buffer_load_dwordx4 v144, s[12:15], s76 offen lds
    s_add_u32 m0, s66, 8192
    s_add_u32 s76, s69, 1572864
    buffer_load_dwordx4 v144, s[12:15], s76 offen lds
    s_add_u32 m0, s66, 9216
    s_add_u32 s76, s69, 1769472
    buffer_load_dwordx4 v144, s[12:15], s76 offen lds
    s_add_u32 m0, s66, 10240
    s_add_u32 s76, s69, 1966080
    buffer_load_dwordx4 v144, s[12:15], s76 offen lds
    s_add_u32 m0, s66, 11264
    s_add_u32 s76, s69, 2162688
    buffer_load_dwordx4 v144, s[12:15], s76 offen lds
    s_add_u32 m0, s66, 12288
    s_add_u32 s76, s69, 2359296
    buffer_load_dwordx4 v144, s[12:15], s76 offen lds
    s_add_u32 m0, s66, 13312
    s_add_u32 s76, s69, 2555904
    buffer_load_dwordx4 v144, s[12:15], s76 offen lds
    s_add_u32 m0, s66, 14336
    s_add_u32 s76, s69, 2752512
    buffer_load_dwordx4 v144, s[12:15], s76 offen lds
    s_add_u32 m0, s66, 15360
    s_add_u32 s76, s69, 2949120
    buffer_load_dwordx4 v144, s[12:15], s76 offen lds
    s_add_u32 m0, s66, 16384
    s_add_u32 s76, s69, 3145728
    buffer_load_dwordx4 v144, s[12:15], s76 offen lds
    s_add_u32 m0, s66, 17408
    s_add_u32 s76, s69, 3342336
    buffer_load_dwordx4 v144, s[12:15], s76 offen lds
    s_add_u32 m0, s66, 18432
    s_add_u32 s76, s69, 3538944
    buffer_load_dwordx4 v144, s[12:15], s76 offen lds
    s_add_u32 m0, s66, 19456
    s_add_u32 s76, s69, 3735552
    buffer_load_dwordx4 v144, s[12:15], s76 offen lds
    s_waitcnt vmcnt(16)
    v_add_u32 v146, 0, v145
    v_add_u32 v147, 2048, v145
    ds_read2_b32 v[148:149], v146 offset0:0 offset1:16
    ds_read2_b32 v[150:151], v146 offset0:128 offset1:144
    ds_read2_b32 v[152:153], v146 offset0:32 offset1:48
    ds_read2_b32 v[154:155], v146 offset0:160 offset1:176
    ds_read2_b32 v[156:157], v147 offset0:0 offset1:16
    ds_read2_b32 v[158:159], v147 offset0:128 offset1:144
    ds_read2_b32 v[160:161], v147 offset0:32 offset1:48
    ds_read2_b32 v[162:163], v147 offset0:160 offset1:176
    s_waitcnt lgkmcnt(0)
    s_add_u32 m0, s66, 0
    s_add_u32 s76, s69, 3932160
    buffer_load_dwordx4 v144, s[12:15], s76 offen lds
    s_add_u32 m0, s66, 1024
    s_add_u32 s76, s69, 4128768
    buffer_load_dwordx4 v144, s[12:15], s76 offen lds
    s_add_u32 m0, s66, 2048
    s_add_u32 s76, s69, 4325376
    buffer_load_dwordx4 v144, s[12:15], s76 offen lds
    s_add_u32 m0, s66, 3072
    s_add_u32 s76, s69, 4521984
    buffer_load_dwordx4 v144, s[12:15], s76 offen lds
    v_perm_b32 v8, v149, v148, v184
    v_perm_b32 v9, v151, v150, v184
    v_perm_b32 v10, v153, v152, v184
    v_perm_b32 v11, v155, v154, v184
    v_perm_b32 v12, v157, v156, v184
    v_perm_b32 v13, v159, v158, v184
    v_perm_b32 v14, v161, v160, v184
    v_perm_b32 v15, v163, v162, v184
    s_waitcnt vmcnt(16)
    v_add_u32 v146, 4096, v145
    v_add_u32 v147, 6144, v145
    ds_read2_b32 v[148:149], v146 offset0:0 offset1:16
    ds_read2_b32 v[150:151], v146 offset0:128 offset1:144
    ds_read2_b32 v[152:153], v146 offset0:32 offset1:48
    ds_read2_b32 v[154:155], v146 offset0:160 offset1:176
    ds_read2_b32 v[156:157], v147 offset0:0 offset1:16
    ds_read2_b32 v[158:159], v147 offset0:128 offset1:144
    ds_read2_b32 v[160:161], v147 offset0:32 offset1:48
    ds_read2_b32 v[162:163], v147 offset0:160 offset1:176
    s_waitcnt lgkmcnt(0)
    s_add_u32 m0, s66, 4096
    s_add_u32 s76, s69, 4718592
    buffer_load_dwordx4 v144, s[12:15], s76 offen lds
    s_add_u32 m0, s66, 5120
    s_add_u32 s76, s69, 4915200
    buffer_load_dwordx4 v144, s[12:15], s76 offen lds
    s_add_u32 m0, s66, 6144
    s_add_u32 s76, s69, 5111808
    buffer_load_dwordx4 v144, s[12:15], s76 offen lds
    s_add_u32 m0, s66, 7168
    s_add_u32 s76, s69, 5308416
    buffer_load_dwordx4 v144, s[12:15], s76 offen lds
    v_perm_b32 v16, v149, v148, v184
    v_perm_b32 v17, v151, v150, v184
    v_perm_b32 v18, v153, v152, v184
    v_perm_b32 v19, v155, v154, v184
    v_perm_b32 v20, v157, v156, v184
    v_perm_b32 v21, v159, v158, v184
    v_perm_b32 v22, v161, v160, v184
    v_perm_b32 v23, v163, v162, v184
    s_waitcnt vmcnt(16)
    v_add_u32 v146, 8192, v145
    v_add_u32 v147, 10240, v145
    ds_read2_b32 v[148:149], v146 offset0:0 offset1:16
    ds_read2_b32 v[150:151], v146 offset0:128 offset1:144
    ds_read2_b32 v[152:153], v146 offset0:32 offset1:48
    ds_read2_b32 v[154:155], v146 offset0:160 offset1:176
    ds_read2_b32 v[156:157], v147 offset0:0 offset1:16
    ds_read2_b32 v[158:159], v147 offset0:128 offset1:144
    ds_read2_b32 v[160:161], v147 offset0:32 offset1:48
    ds_read2_b32 v[162:163], v147 offset0:160 offset1:176
    s_waitcnt lgkmcnt(0)
    s_add_u32 m0, s66, 8192
    s_add_u32 s76, s69, 5505024
    buffer_load_dwordx4 v144, s[12:15], s76 offen lds
    s_add_u32 m0, s66, 9216
    s_add_u32 s76, s69, 5701632
    buffer_load_dwordx4 v144, s[12:15], s76 offen lds
    s_add_u32 m0, s66, 10240
    s_add_u32 s76, s69, 5898240
    buffer_load_dwordx4 v144, s[12:15], s76 offen lds
    s_add_u32 m0, s66, 11264
    s_add_u32 s76, s69, 6094848
    buffer_load_dwordx4 v144, s[12:15], s76 offen lds
    v_perm_b32 v24, v149, v148, v184
    v_perm_b32 v25, v151, v150, v184
    v_perm_b32 v26, v153, v152, v184
    v_perm_b32 v27, v155, v154, v184
    v_perm_b32 v28, v157, v156, v184
    v_perm_b32 v29, v159, v158, v184
    v_perm_b32 v30, v161, v160, v184
    v_perm_b32 v31, v163, v162, v184
    s_waitcnt vmcnt(16)
    v_add_u32 v146, 12288, v145
    v_add_u32 v147, 14336, v145
    ds_read2_b32 v[148:149], v146 offset0:0 offset1:16
    ds_read2_b32 v[150:151], v146 offset0:128 offset1:144
    ds_read2_b32 v[152:153], v146 offset0:32 offset1:48
    ds_read2_b32 v[154:155], v146 offset0:160 offset1:176
    ds_read2_b32 v[156:157], v147 offset0:0 offset1:16
    ds_read2_b32 v[158:159], v147 offset0:128 offset1:144
    ds_read2_b32 v[160:161], v147 offset0:32 offset1:48
    ds_read2_b32 v[162:163], v147 offset0:160 offset1:176
    s_waitcnt lgkmcnt(0)
    s_add_u32 m0, s66, 12288
    s_add_u32 s76, s69, 6291456
    buffer_load_dwordx4 v144, s[12:15], s76 offen lds
    s_add_u32 m0, s66, 13312
    s_add_u32 s76, s69, 6488064
    buffer_load_dwordx4 v144, s[12:15], s76 offen lds
    s_add_u32 m0, s66, 14336
    s_add_u32 s76, s69, 6684672
    buffer_load_dwordx4 v144, s[12:15], s76 offen lds
    s_add_u32 m0, s66, 15360
    s_add_u32 s76, s69, 6881280
    buffer_load_dwordx4 v144, s[12:15], s76 offen lds
    v_perm_b32 v32, v149, v148, v184
    v_perm_b32 v33, v151, v150, v184
    v_perm_b32 v34, v153, v152, v184
    v_perm_b32 v35, v155, v154, v184
    v_perm_b32 v36, v157, v156, v184
    v_perm_b32 v37, v159, v158, v184
    v_perm_b32 v38, v161, v160, v184
    v_perm_b32 v39, v163, v162, v184
    s_waitcnt vmcnt(16)
    v_add_u32 v146, 16384, v145
    v_add_u32 v147, 18432, v145
    ds_read2_b32 v[148:149], v146 offset0:0 offset1:16
    ds_read2_b32 v[150:151], v146 offset0:128 offset1:144
    ds_read2_b32 v[152:153], v146 offset0:32 offset1:48
    ds_read2_b32 v[154:155], v146 offset0:160 offset1:176
    ds_read2_b32 v[156:157], v147 offset0:0 offset1:16
    ds_read2_b32 v[158:159], v147 offset0:128 offset1:144
    ds_read2_b32 v[160:161], v147 offset0:32 offset1:48
    ds_read2_b32 v[162:163], v147 offset0:160 offset1:176
    s_waitcnt lgkmcnt(0)
    s_add_u32 m0, s66, 16384
    s_add_u32 s76, s69, 7077888
    buffer_load_dwordx4 v144, s[12:15], s76 offen lds
    s_add_u32 m0, s66, 17408
    s_add_u32 s76, s69, 7274496
    buffer_load_dwordx4 v144, s[12:15], s76 offen lds
    s_add_u32 m0, s66, 18432
    s_add_u32 s76, s69, 7471104
    buffer_load_dwordx4 v144, s[12:15], s76 offen lds
    s_add_u32 m0, s66, 19456
    s_add_u32 s76, s69, 7667712
    buffer_load_dwordx4 v144, s[12:15], s76 offen lds
    v_perm_b32 v40, v149, v148, v184
    v_perm_b32 v41, v151, v150, v184
    v_perm_b32 v42, v153, v152, v184
    v_perm_b32 v43, v155, v154, v184
    v_perm_b32 v44, v157, v156, v184
    v_perm_b32 v45, v159, v158, v184
    v_perm_b32 v46, v161, v160, v184
    v_perm_b32 v47, v163, v162, v184
    s_waitcnt vmcnt(16)
    v_add_u32 v146, 0, v145
    v_add_u32 v147, 2048, v145
    ds_read2_b32 v[148:149], v146 offset0:0 offset1:16
    ds_read2_b32 v[150:151], v146 offset0:128 offset1:144
    ds_read2_b32 v[152:153], v146 offset0:32 offset1:48
    ds_read2_b32 v[154:155], v146 offset0:160 offset1:176
    ds_read2_b32 v[156:157], v147 offset0:0 offset1:16
    ds_read2_b32 v[158:159], v147 offset0:128 offset1:144
    ds_read2_b32 v[160:161], v147 offset0:32 offset1:48
    ds_read2_b32 v[162:163], v147 offset0:160 offset1:176
    s_waitcnt lgkmcnt(0)
    v_perm_b32 v48, v149, v148, v184
    v_perm_b32 v49, v151, v150, v184
    v_perm_b32 v50, v153, v152, v184
    v_perm_b32 v51, v155, v154, v184
    v_perm_b32 v52, v157, v156, v184
    v_perm_b32 v53, v159, v158, v184
    v_perm_b32 v54, v161, v160, v184
    v_perm_b32 v55, v163, v162, v184
    s_waitcnt vmcnt(12)
    v_add_u32 v146, 4096, v145
    v_add_u32 v147, 6144, v145
    ds_read2_b32 v[148:149], v146 offset0:0 offset1:16
    ds_read2_b32 v[150:151], v146 offset0:128 offset1:144
    ds_read2_b32 v[152:153], v146 offset0:32 offset1:48
    ds_read2_b32 v[154:155], v146 offset0:160 offset1:176
    ds_read2_b32 v[156:157], v147 offset0:0 offset1:16
    ds_read2_b32 v[158:159], v147 offset0:128 offset1:144
    ds_read2_b32 v[160:161], v147 offset0:32 offset1:48
    ds_read2_b32 v[162:163], v147 offset0:160 offset1:176
    s_waitcnt lgkmcnt(0)
    v_perm_b32 v56, v149, v148, v184
    v_perm_b32 v57, v151, v150, v184
    v_perm_b32 v58, v153, v152, v184
    v_perm_b32 v59, v155, v154, v184
    v_perm_b32 v60, v157, v156, v184
    v_perm_b32 v61, v159, v158, v184
    v_perm_b32 v62, v161, v160, v184
    v_perm_b32 v63, v163, v162, v184
    s_waitcnt vmcnt(8)
    v_add_u32 v146, 8192, v145
    v_add_u32 v147, 10240, v145
    ds_read2_b32 v[148:149], v146 offset0:0 offset1:16
    ds_read2_b32 v[150:151], v146 offset0:128 offset1:144
    ds_read2_b32 v[152:153], v146 offset0:32 offset1:48
    ds_read2_b32 v[154:155], v146 offset0:160 offset1:176
    ds_read2_b32 v[156:157], v147 offset0:0 offset1:16
    ds_read2_b32 v[158:159], v147 offset0:128 offset1:144
    ds_read2_b32 v[160:161], v147 offset0:32 offset1:48
    ds_read2_b32 v[162:163], v147 offset0:160 offset1:176
    s_waitcnt lgkmcnt(0)
    v_perm_b32 v64, v149, v148, v184
    v_perm_b32 v65, v151, v150, v184
    v_perm_b32 v66, v153, v152, v184
    v_perm_b32 v67, v155, v154, v184
    v_perm_b32 v68, v157, v156, v184
    v_perm_b32 v69, v159, v158, v184
    v_perm_b32 v70, v161, v160, v184
    v_perm_b32 v71, v163, v162, v184
    s_waitcnt vmcnt(4)
    v_add_u32 v146, 12288, v145
    v_add_u32 v147, 14336, v145
    ds_read2_b32 v[148:149], v146 offset0:0 offset1:16
    ds_read2_b32 v[150:151], v146 offset0:128 offset1:144
    ds_read2_b32 v[152:153], v146 offset0:32 offset1:48
    ds_read2_b32 v[154:155], v146 offset0:160 offset1:176
    ds_read2_b32 v[156:157], v147 offset0:0 offset1:16
    ds_read2_b32 v[158:159], v147 offset0:128 offset1:144
    ds_read2_b32 v[160:161], v147 offset0:32 offset1:48
    ds_read2_b32 v[162:163], v147 offset0:160 offset1:176
    s_waitcnt lgkmcnt(0)
    v_perm_b32 v72, v149, v148, v184
    v_perm_b32 v73, v151, v150, v184
    v_perm_b32 v74, v153, v152, v184
    v_perm_b32 v75, v155, v154, v184
    v_perm_b32 v76, v157, v156, v184
    v_perm_b32 v77, v159, v158, v184
    v_perm_b32 v78, v161, v160, v184
    v_perm_b32 v79, v163, v162, v184
    s_waitcnt vmcnt(0)
    v_add_u32 v146, 16384, v145
    v_add_u32 v147, 18432, v145
    ds_read2_b32 v[148:149], v146 offset0:0 offset1:16
    ds_read2_b32 v[150:151], v146 offset0:128 offset1:144
    ds_read2_b32 v[152:153], v146 offset0:32 offset1:48
    ds_read2_b32 v[154:155], v146 offset0:160 offset1:176
    ds_read2_b32 v[156:157], v147 offset0:0 offset1:16
    ds_read2_b32 v[158:159], v147 offset0:128 offset1:144
    ds_read2_b32 v[160:161], v147 offset0:32 offset1:48
    ds_read2_b32 v[162:163], v147 offset0:160 offset1:176
    s_waitcnt lgkmcnt(0)
    v_perm_b32 v80, v149, v148, v184
    v_perm_b32 v81, v151, v150, v184
    v_perm_b32 v82, v153, v152, v184
    v_perm_b32 v83, v155, v154, v184
    v_perm_b32 v84, v157, v156, v184
    v_perm_b32 v85, v159, v158, v184
    v_perm_b32 v86, v161, v160, v184
    v_perm_b32 v87, v163, v162, v184
    s_sub_u32 s69, s48, 3
    s_lshl_b32 s69, s69, 11
    v_lshlrev_b32 v197, 4, v1
    v_add_u32 v197, s69, v197
    v_mov_b32 v184, 0
    v_mov_b32 v185, 0
    v_mov_b32 v186, 0
    v_mov_b32 v187, 0
    v_mov_b32 v136, 0
    v_mov_b32 v137, 0
    v_mov_b32 v138, 0
    v_mov_b32 v139, 0
    v_mov_b32 v140, 0
    v_mov_b32 v141, 0
    v_mov_b32 v142, 0
    v_mov_b32 v143, 0
    s_setprio 2
    s_barrier
    s_cmp_lg_u32 s48, 0
    s_cbranch_scc1 Lp0_68
    v_lshlrev_b32 v5, 2, v1
Lreg_69:
    buffer_load_dword v4, v5, s[8:11], 0 offen sc0 sc1
    s_waitcnt vmcnt(0)
    v_readlane_b32 s69, v4, 8
    v_readlane_b32 s76, v4, 32
    s_add_u32 s69, s69, s76
    s_cmp_ge_u32 s69, 640
    s_cbranch_scc1 Lregd_70
    s_sleep 24
    s_sub_u32 s54, s54, 1
    s_cbranch_scc0 Lreg_69
    s_mov_b32 s54, 0
Lregd_70:
    v_readlane_b32 s79, v4, 34
    v_cmp_ne_u32 vcc, 32, v4
    s_and_b32 s79, s79, 1
    s_and_b32 s69, vcc_lo, 0xf
    s_and_b32 s76, vcc_hi, 0xf00
    s_or_b32 s69, s69, s76
    s_cselect_b32 s53, 1, 0
    s_lshl_b32 s79, s79, 1
    s_or_b32 s79, s79, s53
    v_mov_b32 v4, s79
    v_mov_b32 v5, 34880
    ds_write_b32 v5, v4
    s_waitcnt lgkmcnt(0)
Lp0_68:
    s_barrier
    v_mov_b32 v5, 34880
    ds_read_b32 v4, v5
    s_waitcnt lgkmcnt(0)
    v_readfirstlane_b32 s79, v4
    s_and_b32 s53, s79, 1
    s_lshr_b32 s79, s79, 1
    s_and_b32 s69, s55, 3
    s_add_u32 s76, s55, 1
    s_and_b32 s76, s76, 3
    s_xor_b32 s77, s69, 2
    s_lshr_b32 s78, s49, 1
    s_mul_i32 s78, s78, 10240
    s_add_u32 s78, s78, 106954752
    s_mul_i32 s56, s76, 81920
    s_add_u32 s56, s56, s78
    s_mul_i32 s57, s77, 81920
    s_add_u32 s57, s57, s78
    s_mul_i32 s78, s51, 9216
    s_add_u32 s78, s78, 107282432
    s_mul_i32 s58, s69, 294912
    s_add_u32 s58, s58, s78
    s_mul_i32 s59, s77, 294912
    s_add_u32 s59, s59, s78
    s_and_b32 s69, s97, 255
    s_mul_i32 s76, s69, 86
    s_lshr_b32 s76, s76, 8
    s_mul_i32 s62, s69, 655360
    s_mul_i32 s77, s76, 131072
    s_add_u32 s62, s62, s77
    s_add_u32 s62, s62, 167772160
    s_xor_b32 s76, s79, s76
    s_and_b32 s76, s76, 1
    s_lshl_b32 s76, s76, 13
    s_add_u32 s62, s62, s76
    s_lshl_b32 s78, s51, 8
    s_add_u32 s60, s62, s78
    s_lshl_b32 s95, s97, 8
    s_and_b32 s95, s95, 0x10000
    s_xor_b32 s94, s95, 0x10000
    s_mul_i32 s63, s55, 393216
    s_add_u32 s63, s63, 75497472
    ds_read_b128 v[88:91], v198 offset:0
    ds_read_b128 v[92:95], v198 offset:1024
    ds_read_b128 v[96:99], v198 offset:2048
    ds_read_b128 v[100:103], v198 offset:3072
    ds_read_b128 v[104:107], v198 offset:4096
    ds_read_b128 v[108:111], v198 offset:5120
    ds_read_b128 v[112:115], v198 offset:6144
    ds_read_b128 v[116:119], v198 offset:7168
    ds_read_b128 v[120:123], v198 offset:8192
    ds_read_b128 v[124:127], v198 offset:9216
    ds_read_b128 v[128:131], v198 offset:10240
    ds_read_b128 v[132:135], v198 offset:11264
    s_waitcnt lgkmcnt(0)
    s_and_b32 s69, s55, 7
    s_cbranch_scc1 Lwts_73
    s_lshr_b32 s69, s55, 3
    s_mul_i32 s69, s69, 48
    s_lshl_b32 s76, s49, 9
    s_add_u32 s69, s69, s76
    s_and_b32 s76, s51, 3
    s_lshl_b32 s76, s76, 2
    s_add_u32 s69, s69, s76
    s_add_u32 s69, s69, 152043520
    v_lshlrev_b32 v5, 4, v1
    s_mov_b64 exec, 3
Lwt_71:
    buffer_load_dword v4, v5, s[4:7], s69 offen sc1
    s_waitcnt vmcnt(0)
    v_cmp_eq_u32 vcc, 0, v4
    s_cbranch_vccz Lwtok_72
    s_sleep 2
    s_sub_u32 s54, s54, 1
    s_cbranch_scc0 Lwt_71
    s_mov_b32 s54, 0
Lwtok_72:
    s_mov_b64 exec, -1
Lwts_73:
    s_mov_b32 s78, 0
    s_lshl_b32 s69, s51, 6
    s_add_u32 s69, s69, s78
    s_mul_i32 s64, s69, 12288
    s_add_u32 s65, s64, 50331648
    s_mul_i32 s69, s78, 86
    s_lshr_b32 s69, s69, 8
    s_mul_i32 s69, s69, 3
    s_sub_u32 s69, s78, s69
    s_mul_i32 s66, s69, 27648
    s_add_u32 s66, s66, 38912
    s_add_u32 m0, s66, 24576
    s_add_u32 s76, s64, 0
    buffer_load_dwordx4 v199, s[4:7], s76 offen sc1 lds
    s_add_u32 m0, s66, 25600
    s_add_u32 s76, s64, 2048
    buffer_load_dwordx4 v199, s[4:7], s76 offen sc1 lds
    s_add_u32 m0, s66, 26624
    s_add_u32 s76, s64, 4096
    buffer_load_dwordx4 v199, s[4:7], s76 offen sc1 lds
    s_add_u32 s77, s52, 0
    s_and_b32 s77, s77, 3
    s_mul_i32 s77, s77, 3072
    s_add_u32 s76, s66, s77
    s_add_u32 m0, s76, 0
    s_add_u32 s76, s64, s77
    s_add_u32 s76, s76, 25165824
    buffer_load_dwordx4 v198, s[4:7], s76 offen offset:0 sc1 lds
    buffer_load_dwordx4 v198, s[4:7], s76 offen offset:1024 sc1 lds
    buffer_load_dwordx4 v198, s[4:7], s76 offen offset:2048 sc1 lds
    s_add_u32 s77, s52, 1
    s_and_b32 s77, s77, 3
    s_mul_i32 s77, s77, 3072
    s_add_u32 s76, s66, s77
    s_add_u32 m0, s76, 0
    s_add_u32 s76, s64, s77
    s_add_u32 s76, s76, 25165824
    buffer_load_dwordx4 v198, s[4:7], s76 offen offset:0 sc1 lds
    buffer_load_dwordx4 v198, s[4:7], s76 offen offset:1024 sc1 lds
    buffer_load_dwordx4 v198, s[4:7], s76 offen offset:2048 sc1 lds
    s_add_u32 s77, s52, 2
    s_and_b32 s77, s77, 3
    s_mul_i32 s77, s77, 3072
    s_add_u32 s76, s66, s77
    s_add_u32 m0, s76, 0
    s_add_u32 s76, s64, s77
    s_add_u32 s76, s76, 25165824
    buffer_load_dwordx4 v198, s[4:7], s76 offen offset:0 sc1 lds
    buffer_load_dwordx4 v198, s[4:7], s76 offen offset:1024 sc1 lds
    buffer_load_dwordx4 v198, s[4:7], s76 offen offset:2048 sc1 lds
    s_add_u32 s77, s52, 3
    s_and_b32 s77, s77, 3
    s_mul_i32 s77, s77, 3072
    s_add_u32 s76, s66, s77
    s_add_u32 m0, s76, 0
    s_add_u32 s76, s64, s77
    s_add_u32 s76, s76, 25165824
    buffer_load_dwordx4 v198, s[4:7], s76 offen offset:0 sc1 lds
    buffer_load_dwordx4 v198, s[4:7], s76 offen offset:1024 sc1 lds
    buffer_load_dwordx4 v198, s[4:7], s76 offen offset:2048 sc1 lds
    s_mov_b32 s78, 1
    s_lshl_b32 s69, s51, 6
    s_add_u32 s69, s69, s78
    s_mul_i32 s64, s69, 12288
    s_add_u32 s65, s64, 50331648
    s_mul_i32 s69, s78, 86
    s_lshr_b32 s69, s69, 8
    s_mul_i32 s69, s69, 3
    s_sub_u32 s69, s78, s69
    s_mul_i32 s66, s69, 27648
    s_add_u32 s66, s66, 38912
    s_add_u32 m0, s66, 24576
    s_add_u32 s76, s64, 0
    buffer_load_dwordx4 v199, s[4:7], s76 offen sc1 lds
    s_add_u32 m0, s66, 25600
    s_add_u32 s76, s64, 2048
    buffer_load_dwordx4 v199, s[4:7], s76 offen sc1 lds
    s_add_u32 m0, s66, 26624
    s_add_u32 s76, s64, 4096
    buffer_load_dwordx4 v199, s[4:7], s76 offen sc1 lds
    s_add_u32 s77, s52, 0
    s_and_b32 s77, s77, 3
    s_mul_i32 s77, s77, 3072
    s_add_u32 s76, s66, s77
    s_add_u32 m0, s76, 0
    s_add_u32 s76, s64, s77
    s_add_u32 s76, s76, 25165824
    buffer_load_dwordx4 v198, s[4:7], s76 offen offset:0 sc1 lds
    buffer_load_dwordx4 v198, s[4:7], s76 offen offset:1024 sc1 lds
    buffer_load_dwordx4 v198, s[4:7], s76 offen offset:2048 sc1 lds
    s_add_u32 s77, s52, 1
    s_and_b32 s77, s77, 3
    s_mul_i32 s77, s77, 3072
    s_add_u32 s76, s66, s77
    s_add_u32 m0, s76, 0
    s_add_u32 s76, s64, s77
    s_add_u32 s76, s76, 25165824
    buffer_load_dwordx4 v198, s[4:7], s76 offen offset:0 sc1 lds
    buffer_load_dwordx4 v198, s[4:7], s76 offen offset:1024 sc1 lds
    buffer_load_dwordx4 v198, s[4:7], s76 offen offset:2048 sc1 lds
    s_add_u32 s77, s52, 2
    s_and_b32 s77, s77, 3
    s_mul_i32 s77, s77, 3072
    s_add_u32 s76, s66, s77
    s_add_u32 m0, s76, 0
    s_add_u32 s76, s64, s77
    s_add_u32 s76, s76, 25165824
    buffer_load_dwordx4 v198, s[4:7], s76 offen offset:0 sc1 lds
    buffer_load_dwordx4 v198, s[4:7], s76 offen offset:1024 sc1 lds
    buffer_load_dwordx4 v198, s[4:7], s76 offen offset:2048 sc1 lds
    s_add_u32 s77, s52, 3
    s_and_b32 s77, s77, 3
    s_mul_i32 s77, s77, 3072
    s_add_u32 s76, s66, s77
    s_add_u32 m0, s76, 0
    s_add_u32 s76, s64, s77
    s_add_u32 s76, s76, 25165824
    buffer_load_dwordx4 v198, s[4:7], s76 offen offset:0 sc1 lds
    buffer_load_dwordx4 v198, s[4:7], s76 offen offset:1024 sc1 lds
    buffer_load_dwordx4 v198, s[4:7], s76 offen offset:2048 sc1 lds
    s_mov_b32 s78, 2
    s_lshl_b32 s69, s51, 6
    s_add_u32 s69, s69, s78
    s_mul_i32 s64, s69, 12288
    s_add_u32 s65, s64, 50331648
    s_mul_i32 s69, s78, 86
    s_lshr_b32 s69, s69, 8
    s_mul_i32 s69, s69, 3
    s_sub_u32 s69, s78, s69
    s_mul_i32 s66, s69, 27648
    s_add_u32 s66, s66, 38912
    s_add_u32 m0, s66, 24576
    s_add_u32 s76, s64, 0
    buffer_load_dwordx4 v199, s[4:7], s76 offen sc1 lds
    s_add_u32 m0, s66, 25600
    s_add_u32 s76, s64, 2048
    buffer_load_dwordx4 v199, s[4:7], s76 offen sc1 lds
    s_add_u32 m0, s66, 26624
    s_add_u32 s76, s64, 4096
    buffer_load_dwordx4 v199, s[4:7], s76 offen sc1 lds
    s_add_u32 s77, s52, 0
    s_and_b32 s77, s77, 3
    s_mul_i32 s77, s77, 3072
    s_add_u32 s76, s66, s77
    s_add_u32 m0, s76, 0
    s_add_u32 s76, s64, s77
    s_add_u32 s76, s76, 25165824
    buffer_load_dwordx4 v198, s[4:7], s76 offen offset:0 sc1 lds
    buffer_load_dwordx4 v198, s[4:7], s76 offen offset:1024 sc1 lds
    buffer_load_dwordx4 v198, s[4:7], s76 offen offset:2048 sc1 lds
    s_waitcnt vmcnt(21)
    s_barrier
    s_lshr_b32 s96, s49, 1
    s_mul_i32 s96, s96, 10240
    s_add_u32 s96, s96, 106954752
    s_barrier
    buffer_load_dwordx4 v[202:205], v197, s[4:7], s96 offen sc1
    buffer_load_dwordx4 v[206:209], v197, s[4:7], s96 offen offset:1024 sc1
    s_waitcnt vmcnt(0)
    ds_write_b128 v197, v[202:205] offset:0
    ds_write_b128 v197, v[206:209] offset:1024
    v_max3_u32 v4, v202, v203, v204
    v_max3_u32 v5, v205, v206, v207
    v_max3_u32 v4, v4, v208, v209
    v_max_u32 v4, v4, v5
    v_cmp_eq_u32 vcc, -1, v4
    s_cbranch_vccnz Lp_76
    s_waitcnt lgkmcnt(0)
    s_barrier
Lpok_77:
Lw7_74:
    ds_read_b128 v[144:147], v198 offset:0
    ds_read_b128 v[148:151], v198 offset:1024
    ds_read_b128 v[152:155], v198 offset:2048
    ds_read_b128 v[156:159], v198 offset:3072
    ds_read_b128 v[160:163], v198 offset:4096
    ds_read_b128 v[164:167], v198 offset:5120
    ds_read_b128 v[168:171], v198 offset:6144
    ds_read_b128 v[172:175], v198 offset:7168
    ds_read_b128 v[176:179], v198 offset:8192
    ds_read_b128 v[180:183], v198 offset:9216
    s_waitcnt lgkmcnt(9)
    v_smfmac_f32_16x16x64_bf16 v[184:187], v[144:147], v[8:15], v195
    s_waitcnt lgkmcnt(8)
    v_smfmac_f32_16x16x64_bf16 v[184:187], v[148:151], v[16:23], v195
    s_waitcnt lgkmcnt(7)
    v_smfmac_f32_16x16x64_bf16 v[184:187], v[152:155], v[24:31], v195
    s_waitcnt lgkmcnt(6)
    v_smfmac_f32_16x16x64_bf16 v[184:187], v[156:159], v[32:39], v195
    s_waitcnt lgkmcnt(5)
    v_smfmac_f32_16x16x64_bf16 v[184:187], v[160:163], v[40:47], v195
    s_waitcnt lgkmcnt(4)
    v_smfmac_f32_16x16x64_bf16 v[184:187], v[164:167], v[48:55], v195
    s_waitcnt lgkmcnt(3)
    v_smfmac_f32_16x16x64_bf16 v[184:187], v[168:171], v[56:63], v195
    s_waitcnt lgkmcnt(2)
    v_smfmac_f32_16x16x64_bf16 v[184:187], v[172:175], v[64:71], v195
    s_waitcnt lgkmcnt(1)
    v_smfmac_f32_16x16x64_bf16 v[184:187], v[176:179], v[72:79], v195
    s_barrier
    s_waitcnt lgkmcnt(0)
    v_smfmac_f32_16x16x64_bf16 v[184:187], v[180:183], v[80:87], v195
    s_nop 7
    v_pk_add_f32 v[184:185], v[184:185], v[186:187]
    v_cvt_pk_bf16_f32 v184, v184, v185
    v_min_u32 v184, -2, v184
    s_cmp_lg_u32 s53, 0
    s_cbranch_scc1 Lslow_78
    buffer_store_dword v184, v196, s[4:7], s58 offen
Lback_79:
    v_mov_b32 v184, 0
    v_mov_b32 v185, 0
    v_mov_b32 v186, 0
    v_mov_b32 v187, 0
    s_barrier
    s_cmp_lg_u32 s53, 0
    s_cbranch_scc1 Lslow_80
    buffer_store_dword v188, v196, s[4:7], s59 offen
Lback_81:
    s_sleep 2
    s_cmp_ge_u32 s55, 58
    s_cbranch_scc1 Lw7nf_82
    s_and_b32 s69, s55, 3
    s_cmp_lg_u32 s69, 2
    s_cbranch_scc1 Lw7nf_82
    s_cmp_lt_u32 s55, 2
    s_cbranch_scc1 Lw7nf_82
Lw7yf_83:
    s_lshl_b32 s69, s49, 4
    s_add_u32 s69, s69, s50
    s_lshl_b32 s69, s69, 7
    s_add_u32 s69, s69, 152174592
    s_add_u32 s76, s55, -1
    v_mov_b32 v4, s76
    v_mov_b32 v5, 0
    s_mov_b64 exec, 1
    buffer_store_dword v4, v5, s[4:7], s69 offen sc1
    s_mov_b64 exec, -1
Lw7nf_82:
    s_add_u32 s78, s55, 2
    s_cmp_ge_u32 s78, 64
    s_cbranch_scc1 Lsg_85
    s_lshl_b32 s69, s51, 6
    s_add_u32 s69, s69, s78
    s_mul_i32 s64, s69, 12288
    s_add_u32 s65, s64, 50331648
    s_mul_i32 s69, s78, 86
    s_lshr_b32 s69, s69, 8
    s_mul_i32 s69, s69, 3
    s_sub_u32 s69, s78, s69
    s_mul_i32 s66, s69, 27648
    s_add_u32 s66, s66, 38912
    s_add_u32 s77, s52, 1
    s_and_b32 s77, s77, 3
    s_mul_i32 s77, s77, 3072
    s_add_u32 s76, s66, s77
    s_add_u32 m0, s76, 0
    s_add_u32 s76, s64, s77
    s_add_u32 s76, s76, 25165824
    buffer_load_dwordx4 v198, s[4:7], s76 offen offset:0 sc1 lds
    buffer_load_dwordx4 v198, s[4:7], s76 offen offset:1024 sc1 lds
    buffer_load_dwordx4 v198, s[4:7], s76 offen offset:2048 sc1 lds
    s_add_u32 s77, s52, 2
    s_and_b32 s77, s77, 3
    s_mul_i32 s77, s77, 3072
    s_add_u32 s76, s66, s77
    s_add_u32 m0, s76, 0
    s_add_u32 s76, s64, s77
    s_add_u32 s76, s76, 25165824
    buffer_load_dwordx4 v198, s[4:7], s76 offen offset:0 sc1 lds
    buffer_load_dwordx4 v198, s[4:7], s76 offen offset:1024 sc1 lds
    buffer_load_dwordx4 v198, s[4:7], s76 offen offset:2048 sc1 lds
    s_add_u32 s77, s52, 3
    s_and_b32 s77, s77, 3
    s_mul_i32 s77, s77, 3072
    s_add_u32 s76, s66, s77
    s_add_u32 m0, s76, 0
    s_add_u32 s76, s64, s77
    s_add_u32 s76, s76, 25165824
    buffer_load_dwordx4 v198, s[4:7], s76 offen offset:0 sc1 lds
    buffer_load_dwordx4 v198, s[4:7], s76 offen offset:1024 sc1 lds
    buffer_load_dwordx4 v198, s[4:7], s76 offen offset:2048 sc1 lds
Lsg_85:
    s_add_u32 s78, s55, 3
    s_cmp_ge_u32 s78, 64
    s_cbranch_scc1 Lsg_84
    s_and_b32 s69, s78, 7
    s_cbranch_scc1 Lwts_88
    s_lshr_b32 s69, s78, 3
    s_mul_i32 s69, s69, 48
    s_lshl_b32 s76, s49, 9
    s_add_u32 s69, s69, s76
    s_and_b32 s76, s51, 3
    s_lshl_b32 s76, s76, 2
    s_add_u32 s69, s69, s76
    s_add_u32 s69, s69, 152043520
    v_lshlrev_b32 v5, 4, v1
    s_mov_b64 exec, 3
Lwt_86:
    buffer_load_dword v4, v5, s[4:7], s69 offen sc1
    s_waitcnt vmcnt(0)
    v_cmp_eq_u32 vcc, 0, v4
    s_cbranch_vccz Lwtok_87
    s_sleep 2
    s_sub_u32 s54, s54, 1
    s_cbranch_scc0 Lwt_86
    s_mov_b32 s54, 0
Lwtok_87:
    s_mov_b64 exec, -1
Lwts_88:
    s_lshl_b32 s69, s51, 6
    s_add_u32 s69, s69, s78
    s_mul_i32 s64, s69, 12288
    s_add_u32 s65, s64, 50331648
    s_mul_i32 s69, s78, 86
    s_lshr_b32 s69, s69, 8
    s_mul_i32 s69, s69, 3
    s_sub_u32 s69, s78, s69
    s_mul_i32 s66, s69, 27648
    s_add_u32 s66, s66, 38912
    s_add_u32 m0, s66, 24576
    s_add_u32 s76, s64, 0
    buffer_load_dwordx4 v199, s[4:7], s76 offen sc1 lds
    s_add_u32 m0, s66, 25600
    s_add_u32 s76, s64, 2048
    buffer_load_dwordx4 v199, s[4:7], s76 offen sc1 lds
    s_add_u32 m0, s66, 26624
    s_add_u32 s76, s64, 4096
    buffer_load_dwordx4 v199, s[4:7], s76 offen sc1 lds
    s_add_u32 s77, s52, 0
    s_and_b32 s77, s77, 3
    s_mul_i32 s77, s77, 3072
    s_add_u32 s76, s66, s77
    s_add_u32 m0, s76, 0
    s_add_u32 s76, s64, s77
    s_add_u32 s76, s76, 25165824
    buffer_load_dwordx4 v198, s[4:7], s76 offen offset:0 sc1 lds
    buffer_load_dwordx4 v198, s[4:7], s76 offen offset:1024 sc1 lds
    buffer_load_dwordx4 v198, s[4:7], s76 offen offset:2048 sc1 lds
Lsg_84:
    s_barrier
    ds_read_b128 v[144:147], v194 offset:10240
    ds_read_b128 v[148:151], v194 offset:11264
    ds_read_b128 v[152:155], v194 offset:12288
    v_lshlrev_b32 v4, 3, v3
    ds_read_b64 v[192:193], v4 offset:34816
    s_cmp_eq_u32 s55, 63
    s_cbranch_scc1 Lw7end_75
    s_waitcnt lgkmcnt(3)
    v_smfmac_f32_16x16x64_bf16 v[136:139], v[144:147], v[88:95], v195
    v_smfmac_f32_16x16x64_bf16 v[140:143], v[144:147], v[112:119], v195
    s_waitcnt lgkmcnt(2)
    v_smfmac_f32_16x16x64_bf16 v[136:139], v[148:151], v[96:103], v195
    v_smfmac_f32_16x16x64_bf16 v[140:143], v[148:151], v[120:127], v195
    s_waitcnt lgkmcnt(1)
    v_smfmac_f32_16x16x64_bf16 v[136:139], v[152:155], v[104:111], v195
    v_smfmac_f32_16x16x64_bf16 v[140:143], v[152:155], v[128:135], v195
    s_waitcnt lgkmcnt(0)
    s_nop 5
    v_pk_add_f32 v[136:137], v[136:137], v[138:139]
    v_pk_add_f32 v[142:143], v[140:141], v[142:143]
    v_pk_mul_f32 v[136:137], v[136:137], v[192:193]
    v_pk_mul_f32 v[142:143], v[142:143], v[192:193]
    v_add_u32 v136, s94, v136
    v_add_u32 v137, s94, v137
    v_and_or_b32 v136, v136, v0, s95
    v_and_or_b32 v137, v137, v0, s95
    v_cvt_pk_bf16_f32 v136, v136, v142
    v_cvt_pk_bf16_f32 v140, v137, v143
    buffer_store_dword v136, v200, s[4:7], s60 offen offset:0 sc1
    buffer_store_dword v140, v200, s[4:7], s60 offen offset:128 sc1
    v_mov_b32 v136, 0
    v_mov_b32 v137, 0
    v_mov_b32 v138, 0
    v_mov_b32 v139, 0
    v_mov_b32 v140, 0
    v_mov_b32 v141, 0
    v_mov_b32 v142, 0
    v_mov_b32 v143, 0
    s_mov_b32 s96, s56
    s_add_u32 s55, s55, 1
    s_add_u32 s97, s97, 1
    s_and_b32 s69, s97, 255
    s_xor_b32 s76, s97, 265
    s_cmp_eq_u32 s69, 9
    s_cselect_b32 s97, s76, s97
    s_and_b32 s69, s55, 3
    s_add_u32 s76, s55, 1
    s_and_b32 s76, s76, 3
    s_xor_b32 s77, s69, 2
    s_lshr_b32 s78, s49, 1
    s_mul_i32 s78, s78, 10240
    s_add_u32 s78, s78, 106954752
    s_mul_i32 s56, s76, 81920
    s_add_u32 s56, s56, s78
    s_mul_i32 s57, s77, 81920
    s_add_u32 s57, s57, s78
    s_mul_i32 s78, s51, 9216
    s_add_u32 s78, s78, 107282432
    s_mul_i32 s58, s69, 294912
    s_add_u32 s58, s58, s78
    s_mul_i32 s59, s77, 294912
    s_add_u32 s59, s59, s78
    s_and_b32 s69, s97, 255
    s_mul_i32 s76, s69, 86
    s_lshr_b32 s76, s76, 8
    s_mul_i32 s62, s69, 655360
    s_mul_i32 s77, s76, 131072
    s_add_u32 s62, s62, s77
    s_add_u32 s62, s62, 167772160
    s_xor_b32 s76, s79, s76
    s_and_b32 s76, s76, 1
    s_lshl_b32 s76, s76, 13
    s_add_u32 s62, s62, s76
    s_lshl_b32 s78, s51, 8
    s_add_u32 s60, s62, s78
    s_lshl_b32 s95, s97, 8
    s_and_b32 s95, s95, 0x10000
    s_xor_b32 s94, s95, 0x10000
    s_mul_i32 s63, s55, 393216
    s_add_u32 s63, s63, 75497472
    s_barrier
    buffer_load_dwordx4 v[202:205], v197, s[4:7], s96 offen sc1
    buffer_load_dwordx4 v[206:209], v197, s[4:7], s96 offen offset:1024 sc1
    s_sleep 1
    buffer_load_dwordx4 v[210:213], v197, s[4:7], s96 offen sc1
    buffer_load_dwordx4 v[214:217], v197, s[4:7], s96 offen offset:1024 sc1
    s_waitcnt vmcnt(2)
    ds_write_b128 v197, v[202:205] offset:0
    ds_write_b128 v197, v[206:209] offset:1024
    v_max3_u32 v4, v202, v203, v204
    v_max3_u32 v5, v205, v206, v207
    v_max3_u32 v4, v4, v208, v209
    v_max_u32 v4, v4, v5
    v_cmp_eq_u32 vcc, -1, v4
    s_cbranch_vccnz Lp_89
    s_waitcnt lgkmcnt(0)
    s_barrier
Lpok_90:
    s_branch Lw7_74
Lw7end_75:
    s_barrier
    s_endpgm
Lslow_78:
    buffer_store_dword v184, v196, s[4:7], s58 offen sc1
    s_branch Lback_79
Lslow_80:
    buffer_store_dword v188, v196, s[4:7], s59 offen sc1
    s_branch Lback_81
Lp_76:
    s_mov_b64 exec, vcc
    buffer_load_dwordx4 v[202:205], v197, s[4:7], s96 offen sc1
    buffer_load_dwordx4 v[206:209], v197, s[4:7], s96 offen offset:1024 sc1
    s_waitcnt vmcnt(0)
    ds_write_b128 v197, v[202:205] offset:0
    ds_write_b128 v197, v[206:209] offset:1024
    v_max3_u32 v4, v202, v203, v204
    v_max3_u32 v5, v205, v206, v207
    v_max3_u32 v4, v4, v208, v209
    v_max_u32 v4, v4, v5
    v_cmp_eq_u32 vcc, -1, v4
    s_cbranch_vccnz Lpn_91
    s_mov_b64 exec, -1
    s_waitcnt lgkmcnt(0)
    s_barrier
    s_branch Lpok_77
Lpn_91:
    s_sub_u32 s54, s54, 1
    s_cbranch_scc0 Lp_76
    s_mov_b32 s54, 0
    s_mov_b64 exec, -1
    s_waitcnt lgkmcnt(0)
    s_barrier
    s_branch Lpok_77
Lp_89:
    s_mov_b64 exec, vcc
    buffer_load_dwordx4 v[202:205], v197, s[4:7], s96 offen sc1
    buffer_load_dwordx4 v[206:209], v197, s[4:7], s96 offen offset:1024 sc1
    s_waitcnt vmcnt(2)
    ds_write_b128 v197, v[210:213] offset:0
    ds_write_b128 v197, v[214:217] offset:1024
    v_max3_u32 v4, v210, v211, v212
    v_max3_u32 v5, v213, v214, v215
    v_max3_u32 v4, v4, v216, v217
    v_max_u32 v4, v4, v5
    v_cmp_eq_u32 vcc, -1, v4
    s_cbranch_vccnz Lpn_92
    s_mov_b64 exec, -1
    s_waitcnt lgkmcnt(0)
    s_barrier
    s_branch Lpok_90
Lpn_92:
    s_mov_b64 exec, vcc
    buffer_load_dwordx4 v[210:213], v197, s[4:7], s96 offen sc1
    buffer_load_dwordx4 v[214:217], v197, s[4:7], s96 offen offset:1024 sc1
    s_waitcnt vmcnt(2)
    ds_write_b128 v197, v[202:205] offset:0
    ds_write_b128 v197, v[206:209] offset:1024
    v_max3_u32 v4, v202, v203, v204
    v_max3_u32 v5, v205, v206, v207
    v_max3_u32 v4, v4, v208, v209
    v_max_u32 v4, v4, v5
    v_cmp_eq_u32 vcc, -1, v4
    s_cbranch_vccnz Lpn_93
    s_mov_b64 exec, -1
    s_waitcnt lgkmcnt(0)
    s_barrier
    s_branch Lpok_90
Lpn_93:
    s_sub_u32 s54, s54, 1
    s_cbranch_scc0 Lp_89
    s_mov_b32 s54, 0
    s_mov_b64 exec, -1
    s_waitcnt lgkmcnt(0)
    s_barrier
    s_branch Lpok_90
Lrole_att_14:
    v_and_b32 v1, 63, v0
    v_and_b32 v2, 15, v0
    v_bfe_u32 v3, v0, 4, 2
    v_mov_b32 v0, 0xfffe0000
    s_sub_u32 s67, s48, 4
    v_lshlrev_b32 v240, 8, v3
    v_bfe_u32 v4, v2, 1, 1
    v_lshl_add_u32 v240, v4, 7, v240
    v_lshrrev_b32 v4, 2, v2
    v_lshl_add_u32 v240, v4, 5, v240
    v_and_b32 v4, 1, v2
    v_lshl_add_u32 v240, v4, 4, v240
    v_and_b32 v4, 2, v2
    v_cmp_eq_u32 vcc, 2, v4
    v_mov_b32 v241, 0x44444444
    v_mov_b32 v4, 0xeeeeeeee
    s_nop 1
    v_cndmask_b32 v241, v241, v4, vcc
    v_lshrrev_b32 v246, 3, v2
    v_lshlrev_b32 v246, 14, v246
    v_bfe_u32 v4, v2, 2, 1
    v_lshl_add_u32 v246, v4, 6, v246
    v_lshl_add_u32 v246, v3, 4, v246
    v_and_b32 v4, 3, v2
    v_lshl_add_u32 v246, v4, 2, v246
    s_mul_i32 s69, s52, 163840
    s_lshl_b32 s76, s67, 15
    s_add_u32 s69, s69, s76
    v_add_u32 v246, s69, v246
    s_setprio 3
    s_mov_b32 s12, s26
    s_mov_b32 s13, s27
    s_mov_b32 s14, 7864320
    s_mov_b32 s15, 0x20000
    v_lshrrev_b32 v4, 1, v3
    v_lshlrev_b32 v4, 4, v4
    v_and_b32 v5, 1, v3
    v_lshl_add_u32 v4, v5, 2, v4
    s_mov_b32 s69, 1280
    v_mul_lo_u32 v242, v4, s69
    s_mul_i32 s69, s51, 245760
    s_mul_i32 s76, s52, 320
    s_add_u32 s69, s69, s76
    s_lshl_b32 s76, s67, 6
    s_add_u32 s69, s69, s76
    v_lshl_add_u32 v242, v2, 2, v242
    v_add_u32 v242, s69, v242
    s_mov_b32 s69, 0
    buffer_load_dword v10, v242, s[12:15], s69 offen
    s_mov_b32 s76, 1280
    buffer_load_dword v34, v242, s[12:15], s76 offen
    s_mov_b32 s69, 10240
    buffer_load_dword v11, v242, s[12:15], s69 offen
    s_mov_b32 s76, 11520
    buffer_load_dword v35, v242, s[12:15], s76 offen
    s_mov_b32 s69, 2560
    buffer_load_dword v12, v242, s[12:15], s69 offen
    s_mov_b32 s76, 3840
    buffer_load_dword v36, v242, s[12:15], s76 offen
    s_mov_b32 s69, 12800
    buffer_load_dword v13, v242, s[12:15], s69 offen
    s_mov_b32 s76, 14080
    buffer_load_dword v37, v242, s[12:15], s76 offen
    s_mov_b32 s69, 40960
    buffer_load_dword v14, v242, s[12:15], s69 offen
    s_mov_b32 s76, 42240
    buffer_load_dword v38, v242, s[12:15], s76 offen
    s_mov_b32 s69, 51200
    buffer_load_dword v15, v242, s[12:15], s69 offen
    s_mov_b32 s76, 52480
    buffer_load_dword v39, v242, s[12:15], s76 offen
    s_mov_b32 s69, 43520
    buffer_load_dword v16, v242, s[12:15], s69 offen
    s_mov_b32 s76, 44800
    buffer_load_dword v40, v242, s[12:15], s76 offen
    s_mov_b32 s69, 53760
    buffer_load_dword v17, v242, s[12:15], s69 offen
    s_mov_b32 s76, 55040
    buffer_load_dword v41, v242, s[12:15], s76 offen
    s_mov_b32 s69, 81920
    buffer_load_dword v18, v242, s[12:15], s69 offen
    s_mov_b32 s76, 83200
    buffer_load_dword v42, v242, s[12:15], s76 offen
    s_mov_b32 s69, 92160
    buffer_load_dword v19, v242, s[12:15], s69 offen
    s_mov_b32 s76, 93440
    buffer_load_dword v43, v242, s[12:15], s76 offen
    s_mov_b32 s69, 84480
    buffer_load_dword v20, v242, s[12:15], s69 offen
    s_mov_b32 s76, 85760
    buffer_load_dword v44, v242, s[12:15], s76 offen
    s_mov_b32 s69, 94720
    buffer_load_dword v21, v242, s[12:15], s69 offen
    s_mov_b32 s76, 96000
    buffer_load_dword v45, v242, s[12:15], s76 offen
    s_mov_b32 s69, 122880
    buffer_load_dword v22, v242, s[12:15], s69 offen
    s_mov_b32 s76, 124160
    buffer_load_dword v46, v242, s[12:15], s76 offen
    s_mov_b32 s69, 133120
    buffer_load_dword v23, v242, s[12:15], s69 offen
    s_mov_b32 s76, 134400
    buffer_load_dword v47, v242, s[12:15], s76 offen
    s_mov_b32 s69, 125440
    buffer_load_dword v24, v242, s[12:15], s69 offen
    s_mov_b32 s76, 126720
    buffer_load_dword v48, v242, s[12:15], s76 offen
    s_mov_b32 s69, 135680
    buffer_load_dword v25, v242, s[12:15], s69 offen
    s_mov_b32 s76, 136960
    buffer_load_dword v49, v242, s[12:15], s76 offen
    s_mov_b32 s69, 163840
    buffer_load_dword v26, v242, s[12:15], s69 offen
    s_mov_b32 s76, 165120
    buffer_load_dword v50, v242, s[12:15], s76 offen
    s_mov_b32 s69, 174080
    buffer_load_dword v27, v242, s[12:15], s69 offen
    s_mov_b32 s76, 175360
    buffer_load_dword v51, v242, s[12:15], s76 offen
    s_mov_b32 s69, 166400
    buffer_load_dword v28, v242, s[12:15], s69 offen
    s_mov_b32 s76, 167680
    buffer_load_dword v52, v242, s[12:15], s76 offen
    s_mov_b32 s69, 176640
    buffer_load_dword v29, v242, s[12:15], s69 offen
    s_mov_b32 s76, 177920
    buffer_load_dword v53, v242, s[12:15], s76 offen
    s_mov_b32 s69, 204800
    buffer_load_dword v30, v242, s[12:15], s69 offen
    s_mov_b32 s76, 206080
    buffer_load_dword v54, v242, s[12:15], s76 offen
    s_mov_b32 s69, 215040
    buffer_load_dword v31, v242, s[12:15], s69 offen
    s_mov_b32 s76, 216320
    buffer_load_dword v55, v242, s[12:15], s76 offen
    s_mov_b32 s69, 207360
    buffer_load_dword v32, v242, s[12:15], s69 offen
    s_mov_b32 s76, 208640
    buffer_load_dword v56, v242, s[12:15], s76 offen
    s_mov_b32 s69, 217600
    buffer_load_dword v33, v242, s[12:15], s69 offen
    s_mov_b32 s76, 218880
    buffer_load_dword v57, v242, s[12:15], s76 offen
    s_lshl_b32 s96, s49, 4
    s_add_u32 s96, s96, s50
    s_mul_i32 s96, s96, 3
    s_add_u32 s96, s96, s67
    v_lshlrev_b32 v86, 4, v1
    v_mov_b32 v66, -1
    v_mov_b32 v67, -1
    v_mov_b32 v68, -1
    v_mov_b32 v69, -1
    v_mov_b32 v70, 0
    v_mov_b32 v71, 0
    v_mov_b32 v72, 0
    v_mov_b32 v73, 0
    s_cmp_ge_u32 s96, 320
    s_cbranch_scc1 Lin_94
    s_lshl_b32 s69, s96, 11
    s_add_u32 s69, s69, 167772160
    buffer_store_dwordx4 v[66:69], v86, s[4:7], s69 offen sc1
    buffer_store_dwordx4 v[66:69], v86, s[4:7], s69 offen offset:1024 sc1
Lin_94:
    s_cmp_ge_u32 s96, 368
    s_cbranch_scc1 Lin_95
    s_lshl_b32 s69, s96, 12
    s_add_u32 s69, s69, 106954752
    s_cmp_lt_u32 s96, 20
    s_cbranch_scc1 Lin_97
    buffer_store_dwordx4 v[66:69], v86, s[4:7], s69 offen offset:0 sc1
    buffer_store_dwordx4 v[66:69], v86, s[4:7], s69 offen offset:1024 sc1
    buffer_store_dwordx4 v[66:69], v86, s[4:7], s69 offen offset:2048 sc1
    buffer_store_dwordx4 v[66:69], v86, s[4:7], s69 offen offset:3072 sc1
    s_branch Lin_95
Lin_97:
    s_mov_b32 s12, s18
    s_mov_b32 s13, s19
    s_mov_b32 s14, 10240
    s_mov_b32 s15, 0x20000
    s_lshl_b32 s76, s96, 12
    s_add_u32 s77, s76, 0
    s_lshr_b32 s78, s77, 10
    s_mul_i32 s78, s78, 205
    s_lshr_b32 s78, s78, 11
    s_mul_i32 s78, s78, 10240
    s_sub_u32 s77, s77, s78
    s_lshr_b32 s77, s77, 3
    v_lshrrev_b32 v74, 2, v2
    v_and_b32 v75, 1, v2
    v_lshl_add_u32 v74, v74, 1, v75
    v_mul_u32_u24 v74, 1280, v74
    v_lshl_add_u32 v74, v3, 5, v74
    v_bfe_u32 v75, v2, 1, 1
    v_lshl_add_u32 v74, v75, 4, v74
    buffer_load_dwordx4 v[90:93], v74, s[12:15], s77 offen
    s_add_u32 s77, s76, 1024
    s_lshr_b32 s78, s77, 10
    s_mul_i32 s78, s78, 205
    s_lshr_b32 s78, s78, 11
    s_mul_i32 s78, s78, 10240
    s_sub_u32 s77, s77, s78
    s_lshr_b32 s77, s77, 3
    v_lshrrev_b32 v74, 2, v2
    v_and_b32 v75, 1, v2
    v_lshl_add_u32 v74, v74, 1, v75
    v_mul_u32_u24 v74, 1280, v74
    v_lshl_add_u32 v74, v3, 5, v74
    v_bfe_u32 v75, v2, 1, 1
    v_lshl_add_u32 v74, v75, 4, v74
    buffer_load_dwordx4 v[94:97], v74, s[12:15], s77 offen
    s_add_u32 s77, s76, 2048
    s_lshr_b32 s78, s77, 10
    s_mul_i32 s78, s78, 205
    s_lshr_b32 s78, s78, 11
    s_mul_i32 s78, s78, 10240
    s_sub_u32 s77, s77, s78
    s_lshr_b32 s77, s77, 3
    v_lshrrev_b32 v74, 2, v2
    v_and_b32 v75, 1, v2
    v_lshl_add_u32 v74, v74, 1, v75
    v_mul_u32_u24 v74, 1280, v74
    v_lshl_add_u32 v74, v3, 5, v74
    v_bfe_u32 v75, v2, 1, 1
    v_lshl_add_u32 v74, v75, 4, v74
    buffer_load_dwordx4 v[98:101], v74, s[12:15], s77 offen
    s_add_u32 s77, s76, 3072
    s_lshr_b32 s78, s77, 10
    s_mul_i32 s78, s78, 205
    s_lshr_b32 s78, s78, 11
    s_mul_i32 s78, s78, 10240
    s_sub_u32 s77, s77, s78
    s_lshr_b32 s77, s77, 3
    v_lshrrev_b32 v74, 2, v2
    v_and_b32 v75, 1, v2
    v_lshl_add_u32 v74, v74, 1, v75
    v_mul_u32_u24 v74, 1280, v74
    v_lshl_add_u32 v74, v3, 5, v74
    v_bfe_u32 v75, v2, 1, 1
    v_lshl_add_u32 v74, v75, 4, v74
    buffer_load_dwordx4 v[102:105], v74, s[12:15], s77 offen
    s_waitcnt vmcnt(0)
    v_min_u32 v90, -2, v90
    v_min_u32 v91, -2, v91
    v_min_u32 v92, -2, v92
    v_min_u32 v93, -2, v93
    buffer_store_dwordx4 v[90:93], v86, s[4:7], s69 offen offset:0 sc1
    v_min_u32 v94, -2, v94
    v_min_u32 v95, -2, v95
    v_min_u32 v96, -2, v96
    v_min_u32 v97, -2, v97
    buffer_store_dwordx4 v[94:97], v86, s[4:7], s69 offen offset:1024 sc1
    v_min_u32 v98, -2, v98
    v_min_u32 v99, -2, v99
    v_min_u32 v100, -2, v100
    v_min_u32 v101, -2, v101
    buffer_store_dwordx4 v[98:101], v86, s[4:7], s69 offen offset:2048 sc1
    v_min_u32 v102, -2, v102
    v_min_u32 v103, -2, v103
    v_min_u32 v104, -2, v104
    v_min_u32 v105, -2, v105
    buffer_store_dwordx4 v[102:105], v86, s[4:7], s69 offen offset:3072 sc1
    s_waitcnt vmcnt(0)
Lin_95:
    s_sub_u32 s69, s96, 4
    s_cmp_ge_u32 s69, 252
    s_cbranch_scc1 Lin_96
    s_lshl_b32 s69, s96, 10
    s_add_u32 s69, s69, 152043520
    buffer_store_dwordx4 v[70:73], v86, s[4:7], s69 offen sc1
Lin_96:
    s_cmp_lg_u32 s48, 6
    s_cbranch_scc1 Larr_98
    s_cmp_lg_u32 s3, 0
    s_cbranch_scc1 Larr_98
    s_mov_b64 exec, 1
    v_mov_b32 v82, 1
    v_mov_b32 v83, 32
    buffer_atomic_add v82, v83, s[8:11], 0 offen sc1
    s_mov_b64 exec, -1
Larr_98:
    s_waitcnt vmcnt(0)
    v_mov_b32 v80, 1
    v_mov_b32 v81, 128
    s_mov_b64 exec, 1
    buffer_atomic_add v80, v81, s[8:11], 0 offen sc1
    s_mov_b64 exec, -1
    s_waitcnt vmcnt(0)
    s_waitcnt vmcnt(40)
    v_perm_b32 v6, v34, v10, s80
    v_perm_b32 v34, v34, v10, s81
    v_mov_b32 v10, v6
    v_perm_b32 v6, v35, v11, s80
    v_perm_b32 v35, v35, v11, s81
    v_mov_b32 v11, v6
    v_perm_b32 v6, v36, v12, s80
    v_perm_b32 v36, v36, v12, s81
    v_mov_b32 v12, v6
    v_perm_b32 v6, v37, v13, s80
    v_perm_b32 v37, v37, v13, s81
    v_mov_b32 v13, v6
    s_waitcnt vmcnt(32)
    v_perm_b32 v6, v38, v14, s80
    v_perm_b32 v38, v38, v14, s81
    v_mov_b32 v14, v6
    v_perm_b32 v6, v39, v15, s80
    v_perm_b32 v39, v39, v15, s81
    v_mov_b32 v15, v6
    v_perm_b32 v6, v40, v16, s80
    v_perm_b32 v40, v40, v16, s81
    v_mov_b32 v16, v6
    v_perm_b32 v6, v41, v17, s80
    v_perm_b32 v41, v41, v17, s81
    v_mov_b32 v17, v6
    s_waitcnt vmcnt(24)
    v_perm_b32 v6, v42, v18, s80
    v_perm_b32 v42, v42, v18, s81
    v_mov_b32 v18, v6
    v_perm_b32 v6, v43, v19, s80
    v_perm_b32 v43, v43, v19, s81
    v_mov_b32 v19, v6
    v_perm_b32 v6, v44, v20, s80
    v_perm_b32 v44, v44, v20, s81
    v_mov_b32 v20, v6
    v_perm_b32 v6, v45, v21, s80
    v_perm_b32 v45, v45, v21, s81
    v_mov_b32 v21, v6
    s_waitcnt vmcnt(16)
    v_perm_b32 v6, v46, v22, s80
    v_perm_b32 v46, v46, v22, s81
    v_mov_b32 v22, v6
    v_perm_b32 v6, v47, v23, s80
    v_perm_b32 v47, v47, v23, s81
    v_mov_b32 v23, v6
    v_perm_b32 v6, v48, v24, s80
    v_perm_b32 v48, v48, v24, s81
    v_mov_b32 v24, v6
    v_perm_b32 v6, v49, v25, s80
    v_perm_b32 v49, v49, v25, s81
    v_mov_b32 v25, v6
    s_waitcnt vmcnt(8)
    v_perm_b32 v6, v50, v26, s80
    v_perm_b32 v50, v50, v26, s81
    v_mov_b32 v26, v6
    v_perm_b32 v6, v51, v27, s80
    v_perm_b32 v51, v51, v27, s81
    v_mov_b32 v27, v6
    v_perm_b32 v6, v52, v28, s80
    v_perm_b32 v52, v52, v28, s81
    v_mov_b32 v28, v6
    v_perm_b32 v6, v53, v29, s80
    v_perm_b32 v53, v53, v29, s81
    v_mov_b32 v29, v6
    s_waitcnt vmcnt(0)
    v_perm_b32 v6, v54, v30, s80
    v_perm_b32 v54, v54, v30, s81
    v_mov_b32 v30, v6
    v_perm_b32 v6, v55, v31, s80
    v_perm_b32 v55, v55, v31, s81
    v_mov_b32 v31, v6
    v_perm_b32 v6, v56, v32, s80
    v_perm_b32 v56, v56, v32, s81
    v_mov_b32 v32, v6
    v_perm_b32 v6, v57, v33, s80
    v_perm_b32 v57, v57, v33, s81
    v_mov_b32 v33, v6
    s_cmp_ge_u32 s67, 2
    s_cbranch_scc1 Latnx_99
    s_add_u32 s96, s67, 3
    s_mov_b32 s12, s26
    s_mov_b32 s13, s27
    s_mov_b32 s14, 7864320
    s_mov_b32 s15, 0x20000
    v_lshrrev_b32 v4, 1, v3
    v_lshlrev_b32 v4, 4, v4
    v_and_b32 v5, 1, v3
    v_lshl_add_u32 v4, v5, 2, v4
    s_mov_b32 s69, 1280
    v_mul_lo_u32 v242, v4, s69
    s_mul_i32 s69, s51, 245760
    s_mul_i32 s76, s52, 320
    s_add_u32 s69, s69, s76
    s_lshl_b32 s76, s96, 6
    s_add_u32 s69, s69, s76
    v_lshl_add_u32 v242, v2, 2, v242
    v_add_u32 v242, s69, v242
    s_mov_b32 s69, 0
    buffer_load_dword v66, v242, s[12:15], s69 offen
    s_mov_b32 s76, 1280
    buffer_load_dword v90, v242, s[12:15], s76 offen
    s_mov_b32 s69, 10240
    buffer_load_dword v67, v242, s[12:15], s69 offen
    s_mov_b32 s76, 11520
    buffer_load_dword v91, v242, s[12:15], s76 offen
    s_mov_b32 s69, 2560
    buffer_load_dword v68, v242, s[12:15], s69 offen
    s_mov_b32 s76, 3840
    buffer_load_dword v92, v242, s[12:15], s76 offen
    s_mov_b32 s69, 12800
    buffer_load_dword v69, v242, s[12:15], s69 offen
    s_mov_b32 s76, 14080
    buffer_load_dword v93, v242, s[12:15], s76 offen
    s_mov_b32 s69, 40960
    buffer_load_dword v70, v242, s[12:15], s69 offen
    s_mov_b32 s76, 42240
    buffer_load_dword v94, v242, s[12:15], s76 offen
    s_mov_b32 s69, 51200
    buffer_load_dword v71, v242, s[12:15], s69 offen
    s_mov_b32 s76, 52480
    buffer_load_dword v95, v242, s[12:15], s76 offen
    s_mov_b32 s69, 43520
    buffer_load_dword v72, v242, s[12:15], s69 offen
    s_mov_b32 s76, 44800
    buffer_load_dword v96, v242, s[12:15], s76 offen
    s_mov_b32 s69, 53760
    buffer_load_dword v73, v242, s[12:15], s69 offen
    s_mov_b32 s76, 55040
    buffer_load_dword v97, v242, s[12:15], s76 offen
    s_mov_b32 s69, 81920
    buffer_load_dword v74, v242, s[12:15], s69 offen
    s_mov_b32 s76, 83200
    buffer_load_dword v98, v242, s[12:15], s76 offen
    s_mov_b32 s69, 92160
    buffer_load_dword v75, v242, s[12:15], s69 offen
    s_mov_b32 s76, 93440
    buffer_load_dword v99, v242, s[12:15], s76 offen
    s_mov_b32 s69, 84480
    buffer_load_dword v76, v242, s[12:15], s69 offen
    s_mov_b32 s76, 85760
    buffer_load_dword v100, v242, s[12:15], s76 offen
    s_mov_b32 s69, 94720
    buffer_load_dword v77, v242, s[12:15], s69 offen
    s_mov_b32 s76, 96000
    buffer_load_dword v101, v242, s[12:15], s76 offen
    s_mov_b32 s69, 122880
    buffer_load_dword v78, v242, s[12:15], s69 offen
    s_mov_b32 s76, 124160
    buffer_load_dword v102, v242, s[12:15], s76 offen
    s_mov_b32 s69, 133120
    buffer_load_dword v79, v242, s[12:15], s69 offen
    s_mov_b32 s76, 134400
    buffer_load_dword v103, v242, s[12:15], s76 offen
    s_mov_b32 s69, 125440
    buffer_load_dword v80, v242, s[12:15], s69 offen
    s_mov_b32 s76, 126720
    buffer_load_dword v104, v242, s[12:15], s76 offen
    s_mov_b32 s69, 135680
    buffer_load_dword v81, v242, s[12:15], s69 offen
    s_mov_b32 s76, 136960
    buffer_load_dword v105, v242, s[12:15], s76 offen
    s_mov_b32 s69, 163840
    buffer_load_dword v82, v242, s[12:15], s69 offen
    s_mov_b32 s76, 165120
    buffer_load_dword v106, v242, s[12:15], s76 offen
    s_mov_b32 s69, 174080
    buffer_load_dword v83, v242, s[12:15], s69 offen
    s_mov_b32 s76, 175360
    buffer_load_dword v107, v242, s[12:15], s76 offen
    s_mov_b32 s69, 166400
    buffer_load_dword v84, v242, s[12:15], s69 offen
    s_mov_b32 s76, 167680
    buffer_load_dword v108, v242, s[12:15], s76 offen
    s_mov_b32 s69, 176640
    buffer_load_dword v85, v242, s[12:15], s69 offen
    s_mov_b32 s76, 177920
    buffer_load_dword v109, v242, s[12:15], s76 offen
    s_mov_b32 s69, 204800
    buffer_load_dword v86, v242, s[12:15], s69 offen
    s_mov_b32 s76, 206080
    buffer_load_dword v110, v242, s[12:15], s76 offen
    s_mov_b32 s69, 215040
    buffer_load_dword v87, v242, s[12:15], s69 offen
    s_mov_b32 s76, 216320
    buffer_load_dword v111, v242, s[12:15], s76 offen
    s_mov_b32 s69, 207360
    buffer_load_dword v88, v242, s[12:15], s69 offen
    s_mov_b32 s76, 208640
    buffer_load_dword v112, v242, s[12:15], s76 offen
    s_mov_b32 s69, 217600
    buffer_load_dword v89, v242, s[12:15], s69 offen
    s_mov_b32 s76, 218880
    buffer_load_dword v113, v242, s[12:15], s76 offen
    s_waitcnt vmcnt(40)
    v_perm_b32 v6, v90, v66, s80
    v_perm_b32 v90, v90, v66, s81
    v_mov_b32 v66, v6
    v_perm_b32 v6, v91, v67, s80
    v_perm_b32 v91, v91, v67, s81
    v_mov_b32 v67, v6
    v_perm_b32 v6, v92, v68, s80
    v_perm_b32 v92, v92, v68, s81
    v_mov_b32 v68, v6
    v_perm_b32 v6, v93, v69, s80
    v_perm_b32 v93, v93, v69, s81
    v_mov_b32 v69, v6
    s_waitcnt vmcnt(32)
    v_perm_b32 v6, v94, v70, s80
    v_perm_b32 v94, v94, v70, s81
    v_mov_b32 v70, v6
    v_perm_b32 v6, v95, v71, s80
    v_perm_b32 v95, v95, v71, s81
    v_mov_b32 v71, v6
    v_perm_b32 v6, v96, v72, s80
    v_perm_b32 v96, v96, v72, s81
    v_mov_b32 v72, v6
    v_perm_b32 v6, v97, v73, s80
    v_perm_b32 v97, v97, v73, s81
    v_mov_b32 v73, v6
    s_waitcnt vmcnt(24)
    v_perm_b32 v6, v98, v74, s80
    v_perm_b32 v98, v98, v74, s81
    v_mov_b32 v74, v6
    v_perm_b32 v6, v99, v75, s80
    v_perm_b32 v99, v99, v75, s81
    v_mov_b32 v75, v6
    v_perm_b32 v6, v100, v76, s80
    v_perm_b32 v100, v100, v76, s81
    v_mov_b32 v76, v6
    v_perm_b32 v6, v101, v77, s80
    v_perm_b32 v101, v101, v77, s81
    v_mov_b32 v77, v6
    s_waitcnt vmcnt(16)
    v_perm_b32 v6, v102, v78, s80
    v_perm_b32 v102, v102, v78, s81
    v_mov_b32 v78, v6
    v_perm_b32 v6, v103, v79, s80
    v_perm_b32 v103, v103, v79, s81
    v_mov_b32 v79, v6
    v_perm_b32 v6, v104, v80, s80
    v_perm_b32 v104, v104, v80, s81
    v_mov_b32 v80, v6
    v_perm_b32 v6, v105, v81, s80
    v_perm_b32 v105, v105, v81, s81
    v_mov_b32 v81, v6
    s_waitcnt vmcnt(8)
    v_perm_b32 v6, v106, v82, s80
    v_perm_b32 v106, v106, v82, s81
    v_mov_b32 v82, v6
    v_perm_b32 v6, v107, v83, s80
    v_perm_b32 v107, v107, v83, s81
    v_mov_b32 v83, v6
    v_perm_b32 v6, v108, v84, s80
    v_perm_b32 v108, v108, v84, s81
    v_mov_b32 v84, v6
    v_perm_b32 v6, v109, v85, s80
    v_perm_b32 v109, v109, v85, s81
    v_mov_b32 v85, v6
    s_waitcnt vmcnt(0)
    v_perm_b32 v6, v110, v86, s80
    v_perm_b32 v110, v110, v86, s81
    v_mov_b32 v86, v6
    v_perm_b32 v6, v111, v87, s80
    v_perm_b32 v111, v111, v87, s81
    v_mov_b32 v87, v6
    v_perm_b32 v6, v112, v88, s80
    v_perm_b32 v112, v112, v88, s81
    v_mov_b32 v88, v6
    v_perm_b32 v6, v113, v89, s80
    v_perm_b32 v113, v113, v89, s81
    v_mov_b32 v89, v6
    s_cmp_eq_u32 s67, 0
    s_cselect_b32 s69, 0, 22528
    v_lshlrev_b32 v4, 4, v1
    v_add_u32 v4, s69, v4
    ds_write_b128 v4, v[66:69] offset:0
    ds_write_b128 v4, v[70:73] offset:1024
    ds_write_b128 v4, v[74:77] offset:2048
    ds_write_b128 v4, v[78:81] offset:3072
    ds_write_b128 v4, v[82:85] offset:4096
    ds_write_b128 v4, v[86:89] offset:5120
    ds_write_b128 v4, v[90:93] offset:6144
    ds_write_b128 v4, v[94:97] offset:7168
    ds_write_b128 v4, v[98:101] offset:8192
    ds_write_b128 v4, v[102:105] offset:9216
    ds_write_b128 v4, v[106:109] offset:10240
    ds_write_b128 v4, v[110:113] offset:11264
    s_waitcnt lgkmcnt(0)
Latnx_99:
    s_sub_u32 s69, s48, 3
    s_lshl_b32 s69, s69, 11
    v_lshlrev_b32 v242, 4, v1
    v_add_u32 v242, s69, v242
    v_lshlrev_b32 v243, 6, v2
    v_lshl_add_u32 v243, v3, 4, v243
    s_lshl_b32 s69, s67, 10
    s_add_u32 s69, s69, 6144
    v_lshlrev_b32 v244, 4, v2
    v_lshl_add_u32 v244, v3, 3, v244
    v_add_u32 v244, s69, v244
    v_lshlrev_b32 v247, 4, v1
    s_lshl_b32 s69, s67, 11
    v_add_u32 v249, s69, v247
    v_and_b32 v4, 7, v2
    v_lshlrev_b32 v248, 4, v4
    v_lshl_add_u32 v248, v3, 7, v248
    v_lshlrev_b32 v250, 2, v1
    v_add_u32 v5, 13312, v250
    v_add_u32 v250, 34816, v250
    v_cmp_gt_u32 vcc, 8, v1
    s_nop 1
    v_cndmask_b32 v250, v5, v250, vcc
    v_lshrrev_b32 v5, 1, v3
    v_lshlrev_b32 v245, 7, v5
    v_lshl_add_u32 v245, v4, 4, v245
    v_and_b32 v5, 1, v3
    v_lshl_add_u32 v245, v5, 3, v245
    v_lshrrev_b32 v5, 3, v2
    v_mul_u32_u24 v5, 3072, v5
    v_add_u32 v245, v245, v5
    s_lshl_b32 s69, s67, 10
    s_add_u32 s69, s69, 10240
    v_add_u32 v245, s69, v245
    s_lshl_b32 s69, s67, 10
    s_add_u32 s69, s69, 35840
    v_lshlrev_b32 v251, 7, v4
    v_lshl_add_u32 v251, v3, 3, v251
    v_add_u32 v251, s69, v251
    s_lshl_b32 s69, s52, 3
    v_add_u32 v5, s69, v4
    v_cmp_gt_u32 vcc, 8, v2
    v_mov_b32 v6, 31
    s_nop 1
    v_cndmask_b32 v5, v5, v6, vcc
    v_lshlrev_b32 v6, 2, v3
    v_sub_u32 v5, v5, v6
    v_mov_b32 v6, 0xf149f2ca
    v_cmp_gt_i32 vcc, 0, v5
    v_mov_b32 v186, 0
    s_nop 1
    v_cndmask_b32 v186, v186, v6, vcc
    v_cmp_gt_i32 vcc, 1, v5
    v_mov_b32 v187, 0
    s_nop 1
    v_cndmask_b32 v187, v187, v6, vcc
    v_cmp_gt_i32 vcc, 2, v5
    v_mov_b32 v188, 0
    s_nop 1
    v_cndmask_b32 v188, v188, v6, vcc
    v_cmp_gt_i32 vcc, 3, v5
    v_mov_b32 v189, 0
    s_nop 1
    v_cndmask_b32 v189, v189, v6, vcc
    v_cmp_gt_i32 vcc, 16, v5
    v_mov_b32 v190, 0
    s_nop 1
    v_cndmask_b32 v190, v190, v6, vcc
    v_cmp_gt_i32 vcc, 17, v5
    v_mov_b32 v191, 0
    s_nop 1
    v_cndmask_b32 v191, v191, v6, vcc
    v_cmp_gt_i32 vcc, 18, v5
    v_mov_b32 v192, 0
    s_nop 1
    v_cndmask_b32 v192, v192, v6, vcc
    v_cmp_gt_i32 vcc, 19, v5
    v_mov_b32 v193, 0
    s_nop 1
    v_cndmask_b32 v193, v193, v6, vcc
    v_cmp_lt_u32 vcc, 1, v3
    v_mov_b32 v194, 0
    s_nop 1
    v_cndmask_b32 v194, v194, v6, vcc
    v_mov_b32 v195, v194
    v_mov_b32 v196, v194
    v_mov_b32 v197, v194
    v_mov_b32 v236, 0x3f803f80
    v_mov_b32 v237, 0x3f803f80
    v_mov_b32 v238, 0x3f803f80
    v_mov_b32 v239, 0x3f803f80
    v_mov_b32 v138, 0
    v_mov_b32 v139, 0
    v_mov_b32 v140, 0
    v_mov_b32 v141, 0
    v_mov_b32 v142, 0
    v_mov_b32 v143, 0
    v_mov_b32 v144, 0
    v_mov_b32 v145, 0
    v_mov_b32 v146, 0
    v_mov_b32 v147, 0
    v_mov_b32 v148, 0
    v_mov_b32 v149, 0
    v_mov_b32 v150, 0
    v_mov_b32 v151, 0
    v_mov_b32 v152, 0
    v_mov_b32 v153, 0
    v_mov_b32 v154, 0
    v_mov_b32 v155, 0
    v_mov_b32 v156, 0
    v_mov_b32 v157, 0
    v_mov_b32 v158, 0
    v_mov_b32 v159, 0
    v_mov_b32 v160, 0
    v_mov_b32 v161, 0
    v_mov_b32 v178, 0
    v_mov_b32 v179, 0
    v_mov_b32 v180, 0
    v_mov_b32 v181, 0
    v_mov_b32 v182, 0
    v_mov_b32 v183, 0
    v_mov_b32 v184, 0
    v_mov_b32 v185, 0
    v_mov_b32 v58, 0
    v_mov_b32 v59, 0
    v_mov_b32 v60, 0
    v_mov_b32 v61, 0
    v_mov_b32 v62, 0
    v_mov_b32 v63, 0
    v_mov_b32 v64, 0
    v_mov_b32 v65, 0
    s_setprio 2
    s_barrier
    s_cmp_lg_u32 s48, 0
    s_cbranch_scc1 Lp0_100
    v_lshlrev_b32 v5, 2, v1
Lreg_101:
    buffer_load_dword v4, v5, s[8:11], 0 offen sc0 sc1
    s_waitcnt vmcnt(0)
    v_readlane_b32 s69, v4, 8
    v_readlane_b32 s76, v4, 32
    s_add_u32 s69, s69, s76
    s_cmp_ge_u32 s69, 640
    s_cbranch_scc1 Lregd_102
    s_sleep 24
    s_sub_u32 s54, s54, 1
    s_cbranch_scc0 Lreg_101
    s_mov_b32 s54, 0
Lregd_102:
    v_readlane_b32 s79, v4, 34
    v_cmp_ne_u32 vcc, 32, v4
    s_and_b32 s79, s79, 1
    s_and_b32 s69, vcc_lo, 0xf
    s_and_b32 s76, vcc_hi, 0xf00
    s_or_b32 s69, s69, s76
    s_cselect_b32 s53, 1, 0
    s_lshl_b32 s79, s79, 1
    s_or_b32 s79, s79, s53
    v_mov_b32 v4, s79
    v_mov_b32 v5, 34880
    ds_write_b32 v5, v4
    s_waitcnt lgkmcnt(0)
Lp0_100:
    s_barrier
    v_mov_b32 v5, 34880
    ds_read_b32 v4, v5
    s_waitcnt lgkmcnt(0)
    v_readfirstlane_b32 s79, v4
    s_and_b32 s53, s79, 1
    s_lshr_b32 s79, s79, 1
    s_and_b32 s69, s55, 3
    s_add_u32 s76, s55, 1
    s_and_b32 s76, s76, 3
    s_xor_b32 s77, s69, 2
    s_lshr_b32 s78, s49, 1
    s_mul_i32 s78, s78, 10240
    s_add_u32 s78, s78, 106954752
    s_mul_i32 s56, s76, 81920
    s_add_u32 s56, s56, s78
    s_mul_i32 s57, s77, 81920
    s_add_u32 s57, s57, s78
    s_mul_i32 s78, s51, 9216
    s_add_u32 s78, s78, 107282432
    s_mul_i32 s58, s69, 294912
    s_add_u32 s58, s58, s78
    s_mul_i32 s59, s77, 294912
    s_add_u32 s59, s59, s78
    s_and_b32 s69, s97, 255
    s_mul_i32 s76, s69, 86
    s_lshr_b32 s76, s76, 8
    s_mul_i32 s62, s69, 655360
    s_mul_i32 s77, s76, 131072
    s_add_u32 s62, s62, s77
    s_add_u32 s62, s62, 167772160
    s_xor_b32 s76, s79, s76
    s_and_b32 s76, s76, 1
    s_lshl_b32 s76, s76, 13
    s_add_u32 s62, s62, s76
    s_lshl_b32 s78, s51, 8
    s_add_u32 s60, s62, s78
    s_lshl_b32 s95, s97, 8
    s_and_b32 s95, s95, 0x10000
    s_xor_b32 s94, s95, 0x10000
    s_mul_i32 s63, s55, 393216
    s_add_u32 s63, s63, 75497472
    s_barrier
    s_mov_b32 s66, 38912
    v_add_u32 v4, s66, v247
    v_add_u32 v5, s66, v248
    s_lshl_b32 s69, s67, 12
    v_add_u32 v6, s69, v4
    ds_read_b128 v[66:69], v4 offset:0
    ds_read_b128 v[70:73], v4 offset:1024
    ds_read_b128 v[74:77], v4 offset:2048
    ds_read_b128 v[78:81], v4 offset:3072
    ds_read_b128 v[82:85], v4 offset:4096
    ds_read_b128 v[86:89], v4 offset:5120
    ds_read_b128 v[90:93], v4 offset:6144
    ds_read_b128 v[94:97], v4 offset:7168
    ds_read_b128 v[98:101], v4 offset:8192
    ds_read_b128 v[102:105], v4 offset:9216
    ds_read_b128 v[106:109], v4 offset:10240
    ds_read_b128 v[110:113], v4 offset:11264
    ds_read_b128 v[114:117], v5 offset:24576
    ds_read_b128 v[118:121], v5 offset:25088
    ds_read_b128 v[122:125], v5 offset:25600
    ds_read_b128 v[126:129], v5 offset:26112
    ds_read_b128 v[130:133], v5 offset:26624
    ds_read_b128 v[134:137], v5 offset:27136
    ds_read_b128 v[162:165], v6 offset:12288
    ds_read_b128 v[166:169], v6 offset:13312
    ds_read_b128 v[170:173], v6 offset:14336
    ds_read_b128 v[174:177], v6 offset:15360
    s_lshr_b32 s96, s49, 1
    s_mul_i32 s96, s96, 10240
    s_add_u32 s96, s96, 106954752
    s_barrier
    buffer_load_dwordx4 v[198:201], v242, s[4:7], s96 offen sc1
    buffer_load_dwordx4 v[202:205], v242, s[4:7], s96 offen offset:1024 sc1
    s_waitcnt vmcnt(0)
    ds_write_b128 v242, v[198:201] offset:0
    ds_write_b128 v242, v[202:205] offset:1024
    v_max3_u32 v4, v198, v199, v200
    v_max3_u32 v5, v201, v202, v203
    v_max3_u32 v4, v4, v204, v205
    v_max_u32 v4, v4, v5
    v_cmp_eq_u32 vcc, -1, v4
    s_cbranch_vccnz Lp_103
    s_waitcnt lgkmcnt(0)
    s_barrier
Lpok_104:
Lat_105:
    s_barrier
    s_sleep 1
    buffer_load_dwordx4 v[216:219], v249, s[4:7], s58 offen sc1
    buffer_load_dwordx4 v[220:223], v249, s[4:7], s58 offen offset:1024 sc1
    s_sleep 1
    buffer_load_dwordx4 v[224:227], v249, s[4:7], s58 offen sc1
    buffer_load_dwordx4 v[228:231], v249, s[4:7], s58 offen offset:1024 sc1
    s_waitcnt vmcnt(2)
    ds_write_b128 v249, v[216:219] offset:16384
    ds_write_b128 v249, v[220:223] offset:17408
    v_max3_u32 v4, v216, v217, v218
    v_max3_u32 v5, v219, v220, v221
    v_max3_u32 v4, v4, v222, v223
    v_max_u32 v4, v4, v5
    v_cmp_eq_u32 vcc, -1, v4
    s_cbranch_vccnz Lp_112
    s_mov_b64 exec, s[70:71]
    s_waitcnt lgkmcnt(0)
    s_barrier
Lpok_113:
    ds_read_b128 v[114:117], v243 offset:16384
    ds_read_b128 v[118:121], v243 offset:16896
    ds_read_b128 v[122:125], v243 offset:17408
    ds_read_b128 v[126:129], v243 offset:17920
    ds_read_b128 v[130:133], v243 offset:18432
    ds_read_b128 v[134:137], v243 offset:18944
    ds_read_b128 v[138:141], v243 offset:19456
    ds_read_b128 v[142:145], v243 offset:19968
    ds_read_b128 v[146:149], v243 offset:20480
    ds_read_b128 v[150:153], v243 offset:20992
    ds_read_b128 v[154:157], v243 offset:21504
    ds_read_b128 v[158:161], v243 offset:22016
    s_mov_b64 exec, s[72:73]
    buffer_load_dwordx2 v[178:179], v244, s[4:7], s58 offen offset:0 sc1
    buffer_load_dwordx2 v[180:181], v244, s[4:7], s58 offen offset:256 sc1
    buffer_load_dwordx2 v[182:183], v244, s[4:7], s58 offen offset:512 sc1
    buffer_load_dwordx2 v[184:185], v244, s[4:7], s58 offen offset:768 sc1
    s_mov_b64 exec, -1
    s_waitcnt lgkmcnt(11)
    v_mfma_f32_16x16x32_bf16 v[198:201], v[66:69], v[114:117], v[186:189]
    v_mfma_f32_16x16x32_bf16 v[202:205], v[90:93], v[114:117], v[190:193]
    s_waitcnt lgkmcnt(10)
    v_mfma_f32_16x16x32_bf16 v[198:201], v[70:73], v[118:121], v[198:201]
    v_mfma_f32_16x16x32_bf16 v[202:205], v[94:97], v[118:121], v[202:205]
    s_waitcnt lgkmcnt(9)
    v_mfma_f32_16x16x32_bf16 v[198:201], v[74:77], v[122:125], v[198:201]
    v_mfma_f32_16x16x32_bf16 v[202:205], v[98:101], v[122:125], v[202:205]
    s_waitcnt lgkmcnt(8)
    v_mfma_f32_16x16x32_bf16 v[198:201], v[78:81], v[126:129], v[198:201]
    v_mfma_f32_16x16x32_bf16 v[202:205], v[102:105], v[126:129], v[202:205]
    s_waitcnt lgkmcnt(7)
    v_mfma_f32_16x16x32_bf16 v[198:201], v[82:85], v[130:133], v[198:201]
    v_mfma_f32_16x16x32_bf16 v[202:205], v[106:109], v[130:133], v[202:205]
    s_waitcnt lgkmcnt(6)
    v_mfma_f32_16x16x32_bf16 v[198:201], v[86:89], v[134:137], v[198:201]
    v_mfma_f32_16x16x32_bf16 v[202:205], v[110:113], v[134:137], v[202:205]
    s_waitcnt lgkmcnt(0)
    v_mfma_f32_16x16x32_bf16 v[206:209], v[138:141], v[114:117], v[194:197]
    v_mfma_f32_16x16x32_bf16 v[206:209], v[142:145], v[118:121], v[206:209]
    v_mfma_f32_16x16x32_bf16 v[206:209], v[146:149], v[122:125], v[206:209]
    v_mfma_f32_16x16x32_bf16 v[206:209], v[150:153], v[126:129], v[206:209]
    s_waitcnt vmcnt(4)
    v_mfma_f32_16x16x32_bf16 v[206:209], v[154:157], v[130:133], v[206:209]
    v_max3_f32 v4, v198, v199, v200
    v_max3_f32 v5, v201, v202, v203
    v_mfma_f32_16x16x32_bf16 v[206:209], v[158:161], v[134:137], v[206:209]
    v_max3_f32 v4, v4, v204, v205
    v_max_f32 v4, v4, v5
    s_nop 5
    v_max3_f32 v5, v206, v207, v208
    v_max3_f32 v4, v4, v5, v209
    v_mov_b32 v5, v4
    s_nop 1
    v_permlane32_swap_b32 v4, v5
    v_max_f32 v4, v4, v5
    v_mov_b32 v5, v4
    s_nop 1
    v_permlane16_swap_b32 v4, v5
    v_max_f32 v4, v4, v5
    v_mul_f32 v8, s68, v4
    v_pk_fma_f32 v[198:199], v[198:199], s[68:69], v[8:9] op_sel_hi:[1,0,0] neg_lo:[0,0,1] neg_hi:[0,0,1]
    v_pk_fma_f32 v[200:201], v[200:201], s[68:69], v[8:9] op_sel_hi:[1,0,0] neg_lo:[0,0,1] neg_hi:[0,0,1]
    v_pk_fma_f32 v[202:203], v[202:203], s[68:69], v[8:9] op_sel_hi:[1,0,0] neg_lo:[0,0,1] neg_hi:[0,0,1]
    v_pk_fma_f32 v[204:205], v[204:205], s[68:69], v[8:9] op_sel_hi:[1,0,0] neg_lo:[0,0,1] neg_hi:[0,0,1]
    v_exp_f32 v198, v198
    v_exp_f32 v199, v199
    v_exp_f32 v200, v200
    v_exp_f32 v201, v201
    v_exp_f32 v202, v202
    v_exp_f32 v203, v203
    v_exp_f32 v204, v204
    v_exp_f32 v205, v205
    v_pk_fma_f32 v[206:207], v[206:207], s[68:69], v[8:9] op_sel_hi:[1,0,0] neg_lo:[0,0,1] neg_hi:[0,0,1]
    v_pk_fma_f32 v[208:209], v[208:209], s[68:69], v[8:9] op_sel_hi:[1,0,0] neg_lo:[0,0,1] neg_hi:[0,0,1]
    v_cvt_pk_bf16_f32 v210, v198, v199
    v_cvt_pk_bf16_f32 v211, v200, v201
    v_cvt_pk_bf16_f32 v212, v202, v203
    v_cvt_pk_bf16_f32 v213, v204, v205
    v_exp_f32 v206, v206
    v_exp_f32 v207, v207
    v_mfma_f32_16x16x32_bf16 v[232:235], v[236:239], v[210:213], 0
    v_exp_f32 v208, v208
    v_mfma_f32_16x16x32_bf16 v[216:219], v[162:165], v[210:213], 0
    v_exp_f32 v209, v209
    v_mfma_f32_16x16x32_bf16 v[220:223], v[166:169], v[210:213], 0
    v_cvt_pk_bf16_f32 v214, v206, v207
    v_cvt_pk_bf16_f32 v215, v208, v209
    v_mfma_f32_16x16x32_bf16 v[224:227], v[170:173], v[210:213], 0
LpV_109:
    s_waitcnt vmcnt(0)
    v_max3_u32 v5, v178, v179, v180
    v_max3_u32 v6, v181, v182, v183
    v_mfma_f32_16x16x32_bf16 v[228:231], v[174:177], v[210:213], 0
    v_max3_u32 v5, v5, v184, v185
    v_max_u32 v5, v5, v6
    v_cmp_eq_u32 vcc, -1, v5
    s_cbranch_vccnz LpVr_111
LpVok_110:
    v_mfma_f32_16x16x16_bf16 v[232:235], v[236:237], v[214:215], v[232:235]
    v_mfma_f32_16x16x16_bf16 v[216:219], v[178:179], v[214:215], v[216:219]
    v_mfma_f32_16x16x16_bf16 v[220:223], v[180:181], v[214:215], v[220:223]
    v_mfma_f32_16x16x16_bf16 v[224:227], v[182:183], v[214:215], v[224:227]
    v_mfma_f32_16x16x16_bf16 v[228:231], v[184:185], v[214:215], v[228:231]
    s_nop 3
    v_rcp_f32 v232, v232
    v_cvt_pk_bf16_f32 v114, v216, v217
    v_cvt_pk_bf16_f32 v115, v218, v219
    ds_write_b64 v245, v[114:115] offset:0
    ds_write_b32 v250, v232
    v_cvt_pk_bf16_f32 v116, v220, v221
    v_cvt_pk_bf16_f32 v117, v222, v223
    ds_write_b64 v245, v[116:117] offset:256
    v_cvt_pk_bf16_f32 v118, v224, v225
    v_cvt_pk_bf16_f32 v119, v226, v227
    ds_write_b64 v245, v[118:119] offset:512
    v_cvt_pk_bf16_f32 v120, v228, v229
    v_cvt_pk_bf16_f32 v121, v230, v231
    ds_write_b64 v245, v[120:121] offset:768
    s_waitcnt lgkmcnt(0)
    s_barrier
    ds_read_b128 v[198:201], v240 offset:10240
    ds_read_b128 v[202:205], v240 offset:11264
    ds_read_b128 v[206:209], v240 offset:12288
    v_lshlrev_b32 v4, 3, v3
    ds_read_b64 v[210:211], v4 offset:34816
    s_cmp_eq_u32 s55, 63
    s_cbranch_scc1 Latsk_114
    s_waitcnt lgkmcnt(3)
    v_smfmac_f32_16x16x64_bf16 v[58:61], v[198:201], v[10:17], v241
    v_smfmac_f32_16x16x64_bf16 v[62:65], v[198:201], v[34:41], v241
    s_waitcnt lgkmcnt(2)
    v_smfmac_f32_16x16x64_bf16 v[58:61], v[202:205], v[18:25], v241
    v_smfmac_f32_16x16x64_bf16 v[62:65], v[202:205], v[42:49], v241
    s_waitcnt lgkmcnt(1)
    v_smfmac_f32_16x16x64_bf16 v[58:61], v[206:209], v[26:33], v241
    v_smfmac_f32_16x16x64_bf16 v[62:65], v[206:209], v[50:57], v241
    s_waitcnt lgkmcnt(0)
    s_nop 5
    v_pk_add_f32 v[58:59], v[58:59], v[60:61]
    v_pk_add_f32 v[64:65], v[62:63], v[64:65]
    v_pk_mul_f32 v[58:59], v[58:59], v[210:211]
    v_pk_mul_f32 v[64:65], v[64:65], v[210:211]
    v_add_u32 v58, s94, v58
    v_add_u32 v59, s94, v59
    v_and_or_b32 v58, v58, v0, s95
    v_and_or_b32 v59, v59, v0, s95
    v_cvt_pk_bf16_f32 v58, v58, v64
    v_cvt_pk_bf16_f32 v62, v59, v65
    buffer_store_dword v58, v246, s[4:7], s60 offen offset:0 sc1
    buffer_store_dword v62, v246, s[4:7], s60 offen offset:128 sc1
Latsk_114:
    v_mul_f32 v216, v216, v232
    v_mul_f32 v217, v217, v232
    v_mul_f32 v218, v218, v232
    v_mul_f32 v219, v219, v232
    v_cvt_pk_bf16_f32 v216, v216, v217
    v_cvt_pk_bf16_f32 v217, v218, v219
    v_mul_f32 v220, v220, v232
    v_mul_f32 v221, v221, v232
    v_mul_f32 v222, v222, v232
    v_mul_f32 v223, v223, v232
    v_cvt_pk_bf16_f32 v220, v220, v221
    v_cvt_pk_bf16_f32 v221, v222, v223
    v_mul_f32 v224, v224, v232
    v_mul_f32 v225, v225, v232
    v_mul_f32 v226, v226, v232
    v_mul_f32 v227, v227, v232
    v_cvt_pk_bf16_f32 v224, v224, v225
    v_cvt_pk_bf16_f32 v225, v226, v227
    v_mul_f32 v228, v228, v232
    v_mul_f32 v229, v229, v232
    v_mul_f32 v230, v230, v232
    v_mul_f32 v231, v231, v232
    v_cvt_pk_bf16_f32 v228, v228, v229
    v_cvt_pk_bf16_f32 v229, v230, v231
    s_mov_b64 exec, s[74:75]
    ds_write_b64 v251, v[216:217] offset:0
    ds_write_b64 v251, v[220:221] offset:32
    ds_write_b64 v251, v[224:225] offset:64
    ds_write_b64 v251, v[228:229] offset:96
    s_mov_b64 exec, -1
    s_cmp_eq_u32 s55, 63
    s_cbranch_scc1 Latend_106
    s_add_u32 s66, s66, 27648
    s_cmp_eq_u32 s66, 121856
    s_cselect_b32 s66, 38912, s66
    v_add_u32 v4, s66, v247
    v_add_u32 v5, s66, v248
    s_lshl_b32 s69, s67, 12
    v_add_u32 v6, s69, v4
    ds_read_b128 v[66:69], v4 offset:0
    ds_read_b128 v[70:73], v4 offset:1024
    ds_read_b128 v[74:77], v4 offset:2048
    ds_read_b128 v[78:81], v4 offset:3072
    ds_read_b128 v[82:85], v4 offset:4096
    ds_read_b128 v[86:89], v4 offset:5120
    ds_read_b128 v[90:93], v4 offset:6144
    ds_read_b128 v[94:97], v4 offset:7168
    ds_read_b128 v[98:101], v4 offset:8192
    ds_read_b128 v[102:105], v4 offset:9216
    ds_read_b128 v[106:109], v4 offset:10240
    ds_read_b128 v[110:113], v4 offset:11264
    ds_read_b128 v[114:117], v5 offset:24576
    ds_read_b128 v[118:121], v5 offset:25088
    ds_read_b128 v[122:125], v5 offset:25600
    ds_read_b128 v[126:129], v5 offset:26112
    ds_read_b128 v[130:133], v5 offset:26624
    ds_read_b128 v[134:137], v5 offset:27136
    ds_read_b128 v[162:165], v6 offset:12288
    ds_read_b128 v[166:169], v6 offset:13312
    ds_read_b128 v[170:173], v6 offset:14336
    ds_read_b128 v[174:177], v6 offset:15360
    v_mov_b32 v58, 0
    v_mov_b32 v59, 0
    v_mov_b32 v60, 0
    v_mov_b32 v61, 0
    v_mov_b32 v62, 0
    v_mov_b32 v63, 0
    v_mov_b32 v64, 0
    v_mov_b32 v65, 0
    s_mov_b32 s96, s56
    s_add_u32 s55, s55, 1
    s_add_u32 s97, s97, 1
    s_and_b32 s69, s97, 255
    s_xor_b32 s76, s97, 265
    s_cmp_eq_u32 s69, 9
    s_cselect_b32 s97, s76, s97
    s_and_b32 s69, s55, 3
    s_add_u32 s76, s55, 1
    s_and_b32 s76, s76, 3
    s_xor_b32 s77, s69, 2
    s_lshr_b32 s78, s49, 1
    s_mul_i32 s78, s78, 10240
    s_add_u32 s78, s78, 106954752
    s_mul_i32 s56, s76, 81920
    s_add_u32 s56, s56, s78
    s_mul_i32 s57, s77, 81920
    s_add_u32 s57, s57, s78
    s_mul_i32 s78, s51, 9216
    s_add_u32 s78, s78, 107282432
    s_mul_i32 s58, s69, 294912
    s_add_u32 s58, s58, s78
    s_mul_i32 s59, s77, 294912
    s_add_u32 s59, s59, s78
    s_and_b32 s69, s97, 255
    s_mul_i32 s76, s69, 86
    s_lshr_b32 s76, s76, 8
    s_mul_i32 s62, s69, 655360
    s_mul_i32 s77, s76, 131072
    s_add_u32 s62, s62, s77
    s_add_u32 s62, s62, 167772160
    s_xor_b32 s76, s79, s76
    s_and_b32 s76, s76, 1
    s_lshl_b32 s76, s76, 13
    s_add_u32 s62, s62, s76
    s_lshl_b32 s78, s51, 8
    s_add_u32 s60, s62, s78
    s_lshl_b32 s95, s97, 8
    s_and_b32 s95, s95, 0x10000
    s_xor_b32 s94, s95, 0x10000
    s_mul_i32 s63, s55, 393216
    s_add_u32 s63, s63, 75497472
    s_barrier
    buffer_load_dwordx4 v[198:201], v242, s[4:7], s96 offen sc1
    buffer_load_dwordx4 v[202:205], v242, s[4:7], s96 offen offset:1024 sc1
    s_sleep 1
    buffer_load_dwordx4 v[216:219], v242, s[4:7], s96 offen sc1
    buffer_load_dwordx4 v[220:223], v242, s[4:7], s96 offen offset:1024 sc1
    s_waitcnt vmcnt(2)
    ds_write_b128 v242, v[198:201] offset:0
    ds_write_b128 v242, v[202:205] offset:1024
    v_max3_u32 v4, v198, v199, v200
    v_max3_u32 v5, v201, v202, v203
    v_max3_u32 v4, v4, v204, v205
    v_max_u32 v4, v4, v5
    v_cmp_eq_u32 vcc, -1, v4
    s_cbranch_vccnz Lp_115
    s_waitcnt lgkmcnt(0)
    s_barrier
Lpok_116:
    s_branch Lat_105
Latend_106:
    s_waitcnt lgkmcnt(0)
    s_barrier
    s_endpgm
LpVr_111:
    s_mov_b64 exec, s[72:73]
    buffer_load_dwordx2 v[178:179], v244, s[4:7], s58 offen offset:0 sc1
    buffer_load_dwordx2 v[180:181], v244, s[4:7], s58 offen offset:256 sc1
    buffer_load_dwordx2 v[182:183], v244, s[4:7], s58 offen offset:512 sc1
    buffer_load_dwordx2 v[184:185], v244, s[4:7], s58 offen offset:768 sc1
    s_mov_b64 exec, -1
    s_sub_u32 s54, s54, 1
    s_cbranch_scc0 LpV_109
    s_mov_b32 s54, 0
    s_branch LpVok_110
Lp_103:
    s_mov_b64 exec, vcc
    buffer_load_dwordx4 v[198:201], v242, s[4:7], s96 offen sc1
    buffer_load_dwordx4 v[202:205], v242, s[4:7], s96 offen offset:1024 sc1
    s_waitcnt vmcnt(0)
    ds_write_b128 v242, v[198:201] offset:0
    ds_write_b128 v242, v[202:205] offset:1024
    v_max3_u32 v4, v198, v199, v200
    v_max3_u32 v5, v201, v202, v203
    v_max3_u32 v4, v4, v204, v205
    v_max_u32 v4, v4, v5
    v_cmp_eq_u32 vcc, -1, v4
    s_cbranch_vccnz Lpn_117
    s_mov_b64 exec, -1
    s_waitcnt lgkmcnt(0)
    s_barrier
    s_branch Lpok_104
Lpn_117:
    s_sub_u32 s54, s54, 1
    s_cbranch_scc0 Lp_103
    s_mov_b32 s54, 0
    s_mov_b64 exec, -1
    s_waitcnt lgkmcnt(0)
    s_barrier
    s_branch Lpok_104
Lp_112:
    s_mov_b64 exec, vcc
    buffer_load_dwordx4 v[216:219], v249, s[4:7], s58 offen sc1
    buffer_load_dwordx4 v[220:223], v249, s[4:7], s58 offen offset:1024 sc1
    s_waitcnt vmcnt(2)
    ds_write_b128 v249, v[224:227] offset:16384
    ds_write_b128 v249, v[228:231] offset:17408
    v_max3_u32 v4, v224, v225, v226
    v_max3_u32 v5, v227, v228, v229
    v_max3_u32 v4, v4, v230, v231
    v_max_u32 v4, v4, v5
    v_cmp_eq_u32 vcc, -1, v4
    s_cbranch_vccnz Lpn_118
    s_mov_b64 exec, -1
    s_mov_b64 exec, s[70:71]
    s_waitcnt lgkmcnt(0)
    s_barrier
    s_branch Lpok_113
Lpn_118:
    s_mov_b64 exec, vcc
    buffer_load_dwordx4 v[224:227], v249, s[4:7], s58 offen sc1
    buffer_load_dwordx4 v[228:231], v249, s[4:7], s58 offen offset:1024 sc1
    s_waitcnt vmcnt(2)
    ds_write_b128 v249, v[216:219] offset:16384
    ds_write_b128 v249, v[220:223] offset:17408
    v_max3_u32 v4, v216, v217, v218
    v_max3_u32 v5, v219, v220, v221
    v_max3_u32 v4, v4, v222, v223
    v_max_u32 v4, v4, v5
    v_cmp_eq_u32 vcc, -1, v4
    s_cbranch_vccnz Lpn_119
    s_mov_b64 exec, -1
    s_mov_b64 exec, s[70:71]
    s_waitcnt lgkmcnt(0)
    s_barrier
    s_branch Lpok_113
Lpn_119:
    s_sub_u32 s54, s54, 1
    s_cbranch_scc0 Lp_112
    s_mov_b32 s54, 0
    s_mov_b64 exec, -1
    s_mov_b64 exec, s[70:71]
    s_waitcnt lgkmcnt(0)
    s_barrier
    s_branch Lpok_113
Lp_115:
    s_mov_b64 exec, vcc
    buffer_load_dwordx4 v[198:201], v242, s[4:7], s96 offen sc1
    buffer_load_dwordx4 v[202:205], v242, s[4:7], s96 offen offset:1024 sc1
    s_waitcnt vmcnt(2)
    ds_write_b128 v242, v[216:219] offset:0
    ds_write_b128 v242, v[220:223] offset:1024
    v_max3_u32 v4, v216, v217, v218
    v_max3_u32 v5, v219, v220, v221
    v_max3_u32 v4, v4, v222, v223
    v_max_u32 v4, v4, v5
    v_cmp_eq_u32 vcc, -1, v4
    s_cbranch_vccnz Lpn_120
    s_mov_b64 exec, -1
    s_waitcnt lgkmcnt(0)
    s_barrier
    s_branch Lpok_116
Lpn_120:
    s_mov_b64 exec, vcc
    buffer_load_dwordx4 v[216:219], v242, s[4:7], s96 offen sc1
    buffer_load_dwordx4 v[220:223], v242, s[4:7], s96 offen offset:1024 sc1
    s_waitcnt vmcnt(2)
    ds_write_b128 v242, v[198:201] offset:0
    ds_write_b128 v242, v[202:205] offset:1024
    v_max3_u32 v4, v198, v199, v200
    v_max3_u32 v5, v201, v202, v203
    v_max3_u32 v4, v4, v204, v205
    v_max_u32 v4, v4, v5
    v_cmp_eq_u32 vcc, -1, v4
    s_cbranch_vccnz Lpn_121
    s_mov_b64 exec, -1
    s_waitcnt lgkmcnt(0)
    s_barrier
    s_branch Lpok_116
Lpn_121:
    s_sub_u32 s54, s54, 1
    s_cbranch_scc0 Lp_115
    s_mov_b32 s54, 0
    s_mov_b64 exec, -1
    s_waitcnt lgkmcnt(0)
    s_barrier
    s_branch Lpok_116
Lworker:
    v_and_b32 v180, 63, v0
    v_mov_b32 v187, 1
    v_mov_b32 v188, 0
    s_mov_b32 s56, s16
    s_mov_b32 s57, s17
    s_mov_b32 s58, 2621440
    s_mov_b32 s59, 0x20000
    s_mov_b32 s60, s20
    s_mov_b32 s61, s21
    s_mov_b32 s63, 0x20000
    s_mov_b32 s67, 0
    s_mov_b32 s66, 0
    s_mov_b32 s65, 0
    s_mov_b32 s100, 0
    s_mov_b32 s101, 0
    s_mov_b32 s97, 0
    s_mov_b32 s72, 0
    s_mov_b32 s80, 0
    s_mov_b32 s98, 0xc0135761
    s_mov_b32 s99, 0xbdd2d3e8
    s_lshl_b32 s74, s48, 12
    s_mul_i32 s75, s48, 3072
    s_add_u32 s75, s75, 65536
    s_sub_u32 s64, s50, 16
    v_lshrrev_b32 v178, 2, v180
    v_and_b32 v179, 3, v180
    v_lshlrev_b32 v179, 4, v179
    v_lshrrev_b32 v181, 4, v180
    v_add_u32 v181, 0, v181
    v_and_b32 v182, 7, v180
    v_xor_b32 v181, v181, v182
    v_lshlrev_b32 v181, 4, v181
    v_lshrrev_b32 v182, 3, v180
    v_mul_u32_u24 v182, 1280, v182
    v_add_u32 v154, v181, v182
    v_lshrrev_b32 v181, 4, v180
    v_add_u32 v181, 4, v181
    v_and_b32 v182, 7, v180
    v_xor_b32 v181, v181, v182
    v_lshlrev_b32 v181, 4, v181
    v_lshrrev_b32 v182, 3, v180
    v_mul_u32_u24 v182, 1280, v182
    v_add_u32 v155, v181, v182
    v_and_b32 v181, 31, v180
    v_bfe_u32 v182, v180, 1, 3
    v_lshrrev_b32 v183, 5, v180
    v_xor_b32 v182, v182, v183
    s_lshr_b32 s69, s48, 1
    s_lshl_b32 s69, s69, 13
    s_lshl_b32 s76, s48, 12
    v_xor_b32 v183, 0, v182
    v_lshlrev_b32 v183, 4, v183
    v_lshl_add_u32 v183, v181, 7, v183
    v_add_u32 v158, s69, v183
    v_add_u32 v166, s76, v183
    v_add_u32 v162, 32768, v158
    v_add_u32 v170, 32768, v166
    v_xor_b32 v183, 2, v182
    v_lshlrev_b32 v183, 4, v183
    v_lshl_add_u32 v183, v181, 7, v183
    v_add_u32 v159, s69, v183
    v_add_u32 v167, s76, v183
    v_add_u32 v163, 32768, v159
    v_add_u32 v171, 32768, v167
    v_xor_b32 v183, 4, v182
    v_lshlrev_b32 v183, 4, v183
    v_lshl_add_u32 v183, v181, 7, v183
    v_add_u32 v160, s69, v183
    v_add_u32 v168, s76, v183
    v_add_u32 v164, 32768, v160
    v_add_u32 v172, 32768, v168
    v_xor_b32 v183, 6, v182
    v_lshlrev_b32 v183, 4, v183
    v_lshl_add_u32 v183, v181, 7, v183
    v_add_u32 v161, s69, v183
    v_add_u32 v169, s76, v183
    v_add_u32 v165, 32768, v161
    v_add_u32 v173, 32768, v169
    v_lshrrev_b32 v181, 5, v180
    v_lshlrev_b32 v181, 9, v181
    v_bfe_u32 v182, v180, 2, 2
    v_lshl_add_u32 v181, v182, 6, v181
    v_bfe_u32 v182, v180, 4, 1
    v_lshl_add_u32 v181, v182, 5, v181
    v_and_b32 v182, 3, v180
    v_lshl_add_u32 v181, v182, 3, v181
    v_add_u32 v175, 65536, v181
    s_and_b32 s69, s48, 1
    s_mul_i32 s69, s69, 12288
    v_add_u32 v174, s69, v175
    v_and_b32 v181, 15, v180
    v_lshlrev_b32 v181, 4, v181
    v_lshrrev_b32 v182, 5, v180
    v_lshl_add_u32 v181, v182, 8, v181
    v_bfe_u32 v182, v180, 4, 1
    s_lshr_b32 s69, s48, 1
    s_and_b32 s76, s48, 1
    s_mul_i32 s69, s69, 24576
    v_mul_u32_u24 v184, 6144, v182
    v_add_u32 v184, v184, v181
    s_mul_i32 s78, s76, 3072
    s_add_u32 s77, s69, s78
    v_add_u32 v184, s77, v184
    v_lshl_add_u32 v185, v182, 10, v181
    s_mul_i32 s78, s76, 6144
    s_add_u32 s77, s69, s78
    v_add_u32 v185, s77, v185
    v_mul_u32_u24 v186, 49152, v182
    v_add_u32 v186, v186, v181
    s_mul_i32 s77, s48, 98304
    v_add_u32 v186, s77, v186
    s_cmp_ge_u32 s64, 112
    s_cbranch_scc1 Ldn_123
    s_cmp_ge_u32 s64, 96
    s_cbranch_scc1 Ldf_122
    s_mul_i32 s69, s64, 43691
    s_lshr_b32 s69, s69, 19
    s_mul_i32 s76, s69, 12
    s_sub_u32 s76, s64, s76
    s_lshr_b32 s71, s76, 2
    s_and_b32 s76, s76, 3
    s_lshl_b32 s77, s49, 2
    s_add_u32 s76, s76, s77
    s_mul_i32 s100, s69, 327680
    s_mul_i32 s66, s76, 384
    s_mov_b32 s67, 12288
    s_cmp_eq_u32 s71, 1
    s_cselect_b32 s60, s22, s20
    s_cselect_b32 s61, s23, s21
    s_cmp_eq_u32 s71, 2
    s_cselect_b32 s60, s24, s60
    s_cselect_b32 s61, s25, s61
    s_mov_b32 s62, 7864320
    s_mul_i32 s72, s71, 25165824
    s_mul_i32 s77, s76, 786432
    s_add_u32 s72, s72, s77
    s_mul_i32 s77, s69, 98304
    s_add_u32 s72, s72, s77
    s_mul_i32 s77, s48, 3
    s_lshr_b32 s78, s77, 2
    s_branch Ldd_124
Ldf_122:
    s_sub_u32 s76, s64, 96
    s_lshr_b32 s69, s76, 1
    s_and_b32 s76, s76, 1
    s_mov_b32 s71, 3
    s_mul_i32 s100, s69, 327680
    s_mul_i32 s66, s49, 384
    s_mul_i32 s77, s76, 192
    s_add_u32 s66, s66, s77
    s_mov_b32 s67, 3072
    s_cmp_ge_u32 s48, 4
    s_cselect_b32 s60, s34, s32
    s_cselect_b32 s61, s35, s33
    s_mov_b32 s62, 1966080
    s_mul_i32 s72, s69, 786432
    s_lshl_b32 s77, s66, 4
    s_add_u32 s72, s72, s77
    s_add_u32 s72, s72, 100663296
    s_and_b32 s77, s48, 3
    s_mul_i32 s77, s77, 3
    s_lshr_b32 s78, s77, 2
    s_branch Ldd_124
Ldn_123:
    s_mov_b32 s71, 4
    s_mov_b32 s62, 0
    s_mov_b32 s77, 0
    s_mov_b32 s78, 0
Ldd_124:
    s_add_u32 s69, s77, 0
    s_lshr_b32 s76, s69, 2
    s_and_b32 s69, s69, 3
    s_lshl_b32 s69, s69, 4
    s_mul_i32 s69, s69, s67
    s_lshl_b32 s76, s76, 6
    s_add_u32 s69, s69, s76
    s_add_u32 s94, s69, s66
    s_add_u32 s69, s77, 1
    s_lshr_b32 s76, s69, 2
    s_and_b32 s69, s69, 3
    s_lshl_b32 s69, s69, 4
    s_mul_i32 s69, s69, s67
    s_lshl_b32 s76, s76, 6
    s_add_u32 s69, s69, s76
    s_add_u32 s95, s69, s66
    s_add_u32 s69, s77, 2
    s_lshr_b32 s76, s69, 2
    s_and_b32 s69, s69, 3
    s_lshl_b32 s69, s69, 4
    s_mul_i32 s69, s69, s67
    s_lshl_b32 s76, s76, 6
    s_add_u32 s69, s69, s76
    s_add_u32 s96, s69, s66
    s_mul_i32 s69, s48, 40960
    s_add_u32 s100, s100, s69
    s_lshl_b32 s47, s67, 6
    v_mul_lo_u32 v156, v178, s67
    v_add_u32 v156, v156, v179
    s_mov_b32 s65, s100
    s_add_u32 m0, s74, 0
    s_nop 0
    buffer_load_dwordx4 v154, s[56:59], s65 offen lds
    s_add_u32 m0, s74, 1024
    s_add_u32 s69, s65, 10240
    buffer_load_dwordx4 v155, s[56:59], s69 offen lds
    s_add_u32 m0, s74, 2048
    s_add_u32 s69, s65, 20480
    buffer_load_dwordx4 v154, s[56:59], s69 offen lds
    s_add_u32 m0, s74, 3072
    s_add_u32 s69, s65, 30720
    buffer_load_dwordx4 v155, s[56:59], s69 offen lds
    s_add_u32 s65, s65, 128
    s_add_u32 s76, s75, s97
    s_add_u32 m0, s76, 0
    s_nop 0
    buffer_load_dwordx4 v156, s[60:63], s94 offen lds
    s_add_u32 s94, s94, s47
    s_add_u32 m0, s76, 1024
    s_nop 0
    buffer_load_dwordx4 v156, s[60:63], s95 offen lds
    s_add_u32 s95, s95, s47
    s_add_u32 m0, s76, 2048
    s_nop 0
    buffer_load_dwordx4 v156, s[60:63], s96 offen lds
    s_add_u32 s96, s96, s47
    s_add_u32 s97, s97, 24576
    s_cmp_eq_u32 s97, 73728
    s_cselect_b32 s97, 0, s97
    s_add_u32 s76, s75, s97
    s_add_u32 m0, s76, 0
    s_nop 0
    buffer_load_dwordx4 v156, s[60:63], s94 offen lds
    s_add_u32 s94, s94, s47
    s_add_u32 m0, s76, 1024
    s_nop 0
    buffer_load_dwordx4 v156, s[60:63], s95 offen lds
    s_add_u32 s95, s95, s47
    s_add_u32 m0, s76, 2048
    s_nop 0
    buffer_load_dwordx4 v156, s[60:63], s96 offen lds
    s_add_u32 s96, s96, s47
    s_add_u32 s97, s97, 24576
    s_cmp_eq_u32 s97, 73728
    s_cselect_b32 s97, 0, s97
    s_sub_u32 s69, s50, 16
    s_lshl_b32 s69, s69, 3
    s_add_u32 s69, s69, s48
    s_mul_i32 s69, s69, 5120
    s_add_u32 s76, s69, 4096
    s_mov_b32 m0, 139264
    v_lshlrev_b32 v181, 4, v180
    buffer_load_dwordx4 v181, s[56:59], s69 offen offset:0 lds
    buffer_load_dwordx4 v181, s[56:59], s69 offen offset:1024 lds
    buffer_load_dwordx4 v181, s[56:59], s69 offen offset:2048 lds
    buffer_load_dwordx4 v181, s[56:59], s69 offen offset:3072 lds
    buffer_load_dwordx4 v181, s[56:59], s76 offen offset:0 lds
    s_waitcnt vmcnt(8)
    s_cmp_lg_u32 s48, 7
    s_cbranch_scc1 Larr_125
    s_cmp_lg_u32 s3, 0
    s_cbranch_scc1 Larr_125
    s_mov_b64 exec, 1
    v_mov_b32 v182, 1
    v_mov_b32 v183, 32
    buffer_atomic_add v182, v183, s[8:11], 0 offen sc1
    s_mov_b64 exec, -1
Larr_125:
Lgnext_126:
    s_mov_b32 s68, s71
    s_mov_b32 s70, s72
    s_lshl_b32 s81, s64, 2
    s_cmp_eq_u32 s68, 4
    s_cbranch_scc1 Lg_end
    s_cmp_eq_u32 s68, 2
    s_cbranch_scc1 Lg_v
    s_cmp_eq_u32 s68, 3
    s_cbranch_scc1 Lg_f
    v_add_u32 v177, s101, v174
    s_add_u32 s101, s101, 24576
    s_cmp_eq_u32 s101, 73728
    s_cselect_b32 s101, 0, s101
    s_waitcnt vmcnt(15) lgkmcnt(0)
    v_mov_b32 v176, v177
    s_barrier
    ds_read_b128 v[98:101], v158 offset:0
    ds_read_b128 v[102:105], v158 offset:4096
    ds_read_b64_tr_b16 v[106:107], v176 offset:0
    ds_read_b64_tr_b16 v[108:109], v176 offset:256
    ds_read_b64_tr_b16 v[110:111], v176 offset:4096
    ds_read_b64_tr_b16 v[112:113], v176 offset:4352
    ds_read_b64_tr_b16 v[114:115], v176 offset:8192
    ds_read_b64_tr_b16 v[116:117], v176 offset:8448
    s_add_u32 m0, s74, 32768
    s_nop 0
    buffer_load_dwordx4 v154, s[56:59], s65 offen lds
    s_add_u32 m0, s74, 33792
    s_add_u32 s69, s65, 10240
    buffer_load_dwordx4 v155, s[56:59], s69 offen lds
    s_add_u32 m0, s74, 34816
    s_add_u32 s69, s65, 20480
    buffer_load_dwordx4 v154, s[56:59], s69 offen lds
    s_add_u32 m0, s74, 35840
    s_add_u32 s69, s65, 30720
    buffer_load_dwordx4 v155, s[56:59], s69 offen lds
    s_add_u32 s65, s65, 128
    s_add_u32 s76, s75, s97
    s_add_u32 m0, s76, 0
    s_nop 0
    buffer_load_dwordx4 v156, s[60:63], s94 offen lds
    s_add_u32 s94, s94, s47
    s_add_u32 m0, s76, 1024
    s_nop 0
    buffer_load_dwordx4 v156, s[60:63], s95 offen lds
    s_add_u32 s95, s95, s47
    s_add_u32 m0, s76, 2048
    s_nop 0
    buffer_load_dwordx4 v156, s[60:63], s96 offen lds
    s_add_u32 s96, s96, s47
    s_add_u32 s97, s97, 24576
    s_cmp_eq_u32 s97, 73728
    s_cselect_b32 s97, 0, s97
    s_waitcnt lgkmcnt(0)
    v_mfma_f32_32x32x16_bf16 v[2:17], v[106:109], v[98:101], 0
    ds_read_b128 v[126:129], v159 offset:0
    ds_read_b128 v[130:133], v159 offset:4096
    v_mfma_f32_32x32x16_bf16 v[18:33], v[110:113], v[98:101], 0
    ds_read_b64_tr_b16 v[134:135], v176 offset:1024
    ds_read_b64_tr_b16 v[136:137], v176 offset:1280
    v_mfma_f32_32x32x16_bf16 v[34:49], v[114:117], v[98:101], 0
    ds_read_b64_tr_b16 v[138:139], v176 offset:5120
    ds_read_b64_tr_b16 v[140:141], v176 offset:5376
    v_mfma_f32_32x32x16_bf16 v[50:65], v[106:109], v[102:105], 0
    ds_read_b64_tr_b16 v[142:143], v176 offset:9216
    ds_read_b64_tr_b16 v[144:145], v176 offset:9472
    v_mfma_f32_32x32x16_bf16 v[66:81], v[110:113], v[102:105], 0
    v_mfma_f32_32x32x16_bf16 v[82:97], v[114:117], v[102:105], 0
    s_waitcnt lgkmcnt(0)
    v_mfma_f32_32x32x16_bf16 v[2:17], v[134:137], v[126:129], v[2:17]
    ds_read_b128 v[98:101], v160 offset:0
    ds_read_b128 v[102:105], v160 offset:4096
    v_mfma_f32_32x32x16_bf16 v[18:33], v[138:141], v[126:129], v[18:33]
    ds_read_b64_tr_b16 v[106:107], v176 offset:2048
    ds_read_b64_tr_b16 v[108:109], v176 offset:2304
    v_mfma_f32_32x32x16_bf16 v[34:49], v[142:145], v[126:129], v[34:49]
    ds_read_b64_tr_b16 v[110:111], v176 offset:6144
    ds_read_b64_tr_b16 v[112:113], v176 offset:6400
    v_mfma_f32_32x32x16_bf16 v[50:65], v[134:137], v[130:133], v[50:65]
    ds_read_b64_tr_b16 v[114:115], v176 offset:10240
    ds_read_b64_tr_b16 v[116:117], v176 offset:10496
    v_mfma_f32_32x32x16_bf16 v[66:81], v[138:141], v[130:133], v[66:81]
    v_mfma_f32_32x32x16_bf16 v[82:97], v[142:145], v[130:133], v[82:97]
    s_waitcnt lgkmcnt(0)
    v_mfma_f32_32x32x16_bf16 v[2:17], v[106:109], v[98:101], v[2:17]
    ds_read_b128 v[126:129], v161 offset:0
    ds_read_b128 v[130:133], v161 offset:4096
    v_mfma_f32_32x32x16_bf16 v[18:33], v[110:113], v[98:101], v[18:33]
    ds_read_b64_tr_b16 v[134:135], v176 offset:3072
    ds_read_b64_tr_b16 v[136:137], v176 offset:3328
    v_mfma_f32_32x32x16_bf16 v[34:49], v[114:117], v[98:101], v[34:49]
    ds_read_b64_tr_b16 v[138:139], v176 offset:7168
    ds_read_b64_tr_b16 v[140:141], v176 offset:7424
    v_mfma_f32_32x32x16_bf16 v[50:65], v[106:109], v[102:105], v[50:65]
    ds_read_b64_tr_b16 v[142:143], v176 offset:11264
    ds_read_b64_tr_b16 v[144:145], v176 offset:11520
    v_mfma_f32_32x32x16_bf16 v[66:81], v[110:113], v[102:105], v[66:81]
    v_mfma_f32_32x32x16_bf16 v[82:97], v[114:117], v[102:105], v[82:97]
    s_mov_b32 s73, 0
LLg_qk_127:
    v_add_u32 v177, s101, v174
    s_add_u32 s101, s101, 24576
    s_cmp_eq_u32 s101, 73728
    s_cselect_b32 s101, 0, s101
    s_waitcnt vmcnt(3) lgkmcnt(0)
    v_mov_b32 v176, v177
    s_barrier
    s_cmp_lg_u32 s73, 0
    s_cbranch_scc1 Lgnf_128
    s_cmp_eq_u32 s80, 0
    s_cbranch_scc1 Lgf_129
    s_cmp_lg_u32 s48, 0
    s_cbranch_scc1 Lgf_129
    s_mov_b64 exec, 1
    buffer_store_dword v187, v188, s[4:7], s80 offen sc1
    s_mov_b64 exec, -1
Lgf_129:
Lgnf_128:
    v_mfma_f32_32x32x16_bf16 v[2:17], v[134:137], v[126:129], v[2:17]
    ds_read_b128 v[98:101], v162 offset:0
    ds_read_b128 v[102:105], v162 offset:4096
    v_mfma_f32_32x32x16_bf16 v[18:33], v[138:141], v[126:129], v[18:33]
    ds_read_b64_tr_b16 v[106:107], v176 offset:0
    ds_read_b64_tr_b16 v[108:109], v176 offset:256
    v_mfma_f32_32x32x16_bf16 v[34:49], v[142:145], v[126:129], v[34:49]
    ds_read_b64_tr_b16 v[110:111], v176 offset:4096
    ds_read_b64_tr_b16 v[112:113], v176 offset:4352
    v_mfma_f32_32x32x16_bf16 v[50:65], v[134:137], v[130:133], v[50:65]
    ds_read_b64_tr_b16 v[114:115], v176 offset:8192
    ds_read_b64_tr_b16 v[116:117], v176 offset:8448
    v_mfma_f32_32x32x16_bf16 v[66:81], v[138:141], v[130:133], v[66:81]
    v_mfma_f32_32x32x16_bf16 v[82:97], v[142:145], v[130:133], v[82:97]
    s_cmp_eq_u32 s73, 4
    s_cselect_b32 s65, s100, s65
Lgn_130:
    s_add_u32 m0, s74, 0
    s_nop 0
    buffer_load_dwordx4 v154, s[56:59], s65 offen lds
    s_add_u32 m0, s74, 1024
    s_add_u32 s69, s65, 10240
    buffer_load_dwordx4 v155, s[56:59], s69 offen lds
    s_add_u32 m0, s74, 2048
    s_add_u32 s69, s65, 20480
    buffer_load_dwordx4 v154, s[56:59], s69 offen lds
    s_add_u32 m0, s74, 3072
    s_add_u32 s69, s65, 30720
    buffer_load_dwordx4 v155, s[56:59], s69 offen lds
    s_add_u32 s65, s65, 128
    s_add_u32 s76, s75, s97
    s_add_u32 m0, s76, 0
    s_nop 0
    buffer_load_dwordx4 v156, s[60:63], s94 offen lds
    s_add_u32 s94, s94, s47
    s_add_u32 m0, s76, 1024
    s_nop 0
    buffer_load_dwordx4 v156, s[60:63], s95 offen lds
    s_add_u32 s95, s95, s47
    s_add_u32 m0, s76, 2048
    s_nop 0
    buffer_load_dwordx4 v156, s[60:63], s96 offen lds
    s_add_u32 s96, s96, s47
    s_add_u32 s97, s97, 24576
    s_cmp_eq_u32 s97, 73728
    s_cselect_b32 s97, 0, s97
    s_waitcnt lgkmcnt(0)
    v_mfma_f32_32x32x16_bf16 v[2:17], v[106:109], v[98:101], v[2:17]
    ds_read_b128 v[126:129], v163 offset:0
    ds_read_b128 v[130:133], v163 offset:4096
    v_mfma_f32_32x32x16_bf16 v[18:33], v[110:113], v[98:101], v[18:33]
    ds_read_b64_tr_b16 v[134:135], v176 offset:1024
    ds_read_b64_tr_b16 v[136:137], v176 offset:1280
    v_mfma_f32_32x32x16_bf16 v[34:49], v[114:117], v[98:101], v[34:49]
    ds_read_b64_tr_b16 v[138:139], v176 offset:5120
    ds_read_b64_tr_b16 v[140:141], v176 offset:5376
    v_mfma_f32_32x32x16_bf16 v[50:65], v[106:109], v[102:105], v[50:65]
    ds_read_b64_tr_b16 v[142:143], v176 offset:9216
    ds_read_b64_tr_b16 v[144:145], v176 offset:9472
    v_mfma_f32_32x32x16_bf16 v[66:81], v[110:113], v[102:105], v[66:81]
    v_mfma_f32_32x32x16_bf16 v[82:97], v[114:117], v[102:105], v[82:97]
    s_waitcnt lgkmcnt(0)
    v_mfma_f32_32x32x16_bf16 v[2:17], v[134:137], v[126:129], v[2:17]
    ds_read_b128 v[98:101], v164 offset:0
    ds_read_b128 v[102:105], v164 offset:4096
    v_mfma_f32_32x32x16_bf16 v[18:33], v[138:141], v[126:129], v[18:33]
    ds_read_b64_tr_b16 v[106:107], v176 offset:2048
    ds_read_b64_tr_b16 v[108:109], v176 offset:2304
    v_mfma_f32_32x32x16_bf16 v[34:49], v[142:145], v[126:129], v[34:49]
    ds_read_b64_tr_b16 v[110:111], v176 offset:6144
    ds_read_b64_tr_b16 v[112:113], v176 offset:6400
    v_mfma_f32_32x32x16_bf16 v[50:65], v[134:137], v[130:133], v[50:65]
    ds_read_b64_tr_b16 v[114:115], v176 offset:10240
    ds_read_b64_tr_b16 v[116:117], v176 offset:10496
    v_mfma_f32_32x32x16_bf16 v[66:81], v[138:141], v[130:133], v[66:81]
    v_mfma_f32_32x32x16_bf16 v[82:97], v[142:145], v[130:133], v[82:97]
    s_waitcnt lgkmcnt(0)
    v_mfma_f32_32x32x16_bf16 v[2:17], v[106:109], v[98:101], v[2:17]
    ds_read_b128 v[126:129], v165 offset:0
    ds_read_b128 v[130:133], v165 offset:4096
    v_mfma_f32_32x32x16_bf16 v[18:33], v[110:113], v[98:101], v[18:33]
    ds_read_b64_tr_b16 v[134:135], v176 offset:3072
    ds_read_b64_tr_b16 v[136:137], v176 offset:3328
    v_mfma_f32_32x32x16_bf16 v[34:49], v[114:117], v[98:101], v[34:49]
    ds_read_b64_tr_b16 v[138:139], v176 offset:7168
    ds_read_b64_tr_b16 v[140:141], v176 offset:7424
    v_mfma_f32_32x32x16_bf16 v[50:65], v[106:109], v[102:105], v[50:65]
    ds_read_b64_tr_b16 v[142:143], v176 offset:11264
    ds_read_b64_tr_b16 v[144:145], v176 offset:11520
    v_mfma_f32_32x32x16_bf16 v[66:81], v[110:113], v[102:105], v[66:81]
    v_mfma_f32_32x32x16_bf16 v[82:97], v[114:117], v[102:105], v[82:97]
    s_cmp_eq_u32 s73, 4
    s_cbranch_scc1 Lg_qk_done
    v_add_u32 v177, s101, v174
    s_add_u32 s101, s101, 24576
    s_cmp_eq_u32 s101, 73728
    s_cselect_b32 s101, 0, s101
    s_waitcnt vmcnt(3) lgkmcnt(0)
    v_mov_b32 v176, v177
    s_barrier
    v_mfma_f32_32x32x16_bf16 v[2:17], v[134:137], v[126:129], v[2:17]
    ds_read_b128 v[98:101], v158 offset:0
    ds_read_b128 v[102:105], v158 offset:4096
    v_mfma_f32_32x32x16_bf16 v[18:33], v[138:141], v[126:129], v[18:33]
    ds_read_b64_tr_b16 v[106:107], v176 offset:0
    ds_read_b64_tr_b16 v[108:109], v176 offset:256
    v_mfma_f32_32x32x16_bf16 v[34:49], v[142:145], v[126:129], v[34:49]
    ds_read_b64_tr_b16 v[110:111], v176 offset:4096
    ds_read_b64_tr_b16 v[112:113], v176 offset:4352
    v_mfma_f32_32x32x16_bf16 v[50:65], v[134:137], v[130:133], v[50:65]
    ds_read_b64_tr_b16 v[114:115], v176 offset:8192
    ds_read_b64_tr_b16 v[116:117], v176 offset:8448
    v_mfma_f32_32x32x16_bf16 v[66:81], v[138:141], v[130:133], v[66:81]
    v_mfma_f32_32x32x16_bf16 v[82:97], v[142:145], v[130:133], v[82:97]
    s_cmp_lg_u32 s73, 3
    s_cbranch_scc1 Lgn_131
    s_add_u32 s64, s64, 16
    s_cmp_ge_u32 s64, 112
    s_cbranch_scc1 Ldn_133
    s_cmp_ge_u32 s64, 96
    s_cbranch_scc1 Ldf_132
    s_mul_i32 s69, s64, 43691
    s_lshr_b32 s69, s69, 19
    s_mul_i32 s76, s69, 12
    s_sub_u32 s76, s64, s76
    s_lshr_b32 s71, s76, 2
    s_and_b32 s76, s76, 3
    s_lshl_b32 s77, s49, 2
    s_add_u32 s76, s76, s77
    s_mul_i32 s100, s69, 327680
    s_mul_i32 s66, s76, 384
    s_mov_b32 s67, 12288
    s_cmp_eq_u32 s71, 1
    s_cselect_b32 s60, s22, s20
    s_cselect_b32 s61, s23, s21
    s_cmp_eq_u32 s71, 2
    s_cselect_b32 s60, s24, s60
    s_cselect_b32 s61, s25, s61
    s_mov_b32 s62, 7864320
    s_mul_i32 s72, s71, 25165824
    s_mul_i32 s77, s76, 786432
    s_add_u32 s72, s72, s77
    s_mul_i32 s77, s69, 98304
    s_add_u32 s72, s72, s77
    s_mul_i32 s77, s48, 3
    s_lshr_b32 s78, s77, 2
    s_branch Ldd_134
Ldf_132:
    s_sub_u32 s76, s64, 96
    s_lshr_b32 s69, s76, 1
    s_and_b32 s76, s76, 1
    s_mov_b32 s71, 3
    s_mul_i32 s100, s69, 327680
    s_mul_i32 s66, s49, 384
    s_mul_i32 s77, s76, 192
    s_add_u32 s66, s66, s77
    s_mov_b32 s67, 3072
    s_cmp_ge_u32 s48, 4
    s_cselect_b32 s60, s34, s32
    s_cselect_b32 s61, s35, s33
    s_mov_b32 s62, 1966080
    s_mul_i32 s72, s69, 786432
    s_lshl_b32 s77, s66, 4
    s_add_u32 s72, s72, s77
    s_add_u32 s72, s72, 100663296
    s_and_b32 s77, s48, 3
    s_mul_i32 s77, s77, 3
    s_lshr_b32 s78, s77, 2
    s_branch Ldd_134
Ldn_133:
    s_mov_b32 s71, 4
    s_mov_b32 s62, 0
    s_mov_b32 s77, 0
    s_mov_b32 s78, 0
Ldd_134:
    s_add_u32 s69, s77, 0
    s_lshr_b32 s76, s69, 2
    s_and_b32 s69, s69, 3
    s_lshl_b32 s69, s69, 4
    s_mul_i32 s69, s69, s67
    s_lshl_b32 s76, s76, 6
    s_add_u32 s69, s69, s76
    s_add_u32 s94, s69, s66
    s_add_u32 s69, s77, 1
    s_lshr_b32 s76, s69, 2
    s_and_b32 s69, s69, 3
    s_lshl_b32 s69, s69, 4
    s_mul_i32 s69, s69, s67
    s_lshl_b32 s76, s76, 6
    s_add_u32 s69, s69, s76
    s_add_u32 s95, s69, s66
    s_add_u32 s69, s77, 2
    s_lshr_b32 s76, s69, 2
    s_and_b32 s69, s69, 3
    s_lshl_b32 s69, s69, 4
    s_mul_i32 s69, s69, s67
    s_lshl_b32 s76, s76, 6
    s_add_u32 s69, s69, s76
    s_add_u32 s96, s69, s66
    s_mul_i32 s69, s48, 40960
    s_add_u32 s100, s100, s69
    s_lshl_b32 s47, s67, 6
    v_mul_lo_u32 v156, v178, s67
    v_add_u32 v156, v156, v179
Lgn_131:
    s_add_u32 m0, s74, 32768
    s_nop 0
    buffer_load_dwordx4 v154, s[56:59], s65 offen lds
    s_add_u32 m0, s74, 33792
    s_add_u32 s69, s65, 10240
    buffer_load_dwordx4 v155, s[56:59], s69 offen lds
    s_add_u32 m0, s74, 34816
    s_add_u32 s69, s65, 20480
    buffer_load_dwordx4 v154, s[56:59], s69 offen lds
    s_add_u32 m0, s74, 35840
    s_add_u32 s69, s65, 30720
    buffer_load_dwordx4 v155, s[56:59], s69 offen lds
    s_add_u32 s65, s65, 128
    s_add_u32 s76, s75, s97
    s_add_u32 m0, s76, 0
    s_nop 0
    buffer_load_dwordx4 v156, s[60:63], s94 offen lds
    s_add_u32 s94, s94, s47
    s_add_u32 m0, s76, 1024
    s_nop 0
    buffer_load_dwordx4 v156, s[60:63], s95 offen lds
    s_add_u32 s95, s95, s47
    s_add_u32 m0, s76, 2048
    s_nop 0
    buffer_load_dwordx4 v156, s[60:63], s96 offen lds
    s_add_u32 s96, s96, s47
    s_add_u32 s97, s97, 24576
    s_cmp_eq_u32 s97, 73728
    s_cselect_b32 s97, 0, s97
    s_waitcnt lgkmcnt(0)
    v_mfma_f32_32x32x16_bf16 v[2:17], v[106:109], v[98:101], v[2:17]
    ds_read_b128 v[126:129], v159 offset:0
    ds_read_b128 v[130:133], v159 offset:4096
    v_mfma_f32_32x32x16_bf16 v[18:33], v[110:113], v[98:101], v[18:33]
    ds_read_b64_tr_b16 v[134:135], v176 offset:1024
    ds_read_b64_tr_b16 v[136:137], v176 offset:1280
    v_mfma_f32_32x32x16_bf16 v[34:49], v[114:117], v[98:101], v[34:49]
    ds_read_b64_tr_b16 v[138:139], v176 offset:5120
    ds_read_b64_tr_b16 v[140:141], v176 offset:5376
    v_mfma_f32_32x32x16_bf16 v[50:65], v[106:109], v[102:105], v[50:65]
    ds_read_b64_tr_b16 v[142:143], v176 offset:9216
    ds_read_b64_tr_b16 v[144:145], v176 offset:9472
    v_mfma_f32_32x32x16_bf16 v[66:81], v[110:113], v[102:105], v[66:81]
    v_mfma_f32_32x32x16_bf16 v[82:97], v[114:117], v[102:105], v[82:97]
    s_waitcnt lgkmcnt(0)
    v_mfma_f32_32x32x16_bf16 v[2:17], v[134:137], v[126:129], v[2:17]
    ds_read_b128 v[98:101], v160 offset:0
    ds_read_b128 v[102:105], v160 offset:4096
    v_mfma_f32_32x32x16_bf16 v[18:33], v[138:141], v[126:129], v[18:33]
    ds_read_b64_tr_b16 v[106:107], v176 offset:2048
    ds_read_b64_tr_b16 v[108:109], v176 offset:2304
    v_mfma_f32_32x32x16_bf16 v[34:49], v[142:145], v[126:129], v[34:49]
    ds_read_b64_tr_b16 v[110:111], v176 offset:6144
    ds_read_b64_tr_b16 v[112:113], v176 offset:6400
    v_mfma_f32_32x32x16_bf16 v[50:65], v[134:137], v[130:133], v[50:65]
    ds_read_b64_tr_b16 v[114:115], v176 offset:10240
    ds_read_b64_tr_b16 v[116:117], v176 offset:10496
    v_mfma_f32_32x32x16_bf16 v[66:81], v[138:141], v[130:133], v[66:81]
    v_mfma_f32_32x32x16_bf16 v[82:97], v[142:145], v[130:133], v[82:97]
    s_waitcnt lgkmcnt(0)
    v_mfma_f32_32x32x16_bf16 v[2:17], v[106:109], v[98:101], v[2:17]
    ds_read_b128 v[126:129], v161 offset:0
    ds_read_b128 v[130:133], v161 offset:4096
    v_mfma_f32_32x32x16_bf16 v[18:33], v[110:113], v[98:101], v[18:33]
    ds_read_b64_tr_b16 v[134:135], v176 offset:3072
    ds_read_b64_tr_b16 v[136:137], v176 offset:3328
    v_mfma_f32_32x32x16_bf16 v[34:49], v[114:117], v[98:101], v[34:49]
    ds_read_b64_tr_b16 v[138:139], v176 offset:7168
    ds_read_b64_tr_b16 v[140:141], v176 offset:7424
    v_mfma_f32_32x32x16_bf16 v[50:65], v[106:109], v[102:105], v[50:65]
    ds_read_b64_tr_b16 v[142:143], v176 offset:11264
    ds_read_b64_tr_b16 v[144:145], v176 offset:11520
    v_mfma_f32_32x32x16_bf16 v[66:81], v[110:113], v[102:105], v[66:81]
    v_mfma_f32_32x32x16_bf16 v[82:97], v[114:117], v[102:105], v[82:97]
    s_add_u32 s73, s73, 1
    s_branch LLg_qk_127
Lg_qk_done:
    s_waitcnt lgkmcnt(0)
    v_mfma_f32_32x32x16_bf16 v[2:17], v[134:137], v[126:129], v[2:17]
    v_mfma_f32_32x32x16_bf16 v[18:33], v[138:141], v[126:129], v[18:33]
    v_mfma_f32_32x32x16_bf16 v[34:49], v[142:145], v[126:129], v[34:49]
    v_mfma_f32_32x32x16_bf16 v[50:65], v[134:137], v[130:133], v[50:65]
    v_mfma_f32_32x32x16_bf16 v[66:81], v[138:141], v[130:133], v[66:81]
    v_mfma_f32_32x32x16_bf16 v[82:97], v[142:145], v[130:133], v[82:97]
    s_nop 7
    s_nop 3
    s_cmp_lg_u32 s80, 0
    s_cbranch_scc1 Lgreg_135
    v_and_b32 v183, 63, v0
    v_lshlrev_b32 v182, 2, v183
Lreg_136:
    buffer_load_dword v181, v182, s[8:11], 0 offen sc0 sc1
    s_waitcnt vmcnt(0)
    v_readlane_b32 s69, v181, 8
    v_readlane_b32 s76, v181, 8
    s_add_u32 s69, s69, s76
    s_cmp_ge_u32 s69, 512
    s_cbranch_scc1 Lregd_137
    s_sleep 24
    s_sub_u32 s54, s54, 1
    s_cbranch_scc0 Lreg_136
    s_mov_b32 s54, 0
Lregd_137:
    v_readlane_b32 s79, v181, 34
    v_cmp_ne_u32 vcc, 32, v181
    s_and_b32 s79, s79, 1
    s_and_b32 s69, vcc_lo, 0xf
    s_and_b32 s76, vcc_hi, 0xf00
    s_or_b32 s69, s69, s76
    s_cselect_b32 s53, 1, 0
Lgreg_135:
    s_lshr_b32 s69, s81, 2
    s_mul_i32 s76, s69, 43691
    s_lshr_b32 s76, s76, 19
    s_mul_i32 s77, s76, 12
    s_sub_u32 s69, s69, s77
    s_mul_i32 s77, s49, 12
    s_add_u32 s69, s69, s77
    s_lshl_b32 s69, s69, 3
    s_add_u32 s69, s69, s48
    s_cmp_ge_u32 s69, 640
    s_cbranch_scc1 Lgci_138
    s_mul_i32 s77, s69, 52429
    s_lshr_b32 s77, s77, 22
    s_mul_i32 s78, s77, 80
    s_sub_u32 s69, s69, s78
    s_lshl_b32 s76, s76, 3
    s_add_u32 s76, s76, s77
    s_cmp_ge_u32 s76, 9
    s_cbranch_scc1 Lgci_138
    s_cmp_eq_u32 s76, 0
    s_cbranch_scc1 Lgci_138
    s_mul_i32 s77, s76, 86
    s_lshr_b32 s77, s77, 8
    s_mul_i32 s76, s76, 655360
    s_mul_i32 s78, s77, 131072
    s_add_u32 s76, s76, s78
    s_xor_b32 s77, s77, s79
    s_and_b32 s77, s77, 1
    s_lshl_b32 s77, s77, 13
    s_add_u32 s76, s76, s77
    s_lshr_b32 s77, s69, 1
    s_lshl_b32 s77, s77, 14
    s_add_u32 s76, s76, s77
    s_and_b32 s77, s69, 1
    s_lshl_b32 s77, s77, 12
    s_add_u32 s76, s76, s77
    s_add_u32 s76, s76, 167772160
    v_mov_b32 v98, -1
    v_mov_b32 v99, -1
    v_mov_b32 v100, -1
    v_mov_b32 v101, -1
    v_lshlrev_b32 v102, 4, v180
    buffer_store_dwordx4 v[98:101], v102, s[4:7], s76 offen offset:0 sc1
    buffer_store_dwordx4 v[98:101], v102, s[4:7], s76 offen offset:1024 sc1
    buffer_store_dwordx4 v[98:101], v102, s[4:7], s76 offen offset:2048 sc1
    buffer_store_dwordx4 v[98:101], v102, s[4:7], s76 offen offset:3072 sc1
Lgci_138:
    s_add_u32 s69, s70, 0
    s_add_u32 s76, s70, 12288
    v_cvt_pk_bf16_f32 v2, v2, v3
    v_cvt_pk_bf16_f32 v3, v4, v5
    v_cvt_pk_bf16_f32 v4, v6, v7
    v_cvt_pk_bf16_f32 v5, v8, v9
    v_cvt_pk_bf16_f32 v6, v10, v11
    v_cvt_pk_bf16_f32 v7, v12, v13
    v_cvt_pk_bf16_f32 v8, v14, v15
    v_cvt_pk_bf16_f32 v9, v16, v17
    v_cvt_pk_bf16_f32 v18, v18, v19
    v_cvt_pk_bf16_f32 v19, v20, v21
    v_cvt_pk_bf16_f32 v20, v22, v23
    v_cvt_pk_bf16_f32 v21, v24, v25
    v_cvt_pk_bf16_f32 v22, v26, v27
    v_cvt_pk_bf16_f32 v23, v28, v29
    v_cvt_pk_bf16_f32 v24, v30, v31
    v_cvt_pk_bf16_f32 v25, v32, v33
    v_cvt_pk_bf16_f32 v34, v34, v35
    v_cvt_pk_bf16_f32 v35, v36, v37
    v_cvt_pk_bf16_f32 v36, v38, v39
    v_cvt_pk_bf16_f32 v37, v40, v41
    v_cvt_pk_bf16_f32 v38, v42, v43
    v_cvt_pk_bf16_f32 v39, v44, v45
    v_cvt_pk_bf16_f32 v40, v46, v47
    v_cvt_pk_bf16_f32 v41, v48, v49
    v_cvt_pk_bf16_f32 v50, v50, v51
    v_cvt_pk_bf16_f32 v51, v52, v53
    v_cvt_pk_bf16_f32 v52, v54, v55
    v_cvt_pk_bf16_f32 v53, v56, v57
    v_cvt_pk_bf16_f32 v54, v58, v59
    v_cvt_pk_bf16_f32 v55, v60, v61
    v_cvt_pk_bf16_f32 v56, v62, v63
    v_cvt_pk_bf16_f32 v57, v64, v65
    v_cvt_pk_bf16_f32 v66, v66, v67
    v_cvt_pk_bf16_f32 v67, v68, v69
    v_cvt_pk_bf16_f32 v68, v70, v71
    v_cvt_pk_bf16_f32 v69, v72, v73
    v_cvt_pk_bf16_f32 v70, v74, v75
    v_cvt_pk_bf16_f32 v71, v76, v77
    v_cvt_pk_bf16_f32 v72, v78, v79
    v_cvt_pk_bf16_f32 v73, v80, v81
    v_cvt_pk_bf16_f32 v82, v82, v83
    v_cvt_pk_bf16_f32 v83, v84, v85
    v_cvt_pk_bf16_f32 v84, v86, v87
    v_cvt_pk_bf16_f32 v85, v88, v89
    v_cvt_pk_bf16_f32 v86, v90, v91
    v_cvt_pk_bf16_f32 v87, v92, v93
    v_cvt_pk_bf16_f32 v88, v94, v95
    v_cvt_pk_bf16_f32 v89, v96, v97
    buffer_store_dwordx4 v[2:5], v184, s[4:7], s69 offen offset:0 sc1
    buffer_store_dwordx4 v[6:9], v184, s[4:7], s69 offen offset:512 sc1
    buffer_store_dwordx4 v[18:21], v184, s[4:7], s69 offen offset:1024 sc1
    buffer_store_dwordx4 v[22:25], v184, s[4:7], s69 offen offset:1536 sc1
    buffer_store_dwordx4 v[34:37], v184, s[4:7], s69 offen offset:2048 sc1
    buffer_store_dwordx4 v[38:41], v184, s[4:7], s69 offen offset:2560 sc1
    buffer_store_dwordx4 v[50:53], v184, s[4:7], s76 offen offset:0 sc1
    buffer_store_dwordx4 v[54:57], v184, s[4:7], s76 offen offset:512 sc1
    buffer_store_dwordx4 v[66:69], v184, s[4:7], s76 offen offset:1024 sc1
    buffer_store_dwordx4 v[70:73], v184, s[4:7], s76 offen offset:1536 sc1
    buffer_store_dwordx4 v[82:85], v184, s[4:7], s76 offen offset:2048 sc1
    buffer_store_dwordx4 v[86:89], v184, s[4:7], s76 offen offset:2560 sc1
    s_mul_i32 s80, s49, 512
    s_add_u32 s80, s80, s81
    s_add_u32 s80, s80, 152043520
    s_cmp_ge_u32 s81, 64
    s_cbranch_scc1 Lgff_139
    s_waitcnt vmcnt(0)
    s_barrier
    s_cmp_eq_u32 s80, 0
    s_cbranch_scc1 Lgf_140
    s_cmp_lg_u32 s48, 0
    s_cbranch_scc1 Lgf_140
    s_mov_b64 exec, 1
    buffer_store_dword v187, v188, s[4:7], s80 offen sc1
    s_mov_b64 exec, -1
Lgf_140:
Lgff_139:
    s_branch Lgnext_126
Lg_v:
    v_add_u32 v177, s101, v174
    s_add_u32 s101, s101, 24576
    s_cmp_eq_u32 s101, 73728
    s_cselect_b32 s101, 0, s101
    s_waitcnt vmcnt(15) lgkmcnt(0)
    v_mov_b32 v176, v177
    s_barrier
    ds_read_b128 v[98:101], v158 offset:0
    ds_read_b128 v[102:105], v158 offset:4096
    ds_read_b64_tr_b16 v[106:107], v176 offset:0
    ds_read_b64_tr_b16 v[108:109], v176 offset:256
    ds_read_b64_tr_b16 v[110:111], v176 offset:4096
    ds_read_b64_tr_b16 v[112:113], v176 offset:4352
    ds_read_b64_tr_b16 v[114:115], v176 offset:8192
    ds_read_b64_tr_b16 v[116:117], v176 offset:8448
    s_add_u32 m0, s74, 32768
    s_nop 0
    buffer_load_dwordx4 v154, s[56:59], s65 offen lds
    s_add_u32 m0, s74, 33792
    s_add_u32 s69, s65, 10240
    buffer_load_dwordx4 v155, s[56:59], s69 offen lds
    s_add_u32 m0, s74, 34816
    s_add_u32 s69, s65, 20480
    buffer_load_dwordx4 v154, s[56:59], s69 offen lds
    s_add_u32 m0, s74, 35840
    s_add_u32 s69, s65, 30720
    buffer_load_dwordx4 v155, s[56:59], s69 offen lds
    s_add_u32 s65, s65, 128
    s_add_u32 s76, s75, s97
    s_add_u32 m0, s76, 0
    s_nop 0
    buffer_load_dwordx4 v156, s[60:63], s94 offen lds
    s_add_u32 s94, s94, s47
    s_add_u32 m0, s76, 1024
    s_nop 0
    buffer_load_dwordx4 v156, s[60:63], s95 offen lds
    s_add_u32 s95, s95, s47
    s_add_u32 m0, s76, 2048
    s_nop 0
    buffer_load_dwordx4 v156, s[60:63], s96 offen lds
    s_add_u32 s96, s96, s47
    s_add_u32 s97, s97, 24576
    s_cmp_eq_u32 s97, 73728
    s_cselect_b32 s97, 0, s97
    s_waitcnt lgkmcnt(0)
    v_mfma_f32_32x32x16_bf16 v[2:17], v[98:101], v[106:109], 0
    ds_read_b128 v[126:129], v159 offset:0
    ds_read_b128 v[130:133], v159 offset:4096
    v_mfma_f32_32x32x16_bf16 v[18:33], v[98:101], v[110:113], 0
    ds_read_b64_tr_b16 v[134:135], v176 offset:1024
    ds_read_b64_tr_b16 v[136:137], v176 offset:1280
    v_mfma_f32_32x32x16_bf16 v[34:49], v[98:101], v[114:117], 0
    ds_read_b64_tr_b16 v[138:139], v176 offset:5120
    ds_read_b64_tr_b16 v[140:141], v176 offset:5376
    v_mfma_f32_32x32x16_bf16 v[50:65], v[102:105], v[106:109], 0
    ds_read_b64_tr_b16 v[142:143], v176 offset:9216
    ds_read_b64_tr_b16 v[144:145], v176 offset:9472
    v_mfma_f32_32x32x16_bf16 v[66:81], v[102:105], v[110:113], 0
    v_mfma_f32_32x32x16_bf16 v[82:97], v[102:105], v[114:117], 0
    s_waitcnt lgkmcnt(0)
    v_mfma_f32_32x32x16_bf16 v[2:17], v[126:129], v[134:137], v[2:17]
    ds_read_b128 v[98:101], v160 offset:0
    ds_read_b128 v[102:105], v160 offset:4096
    v_mfma_f32_32x32x16_bf16 v[18:33], v[126:129], v[138:141], v[18:33]
    ds_read_b64_tr_b16 v[106:107], v176 offset:2048
    ds_read_b64_tr_b16 v[108:109], v176 offset:2304
    v_mfma_f32_32x32x16_bf16 v[34:49], v[126:129], v[142:145], v[34:49]
    ds_read_b64_tr_b16 v[110:111], v176 offset:6144
    ds_read_b64_tr_b16 v[112:113], v176 offset:6400
    v_mfma_f32_32x32x16_bf16 v[50:65], v[130:133], v[134:137], v[50:65]
    ds_read_b64_tr_b16 v[114:115], v176 offset:10240
    ds_read_b64_tr_b16 v[116:117], v176 offset:10496
    v_mfma_f32_32x32x16_bf16 v[66:81], v[130:133], v[138:141], v[66:81]
    v_mfma_f32_32x32x16_bf16 v[82:97], v[130:133], v[142:145], v[82:97]
    s_waitcnt lgkmcnt(0)
    v_mfma_f32_32x32x16_bf16 v[2:17], v[98:101], v[106:109], v[2:17]
    ds_read_b128 v[126:129], v161 offset:0
    ds_read_b128 v[130:133], v161 offset:4096
    v_mfma_f32_32x32x16_bf16 v[18:33], v[98:101], v[110:113], v[18:33]
    ds_read_b64_tr_b16 v[134:135], v176 offset:3072
    ds_read_b64_tr_b16 v[136:137], v176 offset:3328
    v_mfma_f32_32x32x16_bf16 v[34:49], v[98:101], v[114:117], v[34:49]
    ds_read_b64_tr_b16 v[138:139], v176 offset:7168
    ds_read_b64_tr_b16 v[140:141], v176 offset:7424
    v_mfma_f32_32x32x16_bf16 v[50:65], v[102:105], v[106:109], v[50:65]
    ds_read_b64_tr_b16 v[142:143], v176 offset:11264
    ds_read_b64_tr_b16 v[144:145], v176 offset:11520
    v_mfma_f32_32x32x16_bf16 v[66:81], v[102:105], v[110:113], v[66:81]
    v_mfma_f32_32x32x16_bf16 v[82:97], v[102:105], v[114:117], v[82:97]
    s_mov_b32 s73, 0
LLg_vx_141:
    v_add_u32 v177, s101, v174
    s_add_u32 s101, s101, 24576
    s_cmp_eq_u32 s101, 73728
    s_cselect_b32 s101, 0, s101
    s_waitcnt vmcnt(3) lgkmcnt(0)
    v_mov_b32 v176, v177
    s_barrier
    s_cmp_lg_u32 s73, 0
    s_cbranch_scc1 Lgnf_142
    s_cmp_eq_u32 s80, 0
    s_cbranch_scc1 Lgf_143
    s_cmp_lg_u32 s48, 0
    s_cbranch_scc1 Lgf_143
    s_mov_b64 exec, 1
    buffer_store_dword v187, v188, s[4:7], s80 offen sc1
    s_mov_b64 exec, -1
Lgf_143:
Lgnf_142:
    v_mfma_f32_32x32x16_bf16 v[2:17], v[126:129], v[134:137], v[2:17]
    ds_read_b128 v[98:101], v162 offset:0
    ds_read_b128 v[102:105], v162 offset:4096
    v_mfma_f32_32x32x16_bf16 v[18:33], v[126:129], v[138:141], v[18:33]
    ds_read_b64_tr_b16 v[106:107], v176 offset:0
    ds_read_b64_tr_b16 v[108:109], v176 offset:256
    v_mfma_f32_32x32x16_bf16 v[34:49], v[126:129], v[142:145], v[34:49]
    ds_read_b64_tr_b16 v[110:111], v176 offset:4096
    ds_read_b64_tr_b16 v[112:113], v176 offset:4352
    v_mfma_f32_32x32x16_bf16 v[50:65], v[130:133], v[134:137], v[50:65]
    ds_read_b64_tr_b16 v[114:115], v176 offset:8192
    ds_read_b64_tr_b16 v[116:117], v176 offset:8448
    v_mfma_f32_32x32x16_bf16 v[66:81], v[130:133], v[138:141], v[66:81]
    v_mfma_f32_32x32x16_bf16 v[82:97], v[130:133], v[142:145], v[82:97]
    s_cmp_eq_u32 s73, 4
    s_cselect_b32 s65, s100, s65
Lgn_144:
    s_add_u32 m0, s74, 0
    s_nop 0
    buffer_load_dwordx4 v154, s[56:59], s65 offen lds
    s_add_u32 m0, s74, 1024
    s_add_u32 s69, s65, 10240
    buffer_load_dwordx4 v155, s[56:59], s69 offen lds
    s_add_u32 m0, s74, 2048
    s_add_u32 s69, s65, 20480
    buffer_load_dwordx4 v154, s[56:59], s69 offen lds
    s_add_u32 m0, s74, 3072
    s_add_u32 s69, s65, 30720
    buffer_load_dwordx4 v155, s[56:59], s69 offen lds
    s_add_u32 s65, s65, 128
    s_add_u32 s76, s75, s97
    s_add_u32 m0, s76, 0
    s_nop 0
    buffer_load_dwordx4 v156, s[60:63], s94 offen lds
    s_add_u32 s94, s94, s47
    s_add_u32 m0, s76, 1024
    s_nop 0
    buffer_load_dwordx4 v156, s[60:63], s95 offen lds
    s_add_u32 s95, s95, s47
    s_add_u32 m0, s76, 2048
    s_nop 0
    buffer_load_dwordx4 v156, s[60:63], s96 offen lds
    s_add_u32 s96, s96, s47
    s_add_u32 s97, s97, 24576
    s_cmp_eq_u32 s97, 73728
    s_cselect_b32 s97, 0, s97
    s_waitcnt lgkmcnt(0)
    v_mfma_f32_32x32x16_bf16 v[2:17], v[98:101], v[106:109], v[2:17]
    ds_read_b128 v[126:129], v163 offset:0
    ds_read_b128 v[130:133], v163 offset:4096
    v_mfma_f32_32x32x16_bf16 v[18:33], v[98:101], v[110:113], v[18:33]
    ds_read_b64_tr_b16 v[134:135], v176 offset:1024
    ds_read_b64_tr_b16 v[136:137], v176 offset:1280
    v_mfma_f32_32x32x16_bf16 v[34:49], v[98:101], v[114:117], v[34:49]
    ds_read_b64_tr_b16 v[138:139], v176 offset:5120
    ds_read_b64_tr_b16 v[140:141], v176 offset:5376
    v_mfma_f32_32x32x16_bf16 v[50:65], v[102:105], v[106:109], v[50:65]
    ds_read_b64_tr_b16 v[142:143], v176 offset:9216
    ds_read_b64_tr_b16 v[144:145], v176 offset:9472
    v_mfma_f32_32x32x16_bf16 v[66:81], v[102:105], v[110:113], v[66:81]
    v_mfma_f32_32x32x16_bf16 v[82:97], v[102:105], v[114:117], v[82:97]
    s_waitcnt lgkmcnt(0)
    v_mfma_f32_32x32x16_bf16 v[2:17], v[126:129], v[134:137], v[2:17]
    ds_read_b128 v[98:101], v164 offset:0
    ds_read_b128 v[102:105], v164 offset:4096
    v_mfma_f32_32x32x16_bf16 v[18:33], v[126:129], v[138:141], v[18:33]
    ds_read_b64_tr_b16 v[106:107], v176 offset:2048
    ds_read_b64_tr_b16 v[108:109], v176 offset:2304
    v_mfma_f32_32x32x16_bf16 v[34:49], v[126:129], v[142:145], v[34:49]
    ds_read_b64_tr_b16 v[110:111], v176 offset:6144
    ds_read_b64_tr_b16 v[112:113], v176 offset:6400
    v_mfma_f32_32x32x16_bf16 v[50:65], v[130:133], v[134:137], v[50:65]
    ds_read_b64_tr_b16 v[114:115], v176 offset:10240
    ds_read_b64_tr_b16 v[116:117], v176 offset:10496
    v_mfma_f32_32x32x16_bf16 v[66:81], v[130:133], v[138:141], v[66:81]
    v_mfma_f32_32x32x16_bf16 v[82:97], v[130:133], v[142:145], v[82:97]
    s_waitcnt lgkmcnt(0)
    v_mfma_f32_32x32x16_bf16 v[2:17], v[98:101], v[106:109], v[2:17]
    ds_read_b128 v[126:129], v165 offset:0
    ds_read_b128 v[130:133], v165 offset:4096
    v_mfma_f32_32x32x16_bf16 v[18:33], v[98:101], v[110:113], v[18:33]
    ds_read_b64_tr_b16 v[134:135], v176 offset:3072
    ds_read_b64_tr_b16 v[136:137], v176 offset:3328
    v_mfma_f32_32x32x16_bf16 v[34:49], v[98:101], v[114:117], v[34:49]
    ds_read_b64_tr_b16 v[138:139], v176 offset:7168
    ds_read_b64_tr_b16 v[140:141], v176 offset:7424
    v_mfma_f32_32x32x16_bf16 v[50:65], v[102:105], v[106:109], v[50:65]
    ds_read_b64_tr_b16 v[142:143], v176 offset:11264
    ds_read_b64_tr_b16 v[144:145], v176 offset:11520
    v_mfma_f32_32x32x16_bf16 v[66:81], v[102:105], v[110:113], v[66:81]
    v_mfma_f32_32x32x16_bf16 v[82:97], v[102:105], v[114:117], v[82:97]
    s_cmp_eq_u32 s73, 4
    s_cbranch_scc1 Lg_vx_done
    v_add_u32 v177, s101, v174
    s_add_u32 s101, s101, 24576
    s_cmp_eq_u32 s101, 73728
    s_cselect_b32 s101, 0, s101
    s_waitcnt vmcnt(3) lgkmcnt(0)
    v_mov_b32 v176, v177
    s_barrier
    v_mfma_f32_32x32x16_bf16 v[2:17], v[126:129], v[134:137], v[2:17]
    ds_read_b128 v[98:101], v158 offset:0
    ds_read_b128 v[102:105], v158 offset:4096
    v_mfma_f32_32x32x16_bf16 v[18:33], v[126:129], v[138:141], v[18:33]
    ds_read_b64_tr_b16 v[106:107], v176 offset:0
    ds_read_b64_tr_b16 v[108:109], v176 offset:256
    v_mfma_f32_32x32x16_bf16 v[34:49], v[126:129], v[142:145], v[34:49]
    ds_read_b64_tr_b16 v[110:111], v176 offset:4096
    ds_read_b64_tr_b16 v[112:113], v176 offset:4352
    v_mfma_f32_32x32x16_bf16 v[50:65], v[130:133], v[134:137], v[50:65]
    ds_read_b64_tr_b16 v[114:115], v176 offset:8192
    ds_read_b64_tr_b16 v[116:117], v176 offset:8448
    v_mfma_f32_32x32x16_bf16 v[66:81], v[130:133], v[138:141], v[66:81]
    v_mfma_f32_32x32x16_bf16 v[82:97], v[130:133], v[142:145], v[82:97]
    s_cmp_lg_u32 s73, 3
    s_cbranch_scc1 Lgn_145
    s_add_u32 s64, s64, 16
    s_cmp_ge_u32 s64, 112
    s_cbranch_scc1 Ldn_147
    s_cmp_ge_u32 s64, 96
    s_cbranch_scc1 Ldf_146
    s_mul_i32 s69, s64, 43691
    s_lshr_b32 s69, s69, 19
    s_mul_i32 s76, s69, 12
    s_sub_u32 s76, s64, s76
    s_lshr_b32 s71, s76, 2
    s_and_b32 s76, s76, 3
    s_lshl_b32 s77, s49, 2
    s_add_u32 s76, s76, s77
    s_mul_i32 s100, s69, 327680
    s_mul_i32 s66, s76, 384
    s_mov_b32 s67, 12288
    s_cmp_eq_u32 s71, 1
    s_cselect_b32 s60, s22, s20
    s_cselect_b32 s61, s23, s21
    s_cmp_eq_u32 s71, 2
    s_cselect_b32 s60, s24, s60
    s_cselect_b32 s61, s25, s61
    s_mov_b32 s62, 7864320
    s_mul_i32 s72, s71, 25165824
    s_mul_i32 s77, s76, 786432
    s_add_u32 s72, s72, s77
    s_mul_i32 s77, s69, 98304
    s_add_u32 s72, s72, s77
    s_mul_i32 s77, s48, 3
    s_lshr_b32 s78, s77, 2
    s_branch Ldd_148
Ldf_146:
    s_sub_u32 s76, s64, 96
    s_lshr_b32 s69, s76, 1
    s_and_b32 s76, s76, 1
    s_mov_b32 s71, 3
    s_mul_i32 s100, s69, 327680
    s_mul_i32 s66, s49, 384
    s_mul_i32 s77, s76, 192
    s_add_u32 s66, s66, s77
    s_mov_b32 s67, 3072
    s_cmp_ge_u32 s48, 4
    s_cselect_b32 s60, s34, s32
    s_cselect_b32 s61, s35, s33
    s_mov_b32 s62, 1966080
    s_mul_i32 s72, s69, 786432
    s_lshl_b32 s77, s66, 4
    s_add_u32 s72, s72, s77
    s_add_u32 s72, s72, 100663296
    s_and_b32 s77, s48, 3
    s_mul_i32 s77, s77, 3
    s_lshr_b32 s78, s77, 2
    s_branch Ldd_148
Ldn_147:
    s_mov_b32 s71, 4
    s_mov_b32 s62, 0
    s_mov_b32 s77, 0
    s_mov_b32 s78, 0
Ldd_148:
    s_add_u32 s69, s77, 0
    s_lshr_b32 s76, s69, 2
    s_and_b32 s69, s69, 3
    s_lshl_b32 s69, s69, 4
    s_mul_i32 s69, s69, s67
    s_lshl_b32 s76, s76, 6
    s_add_u32 s69, s69, s76
    s_add_u32 s94, s69, s66
    s_add_u32 s69, s77, 1
    s_lshr_b32 s76, s69, 2
    s_and_b32 s69, s69, 3
    s_lshl_b32 s69, s69, 4
    s_mul_i32 s69, s69, s67
    s_lshl_b32 s76, s76, 6
    s_add_u32 s69, s69, s76
    s_add_u32 s95, s69, s66
    s_add_u32 s69, s77, 2
    s_lshr_b32 s76, s69, 2
    s_and_b32 s69, s69, 3
    s_lshl_b32 s69, s69, 4
    s_mul_i32 s69, s69, s67
    s_lshl_b32 s76, s76, 6
    s_add_u32 s69, s69, s76
    s_add_u32 s96, s69, s66
    s_mul_i32 s69, s48, 40960
    s_add_u32 s100, s100, s69
    s_lshl_b32 s47, s67, 6
    v_mul_lo_u32 v156, v178, s67
    v_add_u32 v156, v156, v179
Lgn_145:
    s_add_u32 m0, s74, 32768
    s_nop 0
    buffer_load_dwordx4 v154, s[56:59], s65 offen lds
    s_add_u32 m0, s74, 33792
    s_add_u32 s69, s65, 10240
    buffer_load_dwordx4 v155, s[56:59], s69 offen lds
    s_add_u32 m0, s74, 34816
    s_add_u32 s69, s65, 20480
    buffer_load_dwordx4 v154, s[56:59], s69 offen lds
    s_add_u32 m0, s74, 35840
    s_add_u32 s69, s65, 30720
    buffer_load_dwordx4 v155, s[56:59], s69 offen lds
    s_add_u32 s65, s65, 128
    s_add_u32 s76, s75, s97
    s_add_u32 m0, s76, 0
    s_nop 0
    buffer_load_dwordx4 v156, s[60:63], s94 offen lds
    s_add_u32 s94, s94, s47
    s_add_u32 m0, s76, 1024
    s_nop 0
    buffer_load_dwordx4 v156, s[60:63], s95 offen lds
    s_add_u32 s95, s95, s47
    s_add_u32 m0, s76, 2048
    s_nop 0
    buffer_load_dwordx4 v156, s[60:63], s96 offen lds
    s_add_u32 s96, s96, s47
    s_add_u32 s97, s97, 24576
    s_cmp_eq_u32 s97, 73728
    s_cselect_b32 s97, 0, s97
    s_waitcnt lgkmcnt(0)
    v_mfma_f32_32x32x16_bf16 v[2:17], v[98:101], v[106:109], v[2:17]
    ds_read_b128 v[126:129], v159 offset:0
    ds_read_b128 v[130:133], v159 offset:4096
    v_mfma_f32_32x32x16_bf16 v[18:33], v[98:101], v[110:113], v[18:33]
    ds_read_b64_tr_b16 v[134:135], v176 offset:1024
    ds_read_b64_tr_b16 v[136:137], v176 offset:1280
    v_mfma_f32_32x32x16_bf16 v[34:49], v[98:101], v[114:117], v[34:49]
    ds_read_b64_tr_b16 v[138:139], v176 offset:5120
    ds_read_b64_tr_b16 v[140:141], v176 offset:5376
    v_mfma_f32_32x32x16_bf16 v[50:65], v[102:105], v[106:109], v[50:65]
    ds_read_b64_tr_b16 v[142:143], v176 offset:9216
    ds_read_b64_tr_b16 v[144:145], v176 offset:9472
    v_mfma_f32_32x32x16_bf16 v[66:81], v[102:105], v[110:113], v[66:81]
    v_mfma_f32_32x32x16_bf16 v[82:97], v[102:105], v[114:117], v[82:97]
    s_waitcnt lgkmcnt(0)
    v_mfma_f32_32x32x16_bf16 v[2:17], v[126:129], v[134:137], v[2:17]
    ds_read_b128 v[98:101], v160 offset:0
    ds_read_b128 v[102:105], v160 offset:4096
    v_mfma_f32_32x32x16_bf16 v[18:33], v[126:129], v[138:141], v[18:33]
    ds_read_b64_tr_b16 v[106:107], v176 offset:2048
    ds_read_b64_tr_b16 v[108:109], v176 offset:2304
    v_mfma_f32_32x32x16_bf16 v[34:49], v[126:129], v[142:145], v[34:49]
    ds_read_b64_tr_b16 v[110:111], v176 offset:6144
    ds_read_b64_tr_b16 v[112:113], v176 offset:6400
    v_mfma_f32_32x32x16_bf16 v[50:65], v[130:133], v[134:137], v[50:65]
    ds_read_b64_tr_b16 v[114:115], v176 offset:10240
    ds_read_b64_tr_b16 v[116:117], v176 offset:10496
    v_mfma_f32_32x32x16_bf16 v[66:81], v[130:133], v[138:141], v[66:81]
    v_mfma_f32_32x32x16_bf16 v[82:97], v[130:133], v[142:145], v[82:97]
    s_waitcnt lgkmcnt(0)
    v_mfma_f32_32x32x16_bf16 v[2:17], v[98:101], v[106:109], v[2:17]
    ds_read_b128 v[126:129], v161 offset:0
    ds_read_b128 v[130:133], v161 offset:4096
    v_mfma_f32_32x32x16_bf16 v[18:33], v[98:101], v[110:113], v[18:33]
    ds_read_b64_tr_b16 v[134:135], v176 offset:3072
    ds_read_b64_tr_b16 v[136:137], v176 offset:3328
    v_mfma_f32_32x32x16_bf16 v[34:49], v[98:101], v[114:117], v[34:49]
    ds_read_b64_tr_b16 v[138:139], v176 offset:7168
    ds_read_b64_tr_b16 v[140:141], v176 offset:7424
    v_mfma_f32_32x32x16_bf16 v[50:65], v[102:105], v[106:109], v[50:65]
    ds_read_b64_tr_b16 v[142:143], v176 offset:11264
    ds_read_b64_tr_b16 v[144:145], v176 offset:11520
    v_mfma_f32_32x32x16_bf16 v[66:81], v[102:105], v[110:113], v[66:81]
    v_mfma_f32_32x32x16_bf16 v[82:97], v[102:105], v[114:117], v[82:97]
    s_add_u32 s73, s73, 1
    s_branch LLg_vx_141
Lg_vx_done:
    s_waitcnt lgkmcnt(0)
    v_mfma_f32_32x32x16_bf16 v[2:17], v[126:129], v[134:137], v[2:17]
    v_mfma_f32_32x32x16_bf16 v[18:33], v[126:129], v[138:141], v[18:33]
    v_mfma_f32_32x32x16_bf16 v[34:49], v[126:129], v[142:145], v[34:49]
    v_mfma_f32_32x32x16_bf16 v[50:65], v[130:133], v[134:137], v[50:65]
    v_mfma_f32_32x32x16_bf16 v[66:81], v[130:133], v[138:141], v[66:81]
    v_mfma_f32_32x32x16_bf16 v[82:97], v[130:133], v[142:145], v[82:97]
    s_nop 7
    s_nop 3
    s_cmp_lg_u32 s80, 0
    s_cbranch_scc1 Lgreg_149
    v_and_b32 v183, 63, v0
    v_lshlrev_b32 v182, 2, v183
Lreg_150:
    buffer_load_dword v181, v182, s[8:11], 0 offen sc0 sc1
    s_waitcnt vmcnt(0)
    v_readlane_b32 s69, v181, 8
    v_readlane_b32 s76, v181, 8
    s_add_u32 s69, s69, s76
    s_cmp_ge_u32 s69, 512
    s_cbranch_scc1 Lregd_151
    s_sleep 24
    s_sub_u32 s54, s54, 1
    s_cbranch_scc0 Lreg_150
    s_mov_b32 s54, 0
Lregd_151:
    v_readlane_b32 s79, v181, 34
    v_cmp_ne_u32 vcc, 32, v181
    s_and_b32 s79, s79, 1
    s_and_b32 s69, vcc_lo, 0xf
    s_and_b32 s76, vcc_hi, 0xf00
    s_or_b32 s69, s69, s76
    s_cselect_b32 s53, 1, 0
Lgreg_149:
    s_lshr_b32 s69, s81, 2
    s_mul_i32 s76, s69, 43691
    s_lshr_b32 s76, s76, 19
    s_mul_i32 s77, s76, 12
    s_sub_u32 s69, s69, s77
    s_mul_i32 s77, s49, 12
    s_add_u32 s69, s69, s77
    s_lshl_b32 s69, s69, 3
    s_add_u32 s69, s69, s48
    s_cmp_ge_u32 s69, 640
    s_cbranch_scc1 Lgci_152
    s_mul_i32 s77, s69, 52429
    s_lshr_b32 s77, s77, 22
    s_mul_i32 s78, s77, 80
    s_sub_u32 s69, s69, s78
    s_lshl_b32 s76, s76, 3
    s_add_u32 s76, s76, s77
    s_cmp_ge_u32 s76, 9
    s_cbranch_scc1 Lgci_152
    s_cmp_eq_u32 s76, 0
    s_cbranch_scc1 Lgci_152
    s_mul_i32 s77, s76, 86
    s_lshr_b32 s77, s77, 8
    s_mul_i32 s76, s76, 655360
    s_mul_i32 s78, s77, 131072
    s_add_u32 s76, s76, s78
    s_xor_b32 s77, s77, s79
    s_and_b32 s77, s77, 1
    s_lshl_b32 s77, s77, 13
    s_add_u32 s76, s76, s77
    s_lshr_b32 s77, s69, 1
    s_lshl_b32 s77, s77, 14
    s_add_u32 s76, s76, s77
    s_and_b32 s77, s69, 1
    s_lshl_b32 s77, s77, 12
    s_add_u32 s76, s76, s77
    s_add_u32 s76, s76, 167772160
    v_mov_b32 v98, -1
    v_mov_b32 v99, -1
    v_mov_b32 v100, -1
    v_mov_b32 v101, -1
    v_lshlrev_b32 v102, 4, v180
    buffer_store_dwordx4 v[98:101], v102, s[4:7], s76 offen offset:0 sc1
    buffer_store_dwordx4 v[98:101], v102, s[4:7], s76 offen offset:1024 sc1
    buffer_store_dwordx4 v[98:101], v102, s[4:7], s76 offen offset:2048 sc1
    buffer_store_dwordx4 v[98:101], v102, s[4:7], s76 offen offset:3072 sc1
Lgci_152:
    s_add_u32 s69, s70, 0
    s_add_u32 s76, s70, 12288
    v_cvt_pk_bf16_f32 v2, v2, v3
    v_cvt_pk_bf16_f32 v3, v4, v5
    v_cvt_pk_bf16_f32 v4, v10, v11
    v_cvt_pk_bf16_f32 v5, v12, v13
    v_cvt_pk_bf16_f32 v6, v6, v7
    v_cvt_pk_bf16_f32 v7, v8, v9
    v_cvt_pk_bf16_f32 v8, v14, v15
    v_cvt_pk_bf16_f32 v9, v16, v17
    v_cvt_pk_bf16_f32 v18, v18, v19
    v_cvt_pk_bf16_f32 v19, v20, v21
    v_cvt_pk_bf16_f32 v20, v26, v27
    v_cvt_pk_bf16_f32 v21, v28, v29
    v_cvt_pk_bf16_f32 v22, v22, v23
    v_cvt_pk_bf16_f32 v23, v24, v25
    v_cvt_pk_bf16_f32 v24, v30, v31
    v_cvt_pk_bf16_f32 v25, v32, v33
    v_cvt_pk_bf16_f32 v34, v34, v35
    v_cvt_pk_bf16_f32 v35, v36, v37
    v_cvt_pk_bf16_f32 v36, v42, v43
    v_cvt_pk_bf16_f32 v37, v44, v45
    v_cvt_pk_bf16_f32 v38, v38, v39
    v_cvt_pk_bf16_f32 v39, v40, v41
    v_cvt_pk_bf16_f32 v40, v46, v47
    v_cvt_pk_bf16_f32 v41, v48, v49
    v_cvt_pk_bf16_f32 v50, v50, v51
    v_cvt_pk_bf16_f32 v51, v52, v53
    v_cvt_pk_bf16_f32 v52, v58, v59
    v_cvt_pk_bf16_f32 v53, v60, v61
    v_cvt_pk_bf16_f32 v54, v54, v55
    v_cvt_pk_bf16_f32 v55, v56, v57
    v_cvt_pk_bf16_f32 v56, v62, v63
    v_cvt_pk_bf16_f32 v57, v64, v65
    v_cvt_pk_bf16_f32 v66, v66, v67
    v_cvt_pk_bf16_f32 v67, v68, v69
    v_cvt_pk_bf16_f32 v68, v74, v75
    v_cvt_pk_bf16_f32 v69, v76, v77
    v_cvt_pk_bf16_f32 v70, v70, v71
    v_cvt_pk_bf16_f32 v71, v72, v73
    v_cvt_pk_bf16_f32 v72, v78, v79
    v_cvt_pk_bf16_f32 v73, v80, v81
    v_cvt_pk_bf16_f32 v82, v82, v83
    v_cvt_pk_bf16_f32 v83, v84, v85
    v_cvt_pk_bf16_f32 v84, v90, v91
    v_cvt_pk_bf16_f32 v85, v92, v93
    v_cvt_pk_bf16_f32 v86, v86, v87
    v_cvt_pk_bf16_f32 v87, v88, v89
    v_cvt_pk_bf16_f32 v88, v94, v95
    v_cvt_pk_bf16_f32 v89, v96, v97
    buffer_store_dwordx4 v[2:5], v185, s[4:7], s69 offen offset:0 sc1
    buffer_store_dwordx4 v[6:9], v185, s[4:7], s69 offen offset:512 sc1
    buffer_store_dwordx4 v[18:21], v185, s[4:7], s69 offen offset:2048 sc1
    buffer_store_dwordx4 v[22:25], v185, s[4:7], s69 offen offset:2560 sc1
    s_add_u32 s77, s69, 4096
    buffer_store_dwordx4 v[34:37], v185, s[4:7], s77 offen offset:0 sc1
    s_add_u32 s77, s69, 4096
    buffer_store_dwordx4 v[38:41], v185, s[4:7], s77 offen offset:512 sc1
    buffer_store_dwordx4 v[50:53], v185, s[4:7], s76 offen offset:0 sc1
    buffer_store_dwordx4 v[54:57], v185, s[4:7], s76 offen offset:512 sc1
    buffer_store_dwordx4 v[66:69], v185, s[4:7], s76 offen offset:2048 sc1
    buffer_store_dwordx4 v[70:73], v185, s[4:7], s76 offen offset:2560 sc1
    s_add_u32 s77, s76, 4096
    buffer_store_dwordx4 v[82:85], v185, s[4:7], s77 offen offset:0 sc1
    s_add_u32 s77, s76, 4096
    buffer_store_dwordx4 v[86:89], v185, s[4:7], s77 offen offset:512 sc1
    s_mul_i32 s80, s49, 512
    s_add_u32 s80, s80, s81
    s_add_u32 s80, s80, 152043520
    s_cmp_ge_u32 s81, 64
    s_cbranch_scc1 Lgff_153
    s_waitcnt vmcnt(0)
    s_barrier
    s_cmp_eq_u32 s80, 0
    s_cbranch_scc1 Lgf_154
    s_cmp_lg_u32 s48, 0
    s_cbranch_scc1 Lgf_154
    s_mov_b64 exec, 1
    buffer_store_dword v187, v188, s[4:7], s80 offen sc1
    s_mov_b64 exec, -1
Lgf_154:
Lgff_153:
    s_branch Lgnext_126
Lg_f:
    s_lshl_b32 s73, s49, 4
    s_add_u32 s73, s73, s50
    s_sub_u32 s73, s73, 16
    s_lshl_b32 s73, s73, 3
    s_add_u32 s73, s73, s48
    s_lshl_b32 s73, s73, 1
    v_lshlrev_b32 v10, 2, v180
    s_mov_b32 s12, s38
    s_mov_b32 s13, s39
    s_mov_b32 s14, 1280
    s_mov_b32 s15, 0x20000
    buffer_load_dword v2, v10, s[12:15], 0 offen offset:0
    buffer_load_dword v3, v10, s[12:15], 0 offen offset:256
    buffer_load_dword v4, v10, s[12:15], 0 offen offset:512
    buffer_load_dword v5, v10, s[12:15], 0 offen offset:768
    buffer_load_dword v6, v10, s[12:15], 0 offen offset:1024
    s_mov_b32 s12, s16
    s_mov_b32 s13, s17
    s_mov_b32 s14, 2621440
    s_mov_b32 s15, 0x20000
    s_mul_i32 s76, s73, 1280
    buffer_load_dword v12, v10, s[12:15], s76 offen offset:0
    buffer_load_dword v13, v10, s[12:15], s76 offen offset:256
    buffer_load_dword v14, v10, s[12:15], s76 offen offset:512
    buffer_load_dword v15, v10, s[12:15], s76 offen offset:768
    buffer_load_dword v16, v10, s[12:15], s76 offen offset:1024
    buffer_load_dword v17, v10, s[12:15], s76 offen offset:1280
    buffer_load_dword v18, v10, s[12:15], s76 offen offset:1536
    buffer_load_dword v19, v10, s[12:15], s76 offen offset:1792
    buffer_load_dword v20, v10, s[12:15], s76 offen offset:2048
    buffer_load_dword v21, v10, s[12:15], s76 offen offset:2304
    s_waitcnt vmcnt(0)
    v_mov_b32 v7, 0
    v_lshlrev_b32 v8, 16, v12
    v_lshlrev_b32 v9, 16, v2
    v_fmac_f32 v7, v8, v9
    v_and_b32 v8, 0xffff0000, v12
    v_and_b32 v9, 0xffff0000, v2
    v_fmac_f32 v7, v8, v9
    v_lshlrev_b32 v8, 16, v13
    v_lshlrev_b32 v9, 16, v3
    v_fmac_f32 v7, v8, v9
    v_and_b32 v8, 0xffff0000, v13
    v_and_b32 v9, 0xffff0000, v3
    v_fmac_f32 v7, v8, v9
    v_lshlrev_b32 v8, 16, v14
    v_lshlrev_b32 v9, 16, v4
    v_fmac_f32 v7, v8, v9
    v_and_b32 v8, 0xffff0000, v14
    v_and_b32 v9, 0xffff0000, v4
    v_fmac_f32 v7, v8, v9
    v_lshlrev_b32 v8, 16, v15
    v_lshlrev_b32 v9, 16, v5
    v_fmac_f32 v7, v8, v9
    v_and_b32 v8, 0xffff0000, v15
    v_and_b32 v9, 0xffff0000, v5
    v_fmac_f32 v7, v8, v9
    v_lshlrev_b32 v8, 16, v16
    v_lshlrev_b32 v9, 16, v6
    v_fmac_f32 v7, v8, v9
    v_and_b32 v8, 0xffff0000, v16
    v_and_b32 v9, 0xffff0000, v6
    v_fmac_f32 v7, v8, v9
    s_nop 1
    v_add_f32_dpp v7, v7, v7 row_ror:8 row_mask:0xf bank_mask:0xf
    s_nop 1
    v_add_f32_dpp v7, v7, v7 row_ror:4 row_mask:0xf bank_mask:0xf
    s_nop 1
    v_add_f32_dpp v7, v7, v7 row_ror:2 row_mask:0xf bank_mask:0xf
    s_nop 1
    v_add_f32_dpp v7, v7, v7 row_ror:1 row_mask:0xf bank_mask:0xf
    v_mov_b32 v8, v7
    s_nop 1
    v_permlane16_swap_b32 v7, v8
    v_add_f32 v7, v7, v8
    v_mov_b32 v8, v7
    s_nop 1
    v_permlane32_swap_b32 v7, v8
    v_add_f32 v7, v7, v8
    v_mul_f32 v7, 0xbfb8aa3b, v7
    v_exp_f32 v7, v7
    s_nop 0
    v_add_f32 v7, 1.0, v7
    v_rcp_f32 v7, v7
    v_mov_b32 v8, 0
    s_lshl_b32 s69, s73, 2
    s_add_u32 s69, s69, 152305664
    s_mov_b64 exec, 1
    buffer_store_dword v7, v8, s[4:7], s69 offen sc1
    s_mov_b64 exec, -1
    v_mov_b32 v7, 0
    v_lshlrev_b32 v8, 16, v17
    v_lshlrev_b32 v9, 16, v2
    v_fmac_f32 v7, v8, v9
    v_and_b32 v8, 0xffff0000, v17
    v_and_b32 v9, 0xffff0000, v2
    v_fmac_f32 v7, v8, v9
    v_lshlrev_b32 v8, 16, v18
    v_lshlrev_b32 v9, 16, v3
    v_fmac_f32 v7, v8, v9
    v_and_b32 v8, 0xffff0000, v18
    v_and_b32 v9, 0xffff0000, v3
    v_fmac_f32 v7, v8, v9
    v_lshlrev_b32 v8, 16, v19
    v_lshlrev_b32 v9, 16, v4
    v_fmac_f32 v7, v8, v9
    v_and_b32 v8, 0xffff0000, v19
    v_and_b32 v9, 0xffff0000, v4
    v_fmac_f32 v7, v8, v9
    v_lshlrev_b32 v8, 16, v20
    v_lshlrev_b32 v9, 16, v5
    v_fmac_f32 v7, v8, v9
    v_and_b32 v8, 0xffff0000, v20
    v_and_b32 v9, 0xffff0000, v5
    v_fmac_f32 v7, v8, v9
    v_lshlrev_b32 v8, 16, v21
    v_lshlrev_b32 v9, 16, v6
    v_fmac_f32 v7, v8, v9
    v_and_b32 v8, 0xffff0000, v21
    v_and_b32 v9, 0xffff0000, v6
    v_fmac_f32 v7, v8, v9
    s_nop 1
    v_add_f32_dpp v7, v7, v7 row_ror:8 row_mask:0xf bank_mask:0xf
    s_nop 1
    v_add_f32_dpp v7, v7, v7 row_ror:4 row_mask:0xf bank_mask:0xf
    s_nop 1
    v_add_f32_dpp v7, v7, v7 row_ror:2 row_mask:0xf bank_mask:0xf
    s_nop 1
    v_add_f32_dpp v7, v7, v7 row_ror:1 row_mask:0xf bank_mask:0xf
    v_mov_b32 v8, v7
    s_nop 1
    v_permlane16_swap_b32 v7, v8
    v_add_f32 v7, v7, v8
    v_mov_b32 v8, v7
    s_nop 1
    v_permlane32_swap_b32 v7, v8
    v_add_f32 v7, v7, v8
    v_mul_f32 v7, 0xbfb8aa3b, v7
    v_exp_f32 v7, v7
    s_nop 0
    v_add_f32 v7, 1.0, v7
    v_rcp_f32 v7, v7
    v_mov_b32 v8, 0
    s_lshl_b32 s69, s73, 2
    s_add_u32 s69, s69, 152305668
    s_mov_b64 exec, 1
    buffer_store_dword v7, v8, s[4:7], s69 offen sc1
    s_mov_b64 exec, -1
    s_waitcnt vmcnt(0)
    v_add_u32 v177, s101, v175
    s_add_u32 s101, s101, 24576
    s_cmp_eq_u32 s101, 73728
    s_cselect_b32 s101, 0, s101
    s_waitcnt vmcnt(15) lgkmcnt(0)
    v_mov_b32 v176, v177
    s_barrier
    s_cmp_lg_u32 s48, 1
    s_cbranch_scc1 Lgg_156
    v_mov_b32 v181, 132
    s_mov_b64 exec, 1
    buffer_atomic_add v187, v181, s[8:11], 0 offen sc1
    s_mov_b64 exec, -1
Lgg_156:
    ds_read_b128 v[98:101], v166 offset:0
    ds_read_b64_tr_b16 v[102:103], v176 offset:0
    ds_read_b64_tr_b16 v[104:105], v176 offset:256
    ds_read_b64_tr_b16 v[106:107], v176 offset:4096
    ds_read_b64_tr_b16 v[108:109], v176 offset:4352
    ds_read_b64_tr_b16 v[110:111], v176 offset:8192
    ds_read_b64_tr_b16 v[112:113], v176 offset:8448
    ds_read_b64_tr_b16 v[114:115], v176 offset:12288
    ds_read_b64_tr_b16 v[116:117], v176 offset:12544
    ds_read_b64_tr_b16 v[118:119], v176 offset:16384
    ds_read_b64_tr_b16 v[120:121], v176 offset:16640
    ds_read_b64_tr_b16 v[122:123], v176 offset:20480
    ds_read_b64_tr_b16 v[124:125], v176 offset:20736
    s_add_u32 m0, s74, 32768
    s_nop 0
    buffer_load_dwordx4 v154, s[56:59], s65 offen lds
    s_add_u32 m0, s74, 33792
    s_add_u32 s69, s65, 10240
    buffer_load_dwordx4 v155, s[56:59], s69 offen lds
    s_add_u32 m0, s74, 34816
    s_add_u32 s69, s65, 20480
    buffer_load_dwordx4 v154, s[56:59], s69 offen lds
    s_add_u32 m0, s74, 35840
    s_add_u32 s69, s65, 30720
    buffer_load_dwordx4 v155, s[56:59], s69 offen lds
    s_add_u32 s65, s65, 128
    s_add_u32 s76, s75, s97
    s_add_u32 m0, s76, 0
    s_nop 0
    buffer_load_dwordx4 v156, s[60:63], s94 offen lds
    s_add_u32 s94, s94, s47
    s_add_u32 m0, s76, 1024
    s_nop 0
    buffer_load_dwordx4 v156, s[60:63], s95 offen lds
    s_add_u32 s95, s95, s47
    s_add_u32 m0, s76, 2048
    s_nop 0
    buffer_load_dwordx4 v156, s[60:63], s96 offen lds
    s_add_u32 s96, s96, s47
    s_add_u32 s97, s97, 24576
    s_cmp_eq_u32 s97, 73728
    s_cselect_b32 s97, 0, s97
    s_waitcnt lgkmcnt(0)
    v_mfma_f32_32x32x16_bf16 v[2:17], v[102:105], v[98:101], 0
    ds_read_b128 v[126:129], v167 offset:0
    ds_read_b64_tr_b16 v[130:131], v176 offset:1024
    ds_read_b64_tr_b16 v[132:133], v176 offset:1280
    v_mfma_f32_32x32x16_bf16 v[18:33], v[106:109], v[98:101], 0
    ds_read_b64_tr_b16 v[134:135], v176 offset:5120
    ds_read_b64_tr_b16 v[136:137], v176 offset:5376
    ds_read_b64_tr_b16 v[138:139], v176 offset:9216
    v_mfma_f32_32x32x16_bf16 v[34:49], v[110:113], v[98:101], 0
    ds_read_b64_tr_b16 v[140:141], v176 offset:9472
    ds_read_b64_tr_b16 v[142:143], v176 offset:13312
    ds_read_b64_tr_b16 v[144:145], v176 offset:13568
    v_mfma_f32_32x32x16_bf16 v[50:65], v[114:117], v[98:101], 0
    ds_read_b64_tr_b16 v[146:147], v176 offset:17408
    ds_read_b64_tr_b16 v[148:149], v176 offset:17664
    ds_read_b64_tr_b16 v[150:151], v176 offset:21504
    v_mfma_f32_32x32x16_bf16 v[66:81], v[118:121], v[98:101], 0
    ds_read_b64_tr_b16 v[152:153], v176 offset:21760
    v_mfma_f32_32x32x16_bf16 v[82:97], v[122:125], v[98:101], 0
    s_waitcnt lgkmcnt(0)
    v_mfma_f32_32x32x16_bf16 v[2:17], v[130:133], v[126:129], v[2:17]
    ds_read_b128 v[98:101], v168 offset:0
    ds_read_b64_tr_b16 v[102:103], v176 offset:2048
    ds_read_b64_tr_b16 v[104:105], v176 offset:2304
    v_mfma_f32_32x32x16_bf16 v[18:33], v[134:137], v[126:129], v[18:33]
    ds_read_b64_tr_b16 v[106:107], v176 offset:6144
    ds_read_b64_tr_b16 v[108:109], v176 offset:6400
    ds_read_b64_tr_b16 v[110:111], v176 offset:10240
    v_mfma_f32_32x32x16_bf16 v[34:49], v[138:141], v[126:129], v[34:49]
    ds_read_b64_tr_b16 v[112:113], v176 offset:10496
    ds_read_b64_tr_b16 v[114:115], v176 offset:14336
    ds_read_b64_tr_b16 v[116:117], v176 offset:14592
    v_mfma_f32_32x32x16_bf16 v[50:65], v[142:145], v[126:129], v[50:65]
    ds_read_b64_tr_b16 v[118:119], v176 offset:18432
    ds_read_b64_tr_b16 v[120:121], v176 offset:18688
    ds_read_b64_tr_b16 v[122:123], v176 offset:22528
    v_mfma_f32_32x32x16_bf16 v[66:81], v[146:149], v[126:129], v[66:81]
    ds_read_b64_tr_b16 v[124:125], v176 offset:22784
    v_mfma_f32_32x32x16_bf16 v[82:97], v[150:153], v[126:129], v[82:97]
    s_waitcnt lgkmcnt(0)
    v_mfma_f32_32x32x16_bf16 v[2:17], v[102:105], v[98:101], v[2:17]
    ds_read_b128 v[126:129], v169 offset:0
    ds_read_b64_tr_b16 v[130:131], v176 offset:3072
    ds_read_b64_tr_b16 v[132:133], v176 offset:3328
    v_mfma_f32_32x32x16_bf16 v[18:33], v[106:109], v[98:101], v[18:33]
    ds_read_b64_tr_b16 v[134:135], v176 offset:7168
    ds_read_b64_tr_b16 v[136:137], v176 offset:7424
    ds_read_b64_tr_b16 v[138:139], v176 offset:11264
    v_mfma_f32_32x32x16_bf16 v[34:49], v[110:113], v[98:101], v[34:49]
    ds_read_b64_tr_b16 v[140:141], v176 offset:11520
    ds_read_b64_tr_b16 v[142:143], v176 offset:15360
    ds_read_b64_tr_b16 v[144:145], v176 offset:15616
    v_mfma_f32_32x32x16_bf16 v[50:65], v[114:117], v[98:101], v[50:65]
    ds_read_b64_tr_b16 v[146:147], v176 offset:19456
    ds_read_b64_tr_b16 v[148:149], v176 offset:19712
    ds_read_b64_tr_b16 v[150:151], v176 offset:23552
    v_mfma_f32_32x32x16_bf16 v[66:81], v[118:121], v[98:101], v[66:81]
    ds_read_b64_tr_b16 v[152:153], v176 offset:23808
    v_mfma_f32_32x32x16_bf16 v[82:97], v[122:125], v[98:101], v[82:97]
    s_mov_b32 s73, 0
LLg_fx_155:
    v_add_u32 v177, s101, v175
    s_add_u32 s101, s101, 24576
    s_cmp_eq_u32 s101, 73728
    s_cselect_b32 s101, 0, s101
    s_waitcnt vmcnt(3) lgkmcnt(0)
    v_mov_b32 v176, v177
    s_barrier
    s_cmp_lg_u32 s73, 0
    s_cbranch_scc1 Lgnf_157
    s_cmp_eq_u32 s80, 0
    s_cbranch_scc1 Lgf_158
    s_cmp_lg_u32 s48, 0
    s_cbranch_scc1 Lgf_158
    s_mov_b64 exec, 1
    buffer_store_dword v187, v188, s[4:7], s80 offen sc1
    s_mov_b64 exec, -1
Lgf_158:
Lgnf_157:
    v_mfma_f32_32x32x16_bf16 v[2:17], v[130:133], v[126:129], v[2:17]
    ds_read_b128 v[98:101], v170 offset:0
    ds_read_b64_tr_b16 v[102:103], v176 offset:0
    ds_read_b64_tr_b16 v[104:105], v176 offset:256
    v_mfma_f32_32x32x16_bf16 v[18:33], v[134:137], v[126:129], v[18:33]
    ds_read_b64_tr_b16 v[106:107], v176 offset:4096
    ds_read_b64_tr_b16 v[108:109], v176 offset:4352
    ds_read_b64_tr_b16 v[110:111], v176 offset:8192
    v_mfma_f32_32x32x16_bf16 v[34:49], v[138:141], v[126:129], v[34:49]
    ds_read_b64_tr_b16 v[112:113], v176 offset:8448
    ds_read_b64_tr_b16 v[114:115], v176 offset:12288
    ds_read_b64_tr_b16 v[116:117], v176 offset:12544
    v_mfma_f32_32x32x16_bf16 v[50:65], v[142:145], v[126:129], v[50:65]
    ds_read_b64_tr_b16 v[118:119], v176 offset:16384
    ds_read_b64_tr_b16 v[120:121], v176 offset:16640
    ds_read_b64_tr_b16 v[122:123], v176 offset:20480
    v_mfma_f32_32x32x16_bf16 v[66:81], v[146:149], v[126:129], v[66:81]
    ds_read_b64_tr_b16 v[124:125], v176 offset:20736
    v_mfma_f32_32x32x16_bf16 v[82:97], v[150:153], v[126:129], v[82:97]
    s_cmp_eq_u32 s73, 4
    s_cselect_b32 s65, s100, s65
Lgn_159:
    s_add_u32 m0, s74, 0
    s_nop 0
    buffer_load_dwordx4 v154, s[56:59], s65 offen lds
    s_add_u32 m0, s74, 1024
    s_add_u32 s69, s65, 10240
    buffer_load_dwordx4 v155, s[56:59], s69 offen lds
    s_add_u32 m0, s74, 2048
    s_add_u32 s69, s65, 20480
    buffer_load_dwordx4 v154, s[56:59], s69 offen lds
    s_add_u32 m0, s74, 3072
    s_add_u32 s69, s65, 30720
    buffer_load_dwordx4 v155, s[56:59], s69 offen lds
    s_add_u32 s65, s65, 128
    s_add_u32 s76, s75, s97
    s_add_u32 m0, s76, 0
    s_nop 0
    buffer_load_dwordx4 v156, s[60:63], s94 offen lds
    s_add_u32 s94, s94, s47
    s_add_u32 m0, s76, 1024
    s_nop 0
    buffer_load_dwordx4 v156, s[60:63], s95 offen lds
    s_add_u32 s95, s95, s47
    s_add_u32 m0, s76, 2048
    s_nop 0
    buffer_load_dwordx4 v156, s[60:63], s96 offen lds
    s_add_u32 s96, s96, s47
    s_add_u32 s97, s97, 24576
    s_cmp_eq_u32 s97, 73728
    s_cselect_b32 s97, 0, s97
    s_waitcnt lgkmcnt(0)
    v_mfma_f32_32x32x16_bf16 v[2:17], v[102:105], v[98:101], v[2:17]
    ds_read_b128 v[126:129], v171 offset:0
    ds_read_b64_tr_b16 v[130:131], v176 offset:1024
    ds_read_b64_tr_b16 v[132:133], v176 offset:1280
    v_mfma_f32_32x32x16_bf16 v[18:33], v[106:109], v[98:101], v[18:33]
    ds_read_b64_tr_b16 v[134:135], v176 offset:5120
    ds_read_b64_tr_b16 v[136:137], v176 offset:5376
    ds_read_b64_tr_b16 v[138:139], v176 offset:9216
    v_mfma_f32_32x32x16_bf16 v[34:49], v[110:113], v[98:101], v[34:49]
    ds_read_b64_tr_b16 v[140:141], v176 offset:9472
    ds_read_b64_tr_b16 v[142:143], v176 offset:13312
    ds_read_b64_tr_b16 v[144:145], v176 offset:13568
    v_mfma_f32_32x32x16_bf16 v[50:65], v[114:117], v[98:101], v[50:65]
    ds_read_b64_tr_b16 v[146:147], v176 offset:17408
    ds_read_b64_tr_b16 v[148:149], v176 offset:17664
    ds_read_b64_tr_b16 v[150:151], v176 offset:21504
    v_mfma_f32_32x32x16_bf16 v[66:81], v[118:121], v[98:101], v[66:81]
    ds_read_b64_tr_b16 v[152:153], v176 offset:21760
    v_mfma_f32_32x32x16_bf16 v[82:97], v[122:125], v[98:101], v[82:97]
    s_waitcnt lgkmcnt(0)
    v_mfma_f32_32x32x16_bf16 v[2:17], v[130:133], v[126:129], v[2:17]
    ds_read_b128 v[98:101], v172 offset:0
    ds_read_b64_tr_b16 v[102:103], v176 offset:2048
    ds_read_b64_tr_b16 v[104:105], v176 offset:2304
    v_mfma_f32_32x32x16_bf16 v[18:33], v[134:137], v[126:129], v[18:33]
    ds_read_b64_tr_b16 v[106:107], v176 offset:6144
    ds_read_b64_tr_b16 v[108:109], v176 offset:6400
    ds_read_b64_tr_b16 v[110:111], v176 offset:10240
    v_mfma_f32_32x32x16_bf16 v[34:49], v[138:141], v[126:129], v[34:49]
    ds_read_b64_tr_b16 v[112:113], v176 offset:10496
    ds_read_b64_tr_b16 v[114:115], v176 offset:14336
    ds_read_b64_tr_b16 v[116:117], v176 offset:14592
    v_mfma_f32_32x32x16_bf16 v[50:65], v[142:145], v[126:129], v[50:65]
    ds_read_b64_tr_b16 v[118:119], v176 offset:18432
    ds_read_b64_tr_b16 v[120:121], v176 offset:18688
    ds_read_b64_tr_b16 v[122:123], v176 offset:22528
    v_mfma_f32_32x32x16_bf16 v[66:81], v[146:149], v[126:129], v[66:81]
    ds_read_b64_tr_b16 v[124:125], v176 offset:22784
    v_mfma_f32_32x32x16_bf16 v[82:97], v[150:153], v[126:129], v[82:97]
    s_waitcnt lgkmcnt(0)
    v_mfma_f32_32x32x16_bf16 v[2:17], v[102:105], v[98:101], v[2:17]
    ds_read_b128 v[126:129], v173 offset:0
    ds_read_b64_tr_b16 v[130:131], v176 offset:3072
    ds_read_b64_tr_b16 v[132:133], v176 offset:3328
    v_mfma_f32_32x32x16_bf16 v[18:33], v[106:109], v[98:101], v[18:33]
    ds_read_b64_tr_b16 v[134:135], v176 offset:7168
    ds_read_b64_tr_b16 v[136:137], v176 offset:7424
    ds_read_b64_tr_b16 v[138:139], v176 offset:11264
    v_mfma_f32_32x32x16_bf16 v[34:49], v[110:113], v[98:101], v[34:49]
    ds_read_b64_tr_b16 v[140:141], v176 offset:11520
    ds_read_b64_tr_b16 v[142:143], v176 offset:15360
    ds_read_b64_tr_b16 v[144:145], v176 offset:15616
    v_mfma_f32_32x32x16_bf16 v[50:65], v[114:117], v[98:101], v[50:65]
    ds_read_b64_tr_b16 v[146:147], v176 offset:19456
    ds_read_b64_tr_b16 v[148:149], v176 offset:19712
    ds_read_b64_tr_b16 v[150:151], v176 offset:23552
    v_mfma_f32_32x32x16_bf16 v[66:81], v[118:121], v[98:101], v[66:81]
    ds_read_b64_tr_b16 v[152:153], v176 offset:23808
    v_mfma_f32_32x32x16_bf16 v[82:97], v[122:125], v[98:101], v[82:97]
    s_cmp_eq_u32 s73, 4
    s_cbranch_scc1 Lg_fx_done
    v_add_u32 v177, s101, v175
    s_add_u32 s101, s101, 24576
    s_cmp_eq_u32 s101, 73728
    s_cselect_b32 s101, 0, s101
    s_waitcnt vmcnt(3) lgkmcnt(0)
    v_mov_b32 v176, v177
    s_barrier
    v_mfma_f32_32x32x16_bf16 v[2:17], v[130:133], v[126:129], v[2:17]
    ds_read_b128 v[98:101], v166 offset:0
    ds_read_b64_tr_b16 v[102:103], v176 offset:0
    ds_read_b64_tr_b16 v[104:105], v176 offset:256
    v_mfma_f32_32x32x16_bf16 v[18:33], v[134:137], v[126:129], v[18:33]
    ds_read_b64_tr_b16 v[106:107], v176 offset:4096
    ds_read_b64_tr_b16 v[108:109], v176 offset:4352
    ds_read_b64_tr_b16 v[110:111], v176 offset:8192
    v_mfma_f32_32x32x16_bf16 v[34:49], v[138:141], v[126:129], v[34:49]
    ds_read_b64_tr_b16 v[112:113], v176 offset:8448
    ds_read_b64_tr_b16 v[114:115], v176 offset:12288
    ds_read_b64_tr_b16 v[116:117], v176 offset:12544
    v_mfma_f32_32x32x16_bf16 v[50:65], v[142:145], v[126:129], v[50:65]
    ds_read_b64_tr_b16 v[118:119], v176 offset:16384
    ds_read_b64_tr_b16 v[120:121], v176 offset:16640
    ds_read_b64_tr_b16 v[122:123], v176 offset:20480
    v_mfma_f32_32x32x16_bf16 v[66:81], v[146:149], v[126:129], v[66:81]
    ds_read_b64_tr_b16 v[124:125], v176 offset:20736
    v_mfma_f32_32x32x16_bf16 v[82:97], v[150:153], v[126:129], v[82:97]
    s_cmp_lg_u32 s73, 3
    s_cbranch_scc1 Lgn_160
    s_add_u32 s64, s64, 16
    s_cmp_ge_u32 s64, 112
    s_cbranch_scc1 Ldn_162
    s_cmp_ge_u32 s64, 96
    s_cbranch_scc1 Ldf_161
    s_mul_i32 s69, s64, 43691
    s_lshr_b32 s69, s69, 19
    s_mul_i32 s76, s69, 12
    s_sub_u32 s76, s64, s76
    s_lshr_b32 s71, s76, 2
    s_and_b32 s76, s76, 3
    s_lshl_b32 s77, s49, 2
    s_add_u32 s76, s76, s77
    s_mul_i32 s100, s69, 327680
    s_mul_i32 s66, s76, 384
    s_mov_b32 s67, 12288
    s_cmp_eq_u32 s71, 1
    s_cselect_b32 s60, s22, s20
    s_cselect_b32 s61, s23, s21
    s_cmp_eq_u32 s71, 2
    s_cselect_b32 s60, s24, s60
    s_cselect_b32 s61, s25, s61
    s_mov_b32 s62, 7864320
    s_mul_i32 s72, s71, 25165824
    s_mul_i32 s77, s76, 786432
    s_add_u32 s72, s72, s77
    s_mul_i32 s77, s69, 98304
    s_add_u32 s72, s72, s77
    s_mul_i32 s77, s48, 3
    s_lshr_b32 s78, s77, 2
    s_branch Ldd_163
Ldf_161:
    s_sub_u32 s76, s64, 96
    s_lshr_b32 s69, s76, 1
    s_and_b32 s76, s76, 1
    s_mov_b32 s71, 3
    s_mul_i32 s100, s69, 327680
    s_mul_i32 s66, s49, 384
    s_mul_i32 s77, s76, 192
    s_add_u32 s66, s66, s77
    s_mov_b32 s67, 3072
    s_cmp_ge_u32 s48, 4
    s_cselect_b32 s60, s34, s32
    s_cselect_b32 s61, s35, s33
    s_mov_b32 s62, 1966080
    s_mul_i32 s72, s69, 786432
    s_lshl_b32 s77, s66, 4
    s_add_u32 s72, s72, s77
    s_add_u32 s72, s72, 100663296
    s_and_b32 s77, s48, 3
    s_mul_i32 s77, s77, 3
    s_lshr_b32 s78, s77, 2
    s_branch Ldd_163
Ldn_162:
    s_mov_b32 s71, 4
    s_mov_b32 s62, 0
    s_mov_b32 s77, 0
    s_mov_b32 s78, 0
Ldd_163:
    s_add_u32 s69, s77, 0
    s_lshr_b32 s76, s69, 2
    s_and_b32 s69, s69, 3
    s_lshl_b32 s69, s69, 4
    s_mul_i32 s69, s69, s67
    s_lshl_b32 s76, s76, 6
    s_add_u32 s69, s69, s76
    s_add_u32 s94, s69, s66
    s_add_u32 s69, s77, 1
    s_lshr_b32 s76, s69, 2
    s_and_b32 s69, s69, 3
    s_lshl_b32 s69, s69, 4
    s_mul_i32 s69, s69, s67
    s_lshl_b32 s76, s76, 6
    s_add_u32 s69, s69, s76
    s_add_u32 s95, s69, s66
    s_add_u32 s69, s77, 2
    s_lshr_b32 s76, s69, 2
    s_and_b32 s69, s69, 3
    s_lshl_b32 s69, s69, 4
    s_mul_i32 s69, s69, s67
    s_lshl_b32 s76, s76, 6
    s_add_u32 s69, s69, s76
    s_add_u32 s96, s69, s66
    s_mul_i32 s69, s48, 40960
    s_add_u32 s100, s100, s69
    s_lshl_b32 s47, s67, 6
    v_mul_lo_u32 v156, v178, s67
    v_add_u32 v156, v156, v179
Lgn_160:
    s_add_u32 m0, s74, 32768
    s_nop 0
    buffer_load_dwordx4 v154, s[56:59], s65 offen lds
    s_add_u32 m0, s74, 33792
    s_add_u32 s69, s65, 10240
    buffer_load_dwordx4 v155, s[56:59], s69 offen lds
    s_add_u32 m0, s74, 34816
    s_add_u32 s69, s65, 20480
    buffer_load_dwordx4 v154, s[56:59], s69 offen lds
    s_add_u32 m0, s74, 35840
    s_add_u32 s69, s65, 30720
    buffer_load_dwordx4 v155, s[56:59], s69 offen lds
    s_add_u32 s65, s65, 128
    s_add_u32 s76, s75, s97
    s_add_u32 m0, s76, 0
    s_nop 0
    buffer_load_dwordx4 v156, s[60:63], s94 offen lds
    s_add_u32 s94, s94, s47
    s_add_u32 m0, s76, 1024
    s_nop 0
    buffer_load_dwordx4 v156, s[60:63], s95 offen lds
    s_add_u32 s95, s95, s47
    s_add_u32 m0, s76, 2048
    s_nop 0
    buffer_load_dwordx4 v156, s[60:63], s96 offen lds
    s_add_u32 s96, s96, s47
    s_add_u32 s97, s97, 24576
    s_cmp_eq_u32 s97, 73728
    s_cselect_b32 s97, 0, s97
    s_waitcnt lgkmcnt(0)
    v_mfma_f32_32x32x16_bf16 v[2:17], v[102:105], v[98:101], v[2:17]
    ds_read_b128 v[126:129], v167 offset:0
    ds_read_b64_tr_b16 v[130:131], v176 offset:1024
    ds_read_b64_tr_b16 v[132:133], v176 offset:1280
    v_mfma_f32_32x32x16_bf16 v[18:33], v[106:109], v[98:101], v[18:33]
    ds_read_b64_tr_b16 v[134:135], v176 offset:5120
    ds_read_b64_tr_b16 v[136:137], v176 offset:5376
    ds_read_b64_tr_b16 v[138:139], v176 offset:9216
    v_mfma_f32_32x32x16_bf16 v[34:49], v[110:113], v[98:101], v[34:49]
    ds_read_b64_tr_b16 v[140:141], v176 offset:9472
    ds_read_b64_tr_b16 v[142:143], v176 offset:13312
    ds_read_b64_tr_b16 v[144:145], v176 offset:13568
    v_mfma_f32_32x32x16_bf16 v[50:65], v[114:117], v[98:101], v[50:65]
    ds_read_b64_tr_b16 v[146:147], v176 offset:17408
    ds_read_b64_tr_b16 v[148:149], v176 offset:17664
    ds_read_b64_tr_b16 v[150:151], v176 offset:21504
    v_mfma_f32_32x32x16_bf16 v[66:81], v[118:121], v[98:101], v[66:81]
    ds_read_b64_tr_b16 v[152:153], v176 offset:21760
    v_mfma_f32_32x32x16_bf16 v[82:97], v[122:125], v[98:101], v[82:97]
    s_waitcnt lgkmcnt(0)
    v_mfma_f32_32x32x16_bf16 v[2:17], v[130:133], v[126:129], v[2:17]
    ds_read_b128 v[98:101], v168 offset:0
    ds_read_b64_tr_b16 v[102:103], v176 offset:2048
    ds_read_b64_tr_b16 v[104:105], v176 offset:2304
    v_mfma_f32_32x32x16_bf16 v[18:33], v[134:137], v[126:129], v[18:33]
    ds_read_b64_tr_b16 v[106:107], v176 offset:6144
    ds_read_b64_tr_b16 v[108:109], v176 offset:6400
    ds_read_b64_tr_b16 v[110:111], v176 offset:10240
    v_mfma_f32_32x32x16_bf16 v[34:49], v[138:141], v[126:129], v[34:49]
    ds_read_b64_tr_b16 v[112:113], v176 offset:10496
    ds_read_b64_tr_b16 v[114:115], v176 offset:14336
    ds_read_b64_tr_b16 v[116:117], v176 offset:14592
    v_mfma_f32_32x32x16_bf16 v[50:65], v[142:145], v[126:129], v[50:65]
    ds_read_b64_tr_b16 v[118:119], v176 offset:18432
    ds_read_b64_tr_b16 v[120:121], v176 offset:18688
    ds_read_b64_tr_b16 v[122:123], v176 offset:22528
    v_mfma_f32_32x32x16_bf16 v[66:81], v[146:149], v[126:129], v[66:81]
    ds_read_b64_tr_b16 v[124:125], v176 offset:22784
    v_mfma_f32_32x32x16_bf16 v[82:97], v[150:153], v[126:129], v[82:97]
    s_waitcnt lgkmcnt(0)
    v_mfma_f32_32x32x16_bf16 v[2:17], v[102:105], v[98:101], v[2:17]
    ds_read_b128 v[126:129], v169 offset:0
    ds_read_b64_tr_b16 v[130:131], v176 offset:3072
    ds_read_b64_tr_b16 v[132:133], v176 offset:3328
    v_mfma_f32_32x32x16_bf16 v[18:33], v[106:109], v[98:101], v[18:33]
    ds_read_b64_tr_b16 v[134:135], v176 offset:7168
    ds_read_b64_tr_b16 v[136:137], v176 offset:7424
    ds_read_b64_tr_b16 v[138:139], v176 offset:11264
    v_mfma_f32_32x32x16_bf16 v[34:49], v[110:113], v[98:101], v[34:49]
    ds_read_b64_tr_b16 v[140:141], v176 offset:11520
    ds_read_b64_tr_b16 v[142:143], v176 offset:15360
    ds_read_b64_tr_b16 v[144:145], v176 offset:15616
    v_mfma_f32_32x32x16_bf16 v[50:65], v[114:117], v[98:101], v[50:65]
    ds_read_b64_tr_b16 v[146:147], v176 offset:19456
    ds_read_b64_tr_b16 v[148:149], v176 offset:19712
    ds_read_b64_tr_b16 v[150:151], v176 offset:23552
    v_mfma_f32_32x32x16_bf16 v[66:81], v[118:121], v[98:101], v[66:81]
    ds_read_b64_tr_b16 v[152:153], v176 offset:23808
    v_mfma_f32_32x32x16_bf16 v[82:97], v[122:125], v[98:101], v[82:97]
    s_add_u32 s73, s73, 1
    s_branch LLg_fx_155
Lg_fx_done:
    s_waitcnt lgkmcnt(0)
    v_mfma_f32_32x32x16_bf16 v[2:17], v[130:133], v[126:129], v[2:17]
    v_mfma_f32_32x32x16_bf16 v[18:33], v[134:137], v[126:129], v[18:33]
    v_mfma_f32_32x32x16_bf16 v[34:49], v[138:141], v[126:129], v[34:49]
    v_mfma_f32_32x32x16_bf16 v[50:65], v[142:145], v[126:129], v[50:65]
    v_mfma_f32_32x32x16_bf16 v[66:81], v[146:149], v[126:129], v[66:81]
    v_mfma_f32_32x32x16_bf16 v[82:97], v[150:153], v[126:129], v[82:97]
    s_nop 7
    s_nop 3
    s_cmp_lg_u32 s80, 0
    s_cbranch_scc1 Lgreg_164
    v_and_b32 v183, 63, v0
    v_lshlrev_b32 v182, 2, v183
Lreg_165:
    buffer_load_dword v181, v182, s[8:11], 0 offen sc0 sc1
    s_waitcnt vmcnt(0)
    v_readlane_b32 s69, v181, 8
    v_readlane_b32 s76, v181, 8
    s_add_u32 s69, s69, s76
    s_cmp_ge_u32 s69, 512
    s_cbranch_scc1 Lregd_166
    s_sleep 24
    s_sub_u32 s54, s54, 1
    s_cbranch_scc0 Lreg_165
    s_mov_b32 s54, 0
Lregd_166:
    v_readlane_b32 s79, v181, 34
    v_cmp_ne_u32 vcc, 32, v181
    s_and_b32 s79, s79, 1
    s_and_b32 s69, vcc_lo, 0xf
    s_and_b32 s76, vcc_hi, 0xf00
    s_or_b32 s69, s69, s76
    s_cselect_b32 s53, 1, 0
Lgreg_164:
    v_mul_f32 v98, v2, v2
    v_mul_f32 v99, v3, v3
    v_mul_f32 v100, v4, v4
    v_mul_f32 v101, v5, v5
    v_mul_f32 v102, v6, v6
    v_mul_f32 v103, v7, v7
    v_mul_f32 v104, v8, v8
    v_mul_f32 v105, v9, v9
    v_mov_b32 v106, s98
    v_mov_b32 v107, s98
    v_mov_b32 v108, s98
    v_mov_b32 v109, s98
    v_mov_b32 v110, s98
    v_mov_b32 v111, s98
    v_mov_b32 v112, s98
    v_mov_b32 v113, s98
    v_fma_f32 v98, v98, s99, v106
    v_fma_f32 v99, v99, s99, v107
    v_fma_f32 v100, v100, s99, v108
    v_fma_f32 v101, v101, s99, v109
    v_fma_f32 v102, v102, s99, v110
    v_fma_f32 v103, v103, s99, v111
    v_fma_f32 v104, v104, s99, v112
    v_fma_f32 v105, v105, s99, v113
    v_mul_f32 v98, v98, v2
    v_mul_f32 v99, v99, v3
    v_mul_f32 v100, v100, v4
    v_mul_f32 v101, v101, v5
    v_mul_f32 v102, v102, v6
    v_mul_f32 v103, v103, v7
    v_mul_f32 v104, v104, v8
    v_mul_f32 v105, v105, v9
    v_exp_f32 v98, v98
    v_exp_f32 v99, v99
    v_exp_f32 v100, v100
    v_exp_f32 v101, v101
    v_exp_f32 v102, v102
    v_exp_f32 v103, v103
    v_exp_f32 v104, v104
    v_exp_f32 v105, v105
    v_mul_f32 v2, v2, v50
    v_mul_f32 v3, v3, v51
    v_mul_f32 v4, v4, v52
    v_mul_f32 v5, v5, v53
    v_mul_f32 v6, v6, v54
    v_mul_f32 v7, v7, v55
    v_mul_f32 v8, v8, v56
    v_mul_f32 v9, v9, v57
    v_add_f32 v98, 1.0, v98
    v_add_f32 v99, 1.0, v99
    v_add_f32 v100, 1.0, v100
    v_add_f32 v101, 1.0, v101
    v_add_f32 v102, 1.0, v102
    v_add_f32 v103, 1.0, v103
    v_add_f32 v104, 1.0, v104
    v_add_f32 v105, 1.0, v105
    v_rcp_f32 v98, v98
    v_rcp_f32 v99, v99
    v_rcp_f32 v100, v100
    v_rcp_f32 v101, v101
    v_rcp_f32 v102, v102
    v_rcp_f32 v103, v103
    v_rcp_f32 v104, v104
    v_rcp_f32 v105, v105
    s_nop 0
    v_mul_f32 v2, v2, v98
    v_mul_f32 v3, v3, v99
    v_mul_f32 v4, v4, v100
    v_mul_f32 v5, v5, v101
    v_mul_f32 v6, v6, v102
    v_mul_f32 v7, v7, v103
    v_mul_f32 v8, v8, v104
    v_mul_f32 v9, v9, v105
    v_mul_f32 v98, v10, v10
    v_mul_f32 v99, v11, v11
    v_mul_f32 v100, v12, v12
    v_mul_f32 v101, v13, v13
    v_mul_f32 v102, v14, v14
    v_mul_f32 v103, v15, v15
    v_mul_f32 v104, v16, v16
    v_mul_f32 v105, v17, v17
    v_mov_b32 v106, s98
    v_mov_b32 v107, s98
    v_mov_b32 v108, s98
    v_mov_b32 v109, s98
    v_mov_b32 v110, s98
    v_mov_b32 v111, s98
    v_mov_b32 v112, s98
    v_mov_b32 v113, s98
    v_fma_f32 v98, v98, s99, v106
    v_fma_f32 v99, v99, s99, v107
    v_fma_f32 v100, v100, s99, v108
    v_fma_f32 v101, v101, s99, v109
    v_fma_f32 v102, v102, s99, v110
    v_fma_f32 v103, v103, s99, v111
    v_fma_f32 v104, v104, s99, v112
    v_fma_f32 v105, v105, s99, v113
    v_mul_f32 v98, v98, v10
    v_mul_f32 v99, v99, v11
    v_mul_f32 v100, v100, v12
    v_mul_f32 v101, v101, v13
    v_mul_f32 v102, v102, v14
    v_mul_f32 v103, v103, v15
    v_mul_f32 v104, v104, v16
    v_mul_f32 v105, v105, v17
    v_exp_f32 v98, v98
    v_exp_f32 v99, v99
    v_exp_f32 v100, v100
    v_exp_f32 v101, v101
    v_exp_f32 v102, v102
    v_exp_f32 v103, v103
    v_exp_f32 v104, v104
    v_exp_f32 v105, v105
    v_mul_f32 v10, v10, v58
    v_mul_f32 v11, v11, v59
    v_mul_f32 v12, v12, v60
    v_mul_f32 v13, v13, v61
    v_mul_f32 v14, v14, v62
    v_mul_f32 v15, v15, v63
    v_mul_f32 v16, v16, v64
    v_mul_f32 v17, v17, v65
    v_add_f32 v98, 1.0, v98
    v_add_f32 v99, 1.0, v99
    v_add_f32 v100, 1.0, v100
    v_add_f32 v101, 1.0, v101
    v_add_f32 v102, 1.0, v102
    v_add_f32 v103, 1.0, v103
    v_add_f32 v104, 1.0, v104
    v_add_f32 v105, 1.0, v105
    v_rcp_f32 v98, v98
    v_rcp_f32 v99, v99
    v_rcp_f32 v100, v100
    v_rcp_f32 v101, v101
    v_rcp_f32 v102, v102
    v_rcp_f32 v103, v103
    v_rcp_f32 v104, v104
    v_rcp_f32 v105, v105
    s_nop 0
    v_mul_f32 v10, v10, v98
    v_mul_f32 v11, v11, v99
    v_mul_f32 v12, v12, v100
    v_mul_f32 v13, v13, v101
    v_mul_f32 v14, v14, v102
    v_mul_f32 v15, v15, v103
    v_mul_f32 v16, v16, v104
    v_mul_f32 v17, v17, v105
    v_cvt_pk_bf16_f32 v2, v2, v3
    v_cvt_pk_bf16_f32 v3, v4, v5
    v_cvt_pk_bf16_f32 v4, v6, v7
    v_cvt_pk_bf16_f32 v5, v8, v9
    v_cvt_pk_bf16_f32 v6, v10, v11
    v_cvt_pk_bf16_f32 v7, v12, v13
    v_cvt_pk_bf16_f32 v8, v14, v15
    v_cvt_pk_bf16_f32 v9, v16, v17
    v_mul_f32 v98, v18, v18
    v_mul_f32 v99, v19, v19
    v_mul_f32 v100, v20, v20
    v_mul_f32 v101, v21, v21
    v_mul_f32 v102, v22, v22
    v_mul_f32 v103, v23, v23
    v_mul_f32 v104, v24, v24
    v_mul_f32 v105, v25, v25
    v_mov_b32 v106, s98
    v_mov_b32 v107, s98
    v_mov_b32 v108, s98
    v_mov_b32 v109, s98
    v_mov_b32 v110, s98
    v_mov_b32 v111, s98
    v_mov_b32 v112, s98
    v_mov_b32 v113, s98
    v_fma_f32 v98, v98, s99, v106
    v_fma_f32 v99, v99, s99, v107
    v_fma_f32 v100, v100, s99, v108
    v_fma_f32 v101, v101, s99, v109
    v_fma_f32 v102, v102, s99, v110
    v_fma_f32 v103, v103, s99, v111
    v_fma_f32 v104, v104, s99, v112
    v_fma_f32 v105, v105, s99, v113
    v_mul_f32 v98, v98, v18
    v_mul_f32 v99, v99, v19
    v_mul_f32 v100, v100, v20
    v_mul_f32 v101, v101, v21
    v_mul_f32 v102, v102, v22
    v_mul_f32 v103, v103, v23
    v_mul_f32 v104, v104, v24
    v_mul_f32 v105, v105, v25
    v_exp_f32 v98, v98
    v_exp_f32 v99, v99
    v_exp_f32 v100, v100
    v_exp_f32 v101, v101
    v_exp_f32 v102, v102
    v_exp_f32 v103, v103
    v_exp_f32 v104, v104
    v_exp_f32 v105, v105
    v_mul_f32 v18, v18, v66
    v_mul_f32 v19, v19, v67
    v_mul_f32 v20, v20, v68
    v_mul_f32 v21, v21, v69
    v_mul_f32 v22, v22, v70
    v_mul_f32 v23, v23, v71
    v_mul_f32 v24, v24, v72
    v_mul_f32 v25, v25, v73
    v_add_f32 v98, 1.0, v98
    v_add_f32 v99, 1.0, v99
    v_add_f32 v100, 1.0, v100
    v_add_f32 v101, 1.0, v101
    v_add_f32 v102, 1.0, v102
    v_add_f32 v103, 1.0, v103
    v_add_f32 v104, 1.0, v104
    v_add_f32 v105, 1.0, v105
    v_rcp_f32 v98, v98
    v_rcp_f32 v99, v99
    v_rcp_f32 v100, v100
    v_rcp_f32 v101, v101
    v_rcp_f32 v102, v102
    v_rcp_f32 v103, v103
    v_rcp_f32 v104, v104
    v_rcp_f32 v105, v105
    s_nop 0
    v_mul_f32 v18, v18, v98
    v_mul_f32 v19, v19, v99
    v_mul_f32 v20, v20, v100
    v_mul_f32 v21, v21, v101
    v_mul_f32 v22, v22, v102
    v_mul_f32 v23, v23, v103
    v_mul_f32 v24, v24, v104
    v_mul_f32 v25, v25, v105
    v_mul_f32 v98, v26, v26
    v_mul_f32 v99, v27, v27
    v_mul_f32 v100, v28, v28
    v_mul_f32 v101, v29, v29
    v_mul_f32 v102, v30, v30
    v_mul_f32 v103, v31, v31
    v_mul_f32 v104, v32, v32
    v_mul_f32 v105, v33, v33
    v_mov_b32 v106, s98
    v_mov_b32 v107, s98
    v_mov_b32 v108, s98
    v_mov_b32 v109, s98
    v_mov_b32 v110, s98
    v_mov_b32 v111, s98
    v_mov_b32 v112, s98
    v_mov_b32 v113, s98
    v_fma_f32 v98, v98, s99, v106
    v_fma_f32 v99, v99, s99, v107
    v_fma_f32 v100, v100, s99, v108
    v_fma_f32 v101, v101, s99, v109
    v_fma_f32 v102, v102, s99, v110
    v_fma_f32 v103, v103, s99, v111
    v_fma_f32 v104, v104, s99, v112
    v_fma_f32 v105, v105, s99, v113
    v_mul_f32 v98, v98, v26
    v_mul_f32 v99, v99, v27
    v_mul_f32 v100, v100, v28
    v_mul_f32 v101, v101, v29
    v_mul_f32 v102, v102, v30
    v_mul_f32 v103, v103, v31
    v_mul_f32 v104, v104, v32
    v_mul_f32 v105, v105, v33
    v_exp_f32 v98, v98
    v_exp_f32 v99, v99
    v_exp_f32 v100, v100
    v_exp_f32 v101, v101
    v_exp_f32 v102, v102
    v_exp_f32 v103, v103
    v_exp_f32 v104, v104
    v_exp_f32 v105, v105
    v_mul_f32 v26, v26, v74
    v_mul_f32 v27, v27, v75
    v_mul_f32 v28, v28, v76
    v_mul_f32 v29, v29, v77
    v_mul_f32 v30, v30, v78
    v_mul_f32 v31, v31, v79
    v_mul_f32 v32, v32, v80
    v_mul_f32 v33, v33, v81
    v_add_f32 v98, 1.0, v98
    v_add_f32 v99, 1.0, v99
    v_add_f32 v100, 1.0, v100
    v_add_f32 v101, 1.0, v101
    v_add_f32 v102, 1.0, v102
    v_add_f32 v103, 1.0, v103
    v_add_f32 v104, 1.0, v104
    v_add_f32 v105, 1.0, v105
    v_rcp_f32 v98, v98
    v_rcp_f32 v99, v99
    v_rcp_f32 v100, v100
    v_rcp_f32 v101, v101
    v_rcp_f32 v102, v102
    v_rcp_f32 v103, v103
    v_rcp_f32 v104, v104
    v_rcp_f32 v105, v105
    s_nop 0
    v_mul_f32 v26, v26, v98
    v_mul_f32 v27, v27, v99
    v_mul_f32 v28, v28, v100
    v_mul_f32 v29, v29, v101
    v_mul_f32 v30, v30, v102
    v_mul_f32 v31, v31, v103
    v_mul_f32 v32, v32, v104
    v_mul_f32 v33, v33, v105
    v_cvt_pk_bf16_f32 v18, v18, v19
    v_cvt_pk_bf16_f32 v19, v20, v21
    v_cvt_pk_bf16_f32 v20, v22, v23
    v_cvt_pk_bf16_f32 v21, v24, v25
    v_cvt_pk_bf16_f32 v22, v26, v27
    v_cvt_pk_bf16_f32 v23, v28, v29
    v_cvt_pk_bf16_f32 v24, v30, v31
    v_cvt_pk_bf16_f32 v25, v32, v33
    v_mul_f32 v98, v34, v34
    v_mul_f32 v99, v35, v35
    v_mul_f32 v100, v36, v36
    v_mul_f32 v101, v37, v37
    v_mul_f32 v102, v38, v38
    v_mul_f32 v103, v39, v39
    v_mul_f32 v104, v40, v40
    v_mul_f32 v105, v41, v41
    v_mov_b32 v106, s98
    v_mov_b32 v107, s98
    v_mov_b32 v108, s98
    v_mov_b32 v109, s98
    v_mov_b32 v110, s98
    v_mov_b32 v111, s98
    v_mov_b32 v112, s98
    v_mov_b32 v113, s98
    v_fma_f32 v98, v98, s99, v106
    v_fma_f32 v99, v99, s99, v107
    v_fma_f32 v100, v100, s99, v108
    v_fma_f32 v101, v101, s99, v109
    v_fma_f32 v102, v102, s99, v110
    v_fma_f32 v103, v103, s99, v111
    v_fma_f32 v104, v104, s99, v112
    v_fma_f32 v105, v105, s99, v113
    v_mul_f32 v98, v98, v34
    v_mul_f32 v99, v99, v35
    v_mul_f32 v100, v100, v36
    v_mul_f32 v101, v101, v37
    v_mul_f32 v102, v102, v38
    v_mul_f32 v103, v103, v39
    v_mul_f32 v104, v104, v40
    v_mul_f32 v105, v105, v41
    v_exp_f32 v98, v98
    v_exp_f32 v99, v99
    v_exp_f32 v100, v100
    v_exp_f32 v101, v101
    v_exp_f32 v102, v102
    v_exp_f32 v103, v103
    v_exp_f32 v104, v104
    v_exp_f32 v105, v105
    v_mul_f32 v34, v34, v82
    v_mul_f32 v35, v35, v83
    v_mul_f32 v36, v36, v84
    v_mul_f32 v37, v37, v85
    v_mul_f32 v38, v38, v86
    v_mul_f32 v39, v39, v87
    v_mul_f32 v40, v40, v88
    v_mul_f32 v41, v41, v89
    v_add_f32 v98, 1.0, v98
    v_add_f32 v99, 1.0, v99
    v_add_f32 v100, 1.0, v100
    v_add_f32 v101, 1.0, v101
    v_add_f32 v102, 1.0, v102
    v_add_f32 v103, 1.0, v103
    v_add_f32 v104, 1.0, v104
    v_add_f32 v105, 1.0, v105
    v_rcp_f32 v98, v98
    v_rcp_f32 v99, v99
    v_rcp_f32 v100, v100
    v_rcp_f32 v101, v101
    v_rcp_f32 v102, v102
    v_rcp_f32 v103, v103
    v_rcp_f32 v104, v104
    v_rcp_f32 v105, v105
    s_nop 0
    v_mul_f32 v34, v34, v98
    v_mul_f32 v35, v35, v99
    v_mul_f32 v36, v36, v100
    v_mul_f32 v37, v37, v101
    v_mul_f32 v38, v38, v102
    v_mul_f32 v39, v39, v103
    v_mul_f32 v40, v40, v104
    v_mul_f32 v41, v41, v105
    v_mul_f32 v98, v42, v42
    v_mul_f32 v99, v43, v43
    v_mul_f32 v100, v44, v44
    v_mul_f32 v101, v45, v45
    v_mul_f32 v102, v46, v46
    v_mul_f32 v103, v47, v47
    v_mul_f32 v104, v48, v48
    v_mul_f32 v105, v49, v49
    v_mov_b32 v106, s98
    v_mov_b32 v107, s98
    v_mov_b32 v108, s98
    v_mov_b32 v109, s98
    v_mov_b32 v110, s98
    v_mov_b32 v111, s98
    v_mov_b32 v112, s98
    v_mov_b32 v113, s98
    v_fma_f32 v98, v98, s99, v106
    v_fma_f32 v99, v99, s99, v107
    v_fma_f32 v100, v100, s99, v108
    v_fma_f32 v101, v101, s99, v109
    v_fma_f32 v102, v102, s99, v110
    v_fma_f32 v103, v103, s99, v111
    v_fma_f32 v104, v104, s99, v112
    v_fma_f32 v105, v105, s99, v113
    v_mul_f32 v98, v98, v42
    v_mul_f32 v99, v99, v43
    v_mul_f32 v100, v100, v44
    v_mul_f32 v101, v101, v45
    v_mul_f32 v102, v102, v46
    v_mul_f32 v103, v103, v47
    v_mul_f32 v104, v104, v48
    v_mul_f32 v105, v105, v49
    v_exp_f32 v98, v98
    v_exp_f32 v99, v99
    v_exp_f32 v100, v100
    v_exp_f32 v101, v101
    v_exp_f32 v102, v102
    v_exp_f32 v103, v103
    v_exp_f32 v104, v104
    v_exp_f32 v105, v105
    v_mul_f32 v42, v42, v90
    v_mul_f32 v43, v43, v91
    v_mul_f32 v44, v44, v92
    v_mul_f32 v45, v45, v93
    v_mul_f32 v46, v46, v94
    v_mul_f32 v47, v47, v95
    v_mul_f32 v48, v48, v96
    v_mul_f32 v49, v49, v97
    v_add_f32 v98, 1.0, v98
    v_add_f32 v99, 1.0, v99
    v_add_f32 v100, 1.0, v100
    v_add_f32 v101, 1.0, v101
    v_add_f32 v102, 1.0, v102
    v_add_f32 v103, 1.0, v103
    v_add_f32 v104, 1.0, v104
    v_add_f32 v105, 1.0, v105
    v_rcp_f32 v98, v98
    v_rcp_f32 v99, v99
    v_rcp_f32 v100, v100
    v_rcp_f32 v101, v101
    v_rcp_f32 v102, v102
    v_rcp_f32 v103, v103
    v_rcp_f32 v104, v104
    v_rcp_f32 v105, v105
    s_nop 0
    v_mul_f32 v42, v42, v98
    v_mul_f32 v43, v43, v99
    v_mul_f32 v44, v44, v100
    v_mul_f32 v45, v45, v101
    v_mul_f32 v46, v46, v102
    v_mul_f32 v47, v47, v103
    v_mul_f32 v48, v48, v104
    v_mul_f32 v49, v49, v105
    v_cvt_pk_bf16_f32 v34, v34, v35
    v_cvt_pk_bf16_f32 v35, v36, v37
    v_cvt_pk_bf16_f32 v36, v38, v39
    v_cvt_pk_bf16_f32 v37, v40, v41
    v_cvt_pk_bf16_f32 v38, v42, v43
    v_cvt_pk_bf16_f32 v39, v44, v45
    v_cvt_pk_bf16_f32 v40, v46, v47
    v_cvt_pk_bf16_f32 v41, v48, v49
    s_cmp_lg_u32 s53, 0
    s_cbranch_scc1 Lgslow_167
    buffer_store_dwordx4 v[2:5], v186, s[4:7], s70 offen offset:0
    buffer_store_dwordx4 v[6:9], v186, s[4:7], s70 offen offset:512
    buffer_store_dwordx4 v[18:21], v186, s[4:7], s70 offen offset:1024
    buffer_store_dwordx4 v[22:25], v186, s[4:7], s70 offen offset:1536
    buffer_store_dwordx4 v[34:37], v186, s[4:7], s70 offen offset:2048
    buffer_store_dwordx4 v[38:41], v186, s[4:7], s70 offen offset:2560
Lgback_168:
    s_mul_i32 s80, s49, 512
    s_add_u32 s80, s80, s81
    s_add_u32 s80, s80, 152043520
    s_cmp_ge_u32 s81, 64
    s_cbranch_scc1 Lgff_169
    s_waitcnt vmcnt(0)
    s_barrier
    s_cmp_eq_u32 s80, 0
    s_cbranch_scc1 Lgf_170
    s_cmp_lg_u32 s48, 0
    s_cbranch_scc1 Lgf_170
    s_mov_b64 exec, 1
    buffer_store_dword v187, v188, s[4:7], s80 offen sc1
    s_mov_b64 exec, -1
Lgf_170:
Lgff_169:
    s_branch Lgnext_126
Lg_end:
    s_waitcnt vmcnt(0) lgkmcnt(0)
    s_barrier
    s_cmp_eq_u32 s80, 0
    s_cbranch_scc1 Lgf_171
    s_cmp_lg_u32 s48, 0
    s_cbranch_scc1 Lgf_171
    s_mov_b64 exec, 1
    buffer_store_dword v187, v188, s[4:7], s80 offen sc1
    s_mov_b64 exec, -1
Lgf_171:
    s_branch Lphase3
Lgslow_167:
    buffer_store_dwordx4 v[2:5], v186, s[4:7], s70 offen offset:0 sc1
    buffer_store_dwordx4 v[6:9], v186, s[4:7], s70 offen offset:512 sc1
    buffer_store_dwordx4 v[18:21], v186, s[4:7], s70 offen offset:1024 sc1
    buffer_store_dwordx4 v[22:25], v186, s[4:7], s70 offen offset:1536 sc1
    buffer_store_dwordx4 v[34:37], v186, s[4:7], s70 offen offset:2048 sc1
    buffer_store_dwordx4 v[38:41], v186, s[4:7], s70 offen offset:2560 sc1
    s_branch Lgback_168
Lphase3:
    v_and_b32 v228, 63, v0
    v_and_b32 v229, 15, v0
    v_bfe_u32 v1, v0, 4, 2
    s_mov_b32 s80, 0x05040100
    s_mov_b32 s81, 0x07060302
    s_mov_b32 s74, -1
    s_mov_b32 s75, 0xffff
    s_sub_u32 s69, s50, 16
    s_and_b32 s56, s69, 7
    s_lshr_b32 s57, s69, 3
    s_lshr_b32 s58, s48, 1
    s_and_b32 s59, s48, 1
    s_mov_b32 s60, s40
    s_mov_b32 s61, s41
    s_mov_b32 s62, 2621440
    s_mov_b32 s63, 0x20000
    v_lshlrev_b32 v0, 2, v228
    v_and_b32 v2, 1, v229
    v_cmp_eq_u32 vcc, 1, v2
    v_mov_b32 v231, s80
    v_mov_b32 v2, s81
    s_nop 1
    v_cndmask_b32 v231, v231, v2, vcc
    s_cmp_eq_u32 s58, 0
    s_cbranch_scc1 Lp3h_172
    s_mov_b32 s12, s26
    s_mov_b32 s13, s27
    s_mov_b32 s14, 7864320
    s_mov_b32 s15, 0x20000
    s_mul_i32 s69, s49, 768
    s_lshl_b32 s76, s58, 8
    s_add_u32 s69, s69, s76
    s_sub_u32 s69, s69, 256
    s_lshl_b32 s65, s69, 5
    s_add_u32 s65, s65, 75497472
    s_mul_i32 s69, s69, 1280
    s_mul_i32 s76, s56, 160
    s_add_u32 s69, s69, s76
    v_mul_u32_u24 v248, 10240, v1
    v_add_u32 v248, s69, v248
    v_and_b32 v2, 14, v229
    v_lshl_add_u32 v251, v2, 1, v248
    v_add_u32 v251, 128, v251
    v_lshl_add_u32 v248, v229, 2, v248
    s_mov_b32 s69, 0
    s_mov_b32 s76, 1280
    buffer_load_dword v4, v248, s[12:15], s69 offen offset:0
    buffer_load_dword v8, v248, s[12:15], s76 offen offset:0
    buffer_load_dword v12, v248, s[12:15], s69 offen offset:64
    buffer_load_dword v16, v248, s[12:15], s76 offen offset:64
    buffer_load_dword v20, v251, s[12:15], s69 offen
    buffer_load_dword v164, v251, s[12:15], s76 offen
    s_mov_b32 s69, 2560
    s_mov_b32 s76, 3840
    buffer_load_dword v5, v248, s[12:15], s69 offen offset:0
    buffer_load_dword v9, v248, s[12:15], s76 offen offset:0
    buffer_load_dword v13, v248, s[12:15], s69 offen offset:64
    buffer_load_dword v17, v248, s[12:15], s76 offen offset:64
    buffer_load_dword v21, v251, s[12:15], s69 offen
    buffer_load_dword v165, v251, s[12:15], s76 offen
    s_mov_b32 s69, 5120
    s_mov_b32 s76, 6400
    buffer_load_dword v6, v248, s[12:15], s69 offen offset:0
    buffer_load_dword v10, v248, s[12:15], s76 offen offset:0
    buffer_load_dword v14, v248, s[12:15], s69 offen offset:64
    buffer_load_dword v18, v248, s[12:15], s76 offen offset:64
    buffer_load_dword v22, v251, s[12:15], s69 offen
    buffer_load_dword v166, v251, s[12:15], s76 offen
    s_mov_b32 s69, 7680
    s_mov_b32 s76, 8960
    buffer_load_dword v7, v248, s[12:15], s69 offen offset:0
    buffer_load_dword v11, v248, s[12:15], s76 offen offset:0
    buffer_load_dword v15, v248, s[12:15], s69 offen offset:64
    buffer_load_dword v19, v248, s[12:15], s76 offen offset:64
    buffer_load_dword v23, v251, s[12:15], s69 offen
    buffer_load_dword v167, v251, s[12:15], s76 offen
    s_mov_b32 s69, 40960
    s_mov_b32 s76, 42240
    buffer_load_dword v24, v248, s[12:15], s69 offen offset:0
    buffer_load_dword v28, v248, s[12:15], s76 offen offset:0
    buffer_load_dword v32, v248, s[12:15], s69 offen offset:64
    buffer_load_dword v36, v248, s[12:15], s76 offen offset:64
    buffer_load_dword v40, v251, s[12:15], s69 offen
    buffer_load_dword v168, v251, s[12:15], s76 offen
    s_mov_b32 s69, 43520
    s_mov_b32 s76, 44800
    buffer_load_dword v25, v248, s[12:15], s69 offen offset:0
    buffer_load_dword v29, v248, s[12:15], s76 offen offset:0
    buffer_load_dword v33, v248, s[12:15], s69 offen offset:64
    buffer_load_dword v37, v248, s[12:15], s76 offen offset:64
    buffer_load_dword v41, v251, s[12:15], s69 offen
    buffer_load_dword v169, v251, s[12:15], s76 offen
    s_mov_b32 s69, 46080
    s_mov_b32 s76, 47360
    buffer_load_dword v26, v248, s[12:15], s69 offen offset:0
    buffer_load_dword v30, v248, s[12:15], s76 offen offset:0
    buffer_load_dword v34, v248, s[12:15], s69 offen offset:64
    buffer_load_dword v38, v248, s[12:15], s76 offen offset:64
    buffer_load_dword v42, v251, s[12:15], s69 offen
    buffer_load_dword v170, v251, s[12:15], s76 offen
    s_mov_b32 s69, 48640
    s_mov_b32 s76, 49920
    buffer_load_dword v27, v248, s[12:15], s69 offen offset:0
    buffer_load_dword v31, v248, s[12:15], s76 offen offset:0
    buffer_load_dword v35, v248, s[12:15], s69 offen offset:64
    buffer_load_dword v39, v248, s[12:15], s76 offen offset:64
    buffer_load_dword v43, v251, s[12:15], s69 offen
    buffer_load_dword v171, v251, s[12:15], s76 offen
    s_waitcnt vmcnt(24)
    v_perm_b32 v2, v8, v4, s80
    v_perm_b32 v8, v8, v4, s81
    v_mov_b32 v4, v2
    v_perm_b32 v2, v16, v12, s80
    v_perm_b32 v16, v16, v12, s81
    v_mov_b32 v12, v2
    v_perm_b32 v20, v164, v20, v231
    v_perm_b32 v2, v9, v5, s80
    v_perm_b32 v9, v9, v5, s81
    v_mov_b32 v5, v2
    v_perm_b32 v2, v17, v13, s80
    v_perm_b32 v17, v17, v13, s81
    v_mov_b32 v13, v2
    v_perm_b32 v21, v165, v21, v231
    v_perm_b32 v2, v10, v6, s80
    v_perm_b32 v10, v10, v6, s81
    v_mov_b32 v6, v2
    v_perm_b32 v2, v18, v14, s80
    v_perm_b32 v18, v18, v14, s81
    v_mov_b32 v14, v2
    v_perm_b32 v22, v166, v22, v231
    v_perm_b32 v2, v11, v7, s80
    v_perm_b32 v11, v11, v7, s81
    v_mov_b32 v7, v2
    v_perm_b32 v2, v19, v15, s80
    v_perm_b32 v19, v19, v15, s81
    v_mov_b32 v15, v2
    v_perm_b32 v23, v167, v23, v231
    s_mov_b32 s69, 81920
    s_mov_b32 s76, 83200
    buffer_load_dword v44, v248, s[12:15], s69 offen offset:0
    buffer_load_dword v48, v248, s[12:15], s76 offen offset:0
    buffer_load_dword v52, v248, s[12:15], s69 offen offset:64
    buffer_load_dword v56, v248, s[12:15], s76 offen offset:64
    buffer_load_dword v60, v251, s[12:15], s69 offen
    buffer_load_dword v164, v251, s[12:15], s76 offen
    s_mov_b32 s69, 84480
    s_mov_b32 s76, 85760
    buffer_load_dword v45, v248, s[12:15], s69 offen offset:0
    buffer_load_dword v49, v248, s[12:15], s76 offen offset:0
    buffer_load_dword v53, v248, s[12:15], s69 offen offset:64
    buffer_load_dword v57, v248, s[12:15], s76 offen offset:64
    buffer_load_dword v61, v251, s[12:15], s69 offen
    buffer_load_dword v165, v251, s[12:15], s76 offen
    s_mov_b32 s69, 87040
    s_mov_b32 s76, 88320
    buffer_load_dword v46, v248, s[12:15], s69 offen offset:0
    buffer_load_dword v50, v248, s[12:15], s76 offen offset:0
    buffer_load_dword v54, v248, s[12:15], s69 offen offset:64
    buffer_load_dword v58, v248, s[12:15], s76 offen offset:64
    buffer_load_dword v62, v251, s[12:15], s69 offen
    buffer_load_dword v166, v251, s[12:15], s76 offen
    s_mov_b32 s69, 89600
    s_mov_b32 s76, 90880
    buffer_load_dword v47, v248, s[12:15], s69 offen offset:0
    buffer_load_dword v51, v248, s[12:15], s76 offen offset:0
    buffer_load_dword v55, v248, s[12:15], s69 offen offset:64
    buffer_load_dword v59, v248, s[12:15], s76 offen offset:64
    buffer_load_dword v63, v251, s[12:15], s69 offen
    buffer_load_dword v167, v251, s[12:15], s76 offen
    s_waitcnt vmcnt(24)
    v_perm_b32 v2, v28, v24, s80
    v_perm_b32 v28, v28, v24, s81
    v_mov_b32 v24, v2
    v_perm_b32 v2, v36, v32, s80
    v_perm_b32 v36, v36, v32, s81
    v_mov_b32 v32, v2
    v_perm_b32 v40, v168, v40, v231
    v_perm_b32 v2, v29, v25, s80
    v_perm_b32 v29, v29, v25, s81
    v_mov_b32 v25, v2
    v_perm_b32 v2, v37, v33, s80
    v_perm_b32 v37, v37, v33, s81
    v_mov_b32 v33, v2
    v_perm_b32 v41, v169, v41, v231
    v_perm_b32 v2, v30, v26, s80
    v_perm_b32 v30, v30, v26, s81
    v_mov_b32 v26, v2
    v_perm_b32 v2, v38, v34, s80
    v_perm_b32 v38, v38, v34, s81
    v_mov_b32 v34, v2
    v_perm_b32 v42, v170, v42, v231
    v_perm_b32 v2, v31, v27, s80
    v_perm_b32 v31, v31, v27, s81
    v_mov_b32 v27, v2
    v_perm_b32 v2, v39, v35, s80
    v_perm_b32 v39, v39, v35, s81
    v_mov_b32 v35, v2
    v_perm_b32 v43, v171, v43, v231
    s_mov_b32 s69, 122880
    s_mov_b32 s76, 124160
    buffer_load_dword v64, v248, s[12:15], s69 offen offset:0
    buffer_load_dword v68, v248, s[12:15], s76 offen offset:0
    buffer_load_dword v72, v248, s[12:15], s69 offen offset:64
    buffer_load_dword v76, v248, s[12:15], s76 offen offset:64
    buffer_load_dword v80, v251, s[12:15], s69 offen
    buffer_load_dword v168, v251, s[12:15], s76 offen
    s_mov_b32 s69, 125440
    s_mov_b32 s76, 126720
    buffer_load_dword v65, v248, s[12:15], s69 offen offset:0
    buffer_load_dword v69, v248, s[12:15], s76 offen offset:0
    buffer_load_dword v73, v248, s[12:15], s69 offen offset:64
    buffer_load_dword v77, v248, s[12:15], s76 offen offset:64
    buffer_load_dword v81, v251, s[12:15], s69 offen
    buffer_load_dword v169, v251, s[12:15], s76 offen
    s_mov_b32 s69, 128000
    s_mov_b32 s76, 129280
    buffer_load_dword v66, v248, s[12:15], s69 offen offset:0
    buffer_load_dword v70, v248, s[12:15], s76 offen offset:0
    buffer_load_dword v74, v248, s[12:15], s69 offen offset:64
    buffer_load_dword v78, v248, s[12:15], s76 offen offset:64
    buffer_load_dword v82, v251, s[12:15], s69 offen
    buffer_load_dword v170, v251, s[12:15], s76 offen
    s_mov_b32 s69, 130560
    s_mov_b32 s76, 131840
    buffer_load_dword v67, v248, s[12:15], s69 offen offset:0
    buffer_load_dword v71, v248, s[12:15], s76 offen offset:0
    buffer_load_dword v75, v248, s[12:15], s69 offen offset:64
    buffer_load_dword v79, v248, s[12:15], s76 offen offset:64
    buffer_load_dword v83, v251, s[12:15], s69 offen
    buffer_load_dword v171, v251, s[12:15], s76 offen
    s_waitcnt vmcnt(24)
    v_perm_b32 v2, v48, v44, s80
    v_perm_b32 v48, v48, v44, s81
    v_mov_b32 v44, v2
    v_perm_b32 v2, v56, v52, s80
    v_perm_b32 v56, v56, v52, s81
    v_mov_b32 v52, v2
    v_perm_b32 v60, v164, v60, v231
    v_perm_b32 v2, v49, v45, s80
    v_perm_b32 v49, v49, v45, s81
    v_mov_b32 v45, v2
    v_perm_b32 v2, v57, v53, s80
    v_perm_b32 v57, v57, v53, s81
    v_mov_b32 v53, v2
    v_perm_b32 v61, v165, v61, v231
    v_perm_b32 v2, v50, v46, s80
    v_perm_b32 v50, v50, v46, s81
    v_mov_b32 v46, v2
    v_perm_b32 v2, v58, v54, s80
    v_perm_b32 v58, v58, v54, s81
    v_mov_b32 v54, v2
    v_perm_b32 v62, v166, v62, v231
    v_perm_b32 v2, v51, v47, s80
    v_perm_b32 v51, v51, v47, s81
    v_mov_b32 v47, v2
    v_perm_b32 v2, v59, v55, s80
    v_perm_b32 v59, v59, v55, s81
    v_mov_b32 v55, v2
    v_perm_b32 v63, v167, v63, v231
    s_mov_b32 s69, 163840
    s_mov_b32 s76, 165120
    buffer_load_dword v84, v248, s[12:15], s69 offen offset:0
    buffer_load_dword v88, v248, s[12:15], s76 offen offset:0
    buffer_load_dword v92, v248, s[12:15], s69 offen offset:64
    buffer_load_dword v96, v248, s[12:15], s76 offen offset:64
    buffer_load_dword v100, v251, s[12:15], s69 offen
    buffer_load_dword v164, v251, s[12:15], s76 offen
    s_mov_b32 s69, 166400
    s_mov_b32 s76, 167680
    buffer_load_dword v85, v248, s[12:15], s69 offen offset:0
    buffer_load_dword v89, v248, s[12:15], s76 offen offset:0
    buffer_load_dword v93, v248, s[12:15], s69 offen offset:64
    buffer_load_dword v97, v248, s[12:15], s76 offen offset:64
    buffer_load_dword v101, v251, s[12:15], s69 offen
    buffer_load_dword v165, v251, s[12:15], s76 offen
    s_mov_b32 s69, 168960
    s_mov_b32 s76, 170240
    buffer_load_dword v86, v248, s[12:15], s69 offen offset:0
    buffer_load_dword v90, v248, s[12:15], s76 offen offset:0
    buffer_load_dword v94, v248, s[12:15], s69 offen offset:64
    buffer_load_dword v98, v248, s[12:15], s76 offen offset:64
    buffer_load_dword v102, v251, s[12:15], s69 offen
    buffer_load_dword v166, v251, s[12:15], s76 offen
    s_mov_b32 s69, 171520
    s_mov_b32 s76, 172800
    buffer_load_dword v87, v248, s[12:15], s69 offen offset:0
    buffer_load_dword v91, v248, s[12:15], s76 offen offset:0
    buffer_load_dword v95, v248, s[12:15], s69 offen offset:64
    buffer_load_dword v99, v248, s[12:15], s76 offen offset:64
    buffer_load_dword v103, v251, s[12:15], s69 offen
    buffer_load_dword v167, v251, s[12:15], s76 offen
    s_waitcnt vmcnt(24)
    v_perm_b32 v2, v68, v64, s80
    v_perm_b32 v68, v68, v64, s81
    v_mov_b32 v64, v2
    v_perm_b32 v2, v76, v72, s80
    v_perm_b32 v76, v76, v72, s81
    v_mov_b32 v72, v2
    v_perm_b32 v80, v168, v80, v231
    v_perm_b32 v2, v69, v65, s80
    v_perm_b32 v69, v69, v65, s81
    v_mov_b32 v65, v2
    v_perm_b32 v2, v77, v73, s80
    v_perm_b32 v77, v77, v73, s81
    v_mov_b32 v73, v2
    v_perm_b32 v81, v169, v81, v231
    v_perm_b32 v2, v70, v66, s80
    v_perm_b32 v70, v70, v66, s81
    v_mov_b32 v66, v2
    v_perm_b32 v2, v78, v74, s80
    v_perm_b32 v78, v78, v74, s81
    v_mov_b32 v74, v2
    v_perm_b32 v82, v170, v82, v231
    v_perm_b32 v2, v71, v67, s80
    v_perm_b32 v71, v71, v67, s81
    v_mov_b32 v67, v2
    v_perm_b32 v2, v79, v75, s80
    v_perm_b32 v79, v79, v75, s81
    v_mov_b32 v75, v2
    v_perm_b32 v83, v171, v83, v231
    s_mov_b32 s69, 204800
    s_mov_b32 s76, 206080
    buffer_load_dword v104, v248, s[12:15], s69 offen offset:0
    buffer_load_dword v108, v248, s[12:15], s76 offen offset:0
    buffer_load_dword v112, v248, s[12:15], s69 offen offset:64
    buffer_load_dword v116, v248, s[12:15], s76 offen offset:64
    buffer_load_dword v120, v251, s[12:15], s69 offen
    buffer_load_dword v168, v251, s[12:15], s76 offen
    s_mov_b32 s69, 207360
    s_mov_b32 s76, 208640
    buffer_load_dword v105, v248, s[12:15], s69 offen offset:0
    buffer_load_dword v109, v248, s[12:15], s76 offen offset:0
    buffer_load_dword v113, v248, s[12:15], s69 offen offset:64
    buffer_load_dword v117, v248, s[12:15], s76 offen offset:64
    buffer_load_dword v121, v251, s[12:15], s69 offen
    buffer_load_dword v169, v251, s[12:15], s76 offen
    s_mov_b32 s69, 209920
    s_mov_b32 s76, 211200
    buffer_load_dword v106, v248, s[12:15], s69 offen offset:0
    buffer_load_dword v110, v248, s[12:15], s76 offen offset:0
    buffer_load_dword v114, v248, s[12:15], s69 offen offset:64
    buffer_load_dword v118, v248, s[12:15], s76 offen offset:64
    buffer_load_dword v122, v251, s[12:15], s69 offen
    buffer_load_dword v170, v251, s[12:15], s76 offen
    s_mov_b32 s69, 212480
    s_mov_b32 s76, 213760
    buffer_load_dword v107, v248, s[12:15], s69 offen offset:0
    buffer_load_dword v111, v248, s[12:15], s76 offen offset:0
    buffer_load_dword v115, v248, s[12:15], s69 offen offset:64
    buffer_load_dword v119, v248, s[12:15], s76 offen offset:64
    buffer_load_dword v123, v251, s[12:15], s69 offen
    buffer_load_dword v171, v251, s[12:15], s76 offen
    s_waitcnt vmcnt(24)
    v_perm_b32 v2, v88, v84, s80
    v_perm_b32 v88, v88, v84, s81
    v_mov_b32 v84, v2
    v_perm_b32 v2, v96, v92, s80
    v_perm_b32 v96, v96, v92, s81
    v_mov_b32 v92, v2
    v_perm_b32 v100, v164, v100, v231
    v_perm_b32 v2, v89, v85, s80
    v_perm_b32 v89, v89, v85, s81
    v_mov_b32 v85, v2
    v_perm_b32 v2, v97, v93, s80
    v_perm_b32 v97, v97, v93, s81
    v_mov_b32 v93, v2
    v_perm_b32 v101, v165, v101, v231
    v_perm_b32 v2, v90, v86, s80
    v_perm_b32 v90, v90, v86, s81
    v_mov_b32 v86, v2
    v_perm_b32 v2, v98, v94, s80
    v_perm_b32 v98, v98, v94, s81
    v_mov_b32 v94, v2
    v_perm_b32 v102, v166, v102, v231
    v_perm_b32 v2, v91, v87, s80
    v_perm_b32 v91, v91, v87, s81
    v_mov_b32 v87, v2
    v_perm_b32 v2, v99, v95, s80
    v_perm_b32 v99, v99, v95, s81
    v_mov_b32 v95, v2
    v_perm_b32 v103, v167, v103, v231
    s_mov_b32 s69, 245760
    s_mov_b32 s76, 247040
    buffer_load_dword v124, v248, s[12:15], s69 offen offset:0
    buffer_load_dword v128, v248, s[12:15], s76 offen offset:0
    buffer_load_dword v132, v248, s[12:15], s69 offen offset:64
    buffer_load_dword v136, v248, s[12:15], s76 offen offset:64
    buffer_load_dword v140, v251, s[12:15], s69 offen
    buffer_load_dword v164, v251, s[12:15], s76 offen
    s_mov_b32 s69, 248320
    s_mov_b32 s76, 249600
    buffer_load_dword v125, v248, s[12:15], s69 offen offset:0
    buffer_load_dword v129, v248, s[12:15], s76 offen offset:0
    buffer_load_dword v133, v248, s[12:15], s69 offen offset:64
    buffer_load_dword v137, v248, s[12:15], s76 offen offset:64
    buffer_load_dword v141, v251, s[12:15], s69 offen
    buffer_load_dword v165, v251, s[12:15], s76 offen
    s_mov_b32 s69, 250880
    s_mov_b32 s76, 252160
    buffer_load_dword v126, v248, s[12:15], s69 offen offset:0
    buffer_load_dword v130, v248, s[12:15], s76 offen offset:0
    buffer_load_dword v134, v248, s[12:15], s69 offen offset:64
    buffer_load_dword v138, v248, s[12:15], s76 offen offset:64
    buffer_load_dword v142, v251, s[12:15], s69 offen
    buffer_load_dword v166, v251, s[12:15], s76 offen
    s_mov_b32 s69, 253440
    s_mov_b32 s76, 254720
    buffer_load_dword v127, v248, s[12:15], s69 offen offset:0
    buffer_load_dword v131, v248, s[12:15], s76 offen offset:0
    buffer_load_dword v135, v248, s[12:15], s69 offen offset:64
    buffer_load_dword v139, v248, s[12:15], s76 offen offset:64
    buffer_load_dword v143, v251, s[12:15], s69 offen
    buffer_load_dword v167, v251, s[12:15], s76 offen
    s_waitcnt vmcnt(24)
    v_perm_b32 v2, v108, v104, s80
    v_perm_b32 v108, v108, v104, s81
    v_mov_b32 v104, v2
    v_perm_b32 v2, v116, v112, s80
    v_perm_b32 v116, v116, v112, s81
    v_mov_b32 v112, v2
    v_perm_b32 v120, v168, v120, v231
    v_perm_b32 v2, v109, v105, s80
    v_perm_b32 v109, v109, v105, s81
    v_mov_b32 v105, v2
    v_perm_b32 v2, v117, v113, s80
    v_perm_b32 v117, v117, v113, s81
    v_mov_b32 v113, v2
    v_perm_b32 v121, v169, v121, v231
    v_perm_b32 v2, v110, v106, s80
    v_perm_b32 v110, v110, v106, s81
    v_mov_b32 v106, v2
    v_perm_b32 v2, v118, v114, s80
    v_perm_b32 v118, v118, v114, s81
    v_mov_b32 v114, v2
    v_perm_b32 v122, v170, v122, v231
    v_perm_b32 v2, v111, v107, s80
    v_perm_b32 v111, v111, v107, s81
    v_mov_b32 v107, v2
    v_perm_b32 v2, v119, v115, s80
    v_perm_b32 v119, v119, v115, s81
    v_mov_b32 v115, v2
    v_perm_b32 v123, v171, v123, v231
    s_mov_b32 s69, 286720
    s_mov_b32 s76, 288000
    buffer_load_dword v144, v248, s[12:15], s69 offen offset:0
    buffer_load_dword v148, v248, s[12:15], s76 offen offset:0
    buffer_load_dword v152, v248, s[12:15], s69 offen offset:64
    buffer_load_dword v156, v248, s[12:15], s76 offen offset:64
    buffer_load_dword v160, v251, s[12:15], s69 offen
    buffer_load_dword v168, v251, s[12:15], s76 offen
    s_mov_b32 s69, 289280
    s_mov_b32 s76, 290560
    buffer_load_dword v145, v248, s[12:15], s69 offen offset:0
    buffer_load_dword v149, v248, s[12:15], s76 offen offset:0
    buffer_load_dword v153, v248, s[12:15], s69 offen offset:64
    buffer_load_dword v157, v248, s[12:15], s76 offen offset:64
    buffer_load_dword v161, v251, s[12:15], s69 offen
    buffer_load_dword v169, v251, s[12:15], s76 offen
    s_mov_b32 s69, 291840
    s_mov_b32 s76, 293120
    buffer_load_dword v146, v248, s[12:15], s69 offen offset:0
    buffer_load_dword v150, v248, s[12:15], s76 offen offset:0
    buffer_load_dword v154, v248, s[12:15], s69 offen offset:64
    buffer_load_dword v158, v248, s[12:15], s76 offen offset:64
    buffer_load_dword v162, v251, s[12:15], s69 offen
    buffer_load_dword v170, v251, s[12:15], s76 offen
    s_mov_b32 s69, 294400
    s_mov_b32 s76, 295680
    buffer_load_dword v147, v248, s[12:15], s69 offen offset:0
    buffer_load_dword v151, v248, s[12:15], s76 offen offset:0
    buffer_load_dword v155, v248, s[12:15], s69 offen offset:64
    buffer_load_dword v159, v248, s[12:15], s76 offen offset:64
    buffer_load_dword v163, v251, s[12:15], s69 offen
    buffer_load_dword v171, v251, s[12:15], s76 offen
    s_waitcnt vmcnt(24)
    v_perm_b32 v2, v128, v124, s80
    v_perm_b32 v128, v128, v124, s81
    v_mov_b32 v124, v2
    v_perm_b32 v2, v136, v132, s80
    v_perm_b32 v136, v136, v132, s81
    v_mov_b32 v132, v2
    v_perm_b32 v140, v164, v140, v231
    v_perm_b32 v2, v129, v125, s80
    v_perm_b32 v129, v129, v125, s81
    v_mov_b32 v125, v2
    v_perm_b32 v2, v137, v133, s80
    v_perm_b32 v137, v137, v133, s81
    v_mov_b32 v133, v2
    v_perm_b32 v141, v165, v141, v231
    v_perm_b32 v2, v130, v126, s80
    v_perm_b32 v130, v130, v126, s81
    v_mov_b32 v126, v2
    v_perm_b32 v2, v138, v134, s80
    v_perm_b32 v138, v138, v134, s81
    v_mov_b32 v134, v2
    v_perm_b32 v142, v166, v142, v231
    v_perm_b32 v2, v131, v127, s80
    v_perm_b32 v131, v131, v127, s81
    v_mov_b32 v127, v2
    v_perm_b32 v2, v139, v135, s80
    v_perm_b32 v139, v139, v135, s81
    v_mov_b32 v135, v2
    v_perm_b32 v143, v167, v143, v231
    s_waitcnt vmcnt(0)
    v_perm_b32 v2, v148, v144, s80
    v_perm_b32 v148, v148, v144, s81
    v_mov_b32 v144, v2
    v_perm_b32 v2, v156, v152, s80
    v_perm_b32 v156, v156, v152, s81
    v_mov_b32 v152, v2
    v_perm_b32 v160, v168, v160, v231
    v_perm_b32 v2, v149, v145, s80
    v_perm_b32 v149, v149, v145, s81
    v_mov_b32 v145, v2
    v_perm_b32 v2, v157, v153, s80
    v_perm_b32 v157, v157, v153, s81
    v_mov_b32 v153, v2
    v_perm_b32 v161, v169, v161, v231
    v_perm_b32 v2, v150, v146, s80
    v_perm_b32 v150, v150, v146, s81
    v_mov_b32 v146, v2
    v_perm_b32 v2, v158, v154, s80
    v_perm_b32 v158, v158, v154, s81
    v_mov_b32 v154, v2
    v_perm_b32 v162, v170, v162, v231
    v_perm_b32 v2, v151, v147, s80
    v_perm_b32 v151, v151, v147, s81
    v_mov_b32 v147, v2
    v_perm_b32 v2, v159, v155, s80
    v_perm_b32 v159, v159, v155, s81
    v_mov_b32 v155, v2
    v_perm_b32 v163, v171, v163, v231
    s_mov_b32 s66, 12288
    s_branch Lp3w_173
Lp3h_172:
    s_mov_b32 s12, s36
    s_mov_b32 s13, s37
    s_mov_b32 s14, 1966080
    s_mov_b32 s15, 0x20000
    s_mul_i32 s69, s49, 192
    s_lshl_b32 s65, s69, 5
    s_add_u32 s65, s65, 100663296
    s_mul_i32 s69, s69, 1280
    s_mul_i32 s76, s56, 160
    s_add_u32 s69, s69, s76
    v_lshrrev_b32 v2, 1, v1
    v_lshlrev_b32 v2, 4, v2
    v_and_b32 v3, 1, v1
    v_lshl_add_u32 v2, v3, 2, v2
    v_mul_u32_u24 v248, 1280, v2
    v_add_u32 v248, s69, v248
    v_and_b32 v2, 14, v229
    v_lshl_add_u32 v251, v2, 1, v248
    v_add_u32 v251, 128, v251
    v_lshl_add_u32 v248, v229, 2, v248
    s_mov_b32 s69, 0
    s_mov_b32 s76, 1280
    buffer_load_dword v4, v248, s[12:15], s69 offen offset:0
    buffer_load_dword v8, v248, s[12:15], s76 offen offset:0
    buffer_load_dword v12, v248, s[12:15], s69 offen offset:64
    buffer_load_dword v16, v248, s[12:15], s76 offen offset:64
    buffer_load_dword v20, v251, s[12:15], s69 offen
    buffer_load_dword v164, v251, s[12:15], s76 offen
    s_mov_b32 s69, 2560
    s_mov_b32 s76, 3840
    buffer_load_dword v5, v248, s[12:15], s69 offen offset:0
    buffer_load_dword v9, v248, s[12:15], s76 offen offset:0
    buffer_load_dword v13, v248, s[12:15], s69 offen offset:64
    buffer_load_dword v17, v248, s[12:15], s76 offen offset:64
    buffer_load_dword v21, v251, s[12:15], s69 offen
    buffer_load_dword v165, v251, s[12:15], s76 offen
    s_mov_b32 s69, 10240
    s_mov_b32 s76, 11520
    buffer_load_dword v6, v248, s[12:15], s69 offen offset:0
    buffer_load_dword v10, v248, s[12:15], s76 offen offset:0
    buffer_load_dword v14, v248, s[12:15], s69 offen offset:64
    buffer_load_dword v18, v248, s[12:15], s76 offen offset:64
    buffer_load_dword v22, v251, s[12:15], s69 offen
    buffer_load_dword v166, v251, s[12:15], s76 offen
    s_mov_b32 s69, 12800
    s_mov_b32 s76, 14080
    buffer_load_dword v7, v248, s[12:15], s69 offen offset:0
    buffer_load_dword v11, v248, s[12:15], s76 offen offset:0
    buffer_load_dword v15, v248, s[12:15], s69 offen offset:64
    buffer_load_dword v19, v248, s[12:15], s76 offen offset:64
    buffer_load_dword v23, v251, s[12:15], s69 offen
    buffer_load_dword v167, v251, s[12:15], s76 offen
    s_mov_b32 s69, 40960
    s_mov_b32 s76, 42240
    buffer_load_dword v24, v248, s[12:15], s69 offen offset:0
    buffer_load_dword v28, v248, s[12:15], s76 offen offset:0
    buffer_load_dword v32, v248, s[12:15], s69 offen offset:64
    buffer_load_dword v36, v248, s[12:15], s76 offen offset:64
    buffer_load_dword v40, v251, s[12:15], s69 offen
    buffer_load_dword v168, v251, s[12:15], s76 offen
    s_mov_b32 s69, 43520
    s_mov_b32 s76, 44800
    buffer_load_dword v25, v248, s[12:15], s69 offen offset:0
    buffer_load_dword v29, v248, s[12:15], s76 offen offset:0
    buffer_load_dword v33, v248, s[12:15], s69 offen offset:64
    buffer_load_dword v37, v248, s[12:15], s76 offen offset:64
    buffer_load_dword v41, v251, s[12:15], s69 offen
    buffer_load_dword v169, v251, s[12:15], s76 offen
    s_mov_b32 s69, 51200
    s_mov_b32 s76, 52480
    buffer_load_dword v26, v248, s[12:15], s69 offen offset:0
    buffer_load_dword v30, v248, s[12:15], s76 offen offset:0
    buffer_load_dword v34, v248, s[12:15], s69 offen offset:64
    buffer_load_dword v38, v248, s[12:15], s76 offen offset:64
    buffer_load_dword v42, v251, s[12:15], s69 offen
    buffer_load_dword v170, v251, s[12:15], s76 offen
    s_mov_b32 s69, 53760
    s_mov_b32 s76, 55040
    buffer_load_dword v27, v248, s[12:15], s69 offen offset:0
    buffer_load_dword v31, v248, s[12:15], s76 offen offset:0
    buffer_load_dword v35, v248, s[12:15], s69 offen offset:64
    buffer_load_dword v39, v248, s[12:15], s76 offen offset:64
    buffer_load_dword v43, v251, s[12:15], s69 offen
    buffer_load_dword v171, v251, s[12:15], s76 offen
    s_waitcnt vmcnt(24)
    v_perm_b32 v2, v8, v4, s80
    v_perm_b32 v8, v8, v4, s81
    v_mov_b32 v4, v2
    v_perm_b32 v2, v16, v12, s80
    v_perm_b32 v16, v16, v12, s81
    v_mov_b32 v12, v2
    v_perm_b32 v20, v164, v20, v231
    v_perm_b32 v2, v9, v5, s80
    v_perm_b32 v9, v9, v5, s81
    v_mov_b32 v5, v2
    v_perm_b32 v2, v17, v13, s80
    v_perm_b32 v17, v17, v13, s81
    v_mov_b32 v13, v2
    v_perm_b32 v21, v165, v21, v231
    v_perm_b32 v2, v10, v6, s80
    v_perm_b32 v10, v10, v6, s81
    v_mov_b32 v6, v2
    v_perm_b32 v2, v18, v14, s80
    v_perm_b32 v18, v18, v14, s81
    v_mov_b32 v14, v2
    v_perm_b32 v22, v166, v22, v231
    v_perm_b32 v2, v11, v7, s80
    v_perm_b32 v11, v11, v7, s81
    v_mov_b32 v7, v2
    v_perm_b32 v2, v19, v15, s80
    v_perm_b32 v19, v19, v15, s81
    v_mov_b32 v15, v2
    v_perm_b32 v23, v167, v23, v231
    s_mov_b32 s69, 81920
    s_mov_b32 s76, 83200
    buffer_load_dword v44, v248, s[12:15], s69 offen offset:0
    buffer_load_dword v48, v248, s[12:15], s76 offen offset:0
    buffer_load_dword v52, v248, s[12:15], s69 offen offset:64
    buffer_load_dword v56, v248, s[12:15], s76 offen offset:64
    buffer_load_dword v60, v251, s[12:15], s69 offen
    buffer_load_dword v164, v251, s[12:15], s76 offen
    s_mov_b32 s69, 84480
    s_mov_b32 s76, 85760
    buffer_load_dword v45, v248, s[12:15], s69 offen offset:0
    buffer_load_dword v49, v248, s[12:15], s76 offen offset:0
    buffer_load_dword v53, v248, s[12:15], s69 offen offset:64
    buffer_load_dword v57, v248, s[12:15], s76 offen offset:64
    buffer_load_dword v61, v251, s[12:15], s69 offen
    buffer_load_dword v165, v251, s[12:15], s76 offen
    s_mov_b32 s69, 92160
    s_mov_b32 s76, 93440
    buffer_load_dword v46, v248, s[12:15], s69 offen offset:0
    buffer_load_dword v50, v248, s[12:15], s76 offen offset:0
    buffer_load_dword v54, v248, s[12:15], s69 offen offset:64
    buffer_load_dword v58, v248, s[12:15], s76 offen offset:64
    buffer_load_dword v62, v251, s[12:15], s69 offen
    buffer_load_dword v166, v251, s[12:15], s76 offen
    s_mov_b32 s69, 94720
    s_mov_b32 s76, 96000
    buffer_load_dword v47, v248, s[12:15], s69 offen offset:0
    buffer_load_dword v51, v248, s[12:15], s76 offen offset:0
    buffer_load_dword v55, v248, s[12:15], s69 offen offset:64
    buffer_load_dword v59, v248, s[12:15], s76 offen offset:64
    buffer_load_dword v63, v251, s[12:15], s69 offen
    buffer_load_dword v167, v251, s[12:15], s76 offen
    s_waitcnt vmcnt(24)
    v_perm_b32 v2, v28, v24, s80
    v_perm_b32 v28, v28, v24, s81
    v_mov_b32 v24, v2
    v_perm_b32 v2, v36, v32, s80
    v_perm_b32 v36, v36, v32, s81
    v_mov_b32 v32, v2
    v_perm_b32 v40, v168, v40, v231
    v_perm_b32 v2, v29, v25, s80
    v_perm_b32 v29, v29, v25, s81
    v_mov_b32 v25, v2
    v_perm_b32 v2, v37, v33, s80
    v_perm_b32 v37, v37, v33, s81
    v_mov_b32 v33, v2
    v_perm_b32 v41, v169, v41, v231
    v_perm_b32 v2, v30, v26, s80
    v_perm_b32 v30, v30, v26, s81
    v_mov_b32 v26, v2
    v_perm_b32 v2, v38, v34, s80
    v_perm_b32 v38, v38, v34, s81
    v_mov_b32 v34, v2
    v_perm_b32 v42, v170, v42, v231
    v_perm_b32 v2, v31, v27, s80
    v_perm_b32 v31, v31, v27, s81
    v_mov_b32 v27, v2
    v_perm_b32 v2, v39, v35, s80
    v_perm_b32 v39, v39, v35, s81
    v_mov_b32 v35, v2
    v_perm_b32 v43, v171, v43, v231
    s_mov_b32 s69, 122880
    s_mov_b32 s76, 124160
    buffer_load_dword v64, v248, s[12:15], s69 offen offset:0
    buffer_load_dword v68, v248, s[12:15], s76 offen offset:0
    buffer_load_dword v72, v248, s[12:15], s69 offen offset:64
    buffer_load_dword v76, v248, s[12:15], s76 offen offset:64
    buffer_load_dword v80, v251, s[12:15], s69 offen
    buffer_load_dword v168, v251, s[12:15], s76 offen
    s_mov_b32 s69, 125440
    s_mov_b32 s76, 126720
    buffer_load_dword v65, v248, s[12:15], s69 offen offset:0
    buffer_load_dword v69, v248, s[12:15], s76 offen offset:0
    buffer_load_dword v73, v248, s[12:15], s69 offen offset:64
    buffer_load_dword v77, v248, s[12:15], s76 offen offset:64
    buffer_load_dword v81, v251, s[12:15], s69 offen
    buffer_load_dword v169, v251, s[12:15], s76 offen
    s_mov_b32 s69, 133120
    s_mov_b32 s76, 134400
    buffer_load_dword v66, v248, s[12:15], s69 offen offset:0
    buffer_load_dword v70, v248, s[12:15], s76 offen offset:0
    buffer_load_dword v74, v248, s[12:15], s69 offen offset:64
    buffer_load_dword v78, v248, s[12:15], s76 offen offset:64
    buffer_load_dword v82, v251, s[12:15], s69 offen
    buffer_load_dword v170, v251, s[12:15], s76 offen
    s_mov_b32 s69, 135680
    s_mov_b32 s76, 136960
    buffer_load_dword v67, v248, s[12:15], s69 offen offset:0
    buffer_load_dword v71, v248, s[12:15], s76 offen offset:0
    buffer_load_dword v75, v248, s[12:15], s69 offen offset:64
    buffer_load_dword v79, v248, s[12:15], s76 offen offset:64
    buffer_load_dword v83, v251, s[12:15], s69 offen
    buffer_load_dword v171, v251, s[12:15], s76 offen
    s_waitcnt vmcnt(24)
    v_perm_b32 v2, v48, v44, s80
    v_perm_b32 v48, v48, v44, s81
    v_mov_b32 v44, v2
    v_perm_b32 v2, v56, v52, s80
    v_perm_b32 v56, v56, v52, s81
    v_mov_b32 v52, v2
    v_perm_b32 v60, v164, v60, v231
    v_perm_b32 v2, v49, v45, s80
    v_perm_b32 v49, v49, v45, s81
    v_mov_b32 v45, v2
    v_perm_b32 v2, v57, v53, s80
    v_perm_b32 v57, v57, v53, s81
    v_mov_b32 v53, v2
    v_perm_b32 v61, v165, v61, v231
    v_perm_b32 v2, v50, v46, s80
    v_perm_b32 v50, v50, v46, s81
    v_mov_b32 v46, v2
    v_perm_b32 v2, v58, v54, s80
    v_perm_b32 v58, v58, v54, s81
    v_mov_b32 v54, v2
    v_perm_b32 v62, v166, v62, v231
    v_perm_b32 v2, v51, v47, s80
    v_perm_b32 v51, v51, v47, s81
    v_mov_b32 v47, v2
    v_perm_b32 v2, v59, v55, s80
    v_perm_b32 v59, v59, v55, s81
    v_mov_b32 v55, v2
    v_perm_b32 v63, v167, v63, v231
    s_mov_b32 s69, 163840
    s_mov_b32 s76, 165120
    buffer_load_dword v84, v248, s[12:15], s69 offen offset:0
    buffer_load_dword v88, v248, s[12:15], s76 offen offset:0
    buffer_load_dword v92, v248, s[12:15], s69 offen offset:64
    buffer_load_dword v96, v248, s[12:15], s76 offen offset:64
    buffer_load_dword v100, v251, s[12:15], s69 offen
    buffer_load_dword v164, v251, s[12:15], s76 offen
    s_mov_b32 s69, 166400
    s_mov_b32 s76, 167680
    buffer_load_dword v85, v248, s[12:15], s69 offen offset:0
    buffer_load_dword v89, v248, s[12:15], s76 offen offset:0
    buffer_load_dword v93, v248, s[12:15], s69 offen offset:64
    buffer_load_dword v97, v248, s[12:15], s76 offen offset:64
    buffer_load_dword v101, v251, s[12:15], s69 offen
    buffer_load_dword v165, v251, s[12:15], s76 offen
    s_mov_b32 s69, 174080
    s_mov_b32 s76, 175360
    buffer_load_dword v86, v248, s[12:15], s69 offen offset:0
    buffer_load_dword v90, v248, s[12:15], s76 offen offset:0
    buffer_load_dword v94, v248, s[12:15], s69 offen offset:64
    buffer_load_dword v98, v248, s[12:15], s76 offen offset:64
    buffer_load_dword v102, v251, s[12:15], s69 offen
    buffer_load_dword v166, v251, s[12:15], s76 offen
    s_mov_b32 s69, 176640
    s_mov_b32 s76, 177920
    buffer_load_dword v87, v248, s[12:15], s69 offen offset:0
    buffer_load_dword v91, v248, s[12:15], s76 offen offset:0
    buffer_load_dword v95, v248, s[12:15], s69 offen offset:64
    buffer_load_dword v99, v248, s[12:15], s76 offen offset:64
    buffer_load_dword v103, v251, s[12:15], s69 offen
    buffer_load_dword v167, v251, s[12:15], s76 offen
    s_waitcnt vmcnt(24)
    v_perm_b32 v2, v68, v64, s80
    v_perm_b32 v68, v68, v64, s81
    v_mov_b32 v64, v2
    v_perm_b32 v2, v76, v72, s80
    v_perm_b32 v76, v76, v72, s81
    v_mov_b32 v72, v2
    v_perm_b32 v80, v168, v80, v231
    v_perm_b32 v2, v69, v65, s80
    v_perm_b32 v69, v69, v65, s81
    v_mov_b32 v65, v2
    v_perm_b32 v2, v77, v73, s80
    v_perm_b32 v77, v77, v73, s81
    v_mov_b32 v73, v2
    v_perm_b32 v81, v169, v81, v231
    v_perm_b32 v2, v70, v66, s80
    v_perm_b32 v70, v70, v66, s81
    v_mov_b32 v66, v2
    v_perm_b32 v2, v78, v74, s80
    v_perm_b32 v78, v78, v74, s81
    v_mov_b32 v74, v2
    v_perm_b32 v82, v170, v82, v231
    v_perm_b32 v2, v71, v67, s80
    v_perm_b32 v71, v71, v67, s81
    v_mov_b32 v67, v2
    v_perm_b32 v2, v79, v75, s80
    v_perm_b32 v79, v79, v75, s81
    v_mov_b32 v75, v2
    v_perm_b32 v83, v171, v83, v231
    s_mov_b32 s69, 204800
    s_mov_b32 s76, 206080
    buffer_load_dword v104, v248, s[12:15], s69 offen offset:0
    buffer_load_dword v108, v248, s[12:15], s76 offen offset:0
    buffer_load_dword v112, v248, s[12:15], s69 offen offset:64
    buffer_load_dword v116, v248, s[12:15], s76 offen offset:64
    buffer_load_dword v120, v251, s[12:15], s69 offen
    buffer_load_dword v168, v251, s[12:15], s76 offen
    s_mov_b32 s69, 207360
    s_mov_b32 s76, 208640
    buffer_load_dword v105, v248, s[12:15], s69 offen offset:0
    buffer_load_dword v109, v248, s[12:15], s76 offen offset:0
    buffer_load_dword v113, v248, s[12:15], s69 offen offset:64
    buffer_load_dword v117, v248, s[12:15], s76 offen offset:64
    buffer_load_dword v121, v251, s[12:15], s69 offen
    buffer_load_dword v169, v251, s[12:15], s76 offen
    s_mov_b32 s69, 215040
    s_mov_b32 s76, 216320
    buffer_load_dword v106, v248, s[12:15], s69 offen offset:0
    buffer_load_dword v110, v248, s[12:15], s76 offen offset:0
    buffer_load_dword v114, v248, s[12:15], s69 offen offset:64
    buffer_load_dword v118, v248, s[12:15], s76 offen offset:64
    buffer_load_dword v122, v251, s[12:15], s69 offen
    buffer_load_dword v170, v251, s[12:15], s76 offen
    s_mov_b32 s69, 217600
    s_mov_b32 s76, 218880
    buffer_load_dword v107, v248, s[12:15], s69 offen offset:0
    buffer_load_dword v111, v248, s[12:15], s76 offen offset:0
    buffer_load_dword v115, v248, s[12:15], s69 offen offset:64
    buffer_load_dword v119, v248, s[12:15], s76 offen offset:64
    buffer_load_dword v123, v251, s[12:15], s69 offen
    buffer_load_dword v171, v251, s[12:15], s76 offen
    s_waitcnt vmcnt(24)
    v_perm_b32 v2, v88, v84, s80
    v_perm_b32 v88, v88, v84, s81
    v_mov_b32 v84, v2
    v_perm_b32 v2, v96, v92, s80
    v_perm_b32 v96, v96, v92, s81
    v_mov_b32 v92, v2
    v_perm_b32 v100, v164, v100, v231
    v_perm_b32 v2, v89, v85, s80
    v_perm_b32 v89, v89, v85, s81
    v_mov_b32 v85, v2
    v_perm_b32 v2, v97, v93, s80
    v_perm_b32 v97, v97, v93, s81
    v_mov_b32 v93, v2
    v_perm_b32 v101, v165, v101, v231
    v_perm_b32 v2, v90, v86, s80
    v_perm_b32 v90, v90, v86, s81
    v_mov_b32 v86, v2
    v_perm_b32 v2, v98, v94, s80
    v_perm_b32 v98, v98, v94, s81
    v_mov_b32 v94, v2
    v_perm_b32 v102, v166, v102, v231
    v_perm_b32 v2, v91, v87, s80
    v_perm_b32 v91, v91, v87, s81
    v_mov_b32 v87, v2
    v_perm_b32 v2, v99, v95, s80
    v_perm_b32 v99, v99, v95, s81
    v_mov_b32 v95, v2
    v_perm_b32 v103, v167, v103, v231
    s_waitcnt vmcnt(0)
    v_perm_b32 v2, v108, v104, s80
    v_perm_b32 v108, v108, v104, s81
    v_mov_b32 v104, v2
    v_perm_b32 v2, v116, v112, s80
    v_perm_b32 v116, v116, v112, s81
    v_mov_b32 v112, v2
    v_perm_b32 v120, v168, v120, v231
    v_perm_b32 v2, v109, v105, s80
    v_perm_b32 v109, v109, v105, s81
    v_mov_b32 v105, v2
    v_perm_b32 v2, v117, v113, s80
    v_perm_b32 v117, v117, v113, s81
    v_mov_b32 v113, v2
    v_perm_b32 v121, v169, v121, v231
    v_perm_b32 v2, v110, v106, s80
    v_perm_b32 v110, v110, v106, s81
    v_mov_b32 v106, v2
    v_perm_b32 v2, v118, v114, s80
    v_perm_b32 v118, v118, v114, s81
    v_mov_b32 v114, v2
    v_perm_b32 v122, v170, v122, v231
    v_perm_b32 v2, v111, v107, s80
    v_perm_b32 v111, v111, v107, s81
    v_mov_b32 v107, v2
    v_perm_b32 v2, v119, v115, s80
    v_perm_b32 v119, v119, v115, s81
    v_mov_b32 v115, v2
    v_perm_b32 v123, v171, v123, v231
    s_mov_b32 s66, 3072
Lp3w_173:
    s_lshl_b32 s69, s59, 4
    v_add_u32 v2, s69, v229
    s_mul_i32 s76, s69, s66
    v_lshlrev_b32 v248, 4, v228
    v_add_u32 v248, s76, v248
    v_lshlrev_b32 v251, 2, v2
    v_mul_u32_u24 v253, 160, v2
    s_lshl_b32 s66, s66, 5
    s_sub_u32 s69, s48, 2
    s_cmp_eq_u32 s58, 0
    s_cselect_b32 s69, s48, s69
    s_mul_i32 s69, s69, 5120
    v_lshlrev_b32 v252, 4, v228
    v_add_u32 v252, s69, v252
    s_max_u32 s69, s48, 3
    s_sub_u32 s69, s69, 3
    s_lshl_b32 s69, s69, 6
    v_add_u32 v2, s69, v228
    v_lshlrev_b32 v254, 4, v2
    v_mul_u32_u24 v3, 6554, v2
    v_lshrrev_b32 v3, 16, v3
    v_mul_u32_u24 v230, 1120, v3
    v_add_u32 v255, v254, v230
    s_mov_b32 s64, s57
    s_mov_b32 s73, 0
    s_mov_b32 s46, 0
    s_mov_b32 s80, 0
Lp3g_174:
    buffer_load_dword v2, v0, s[8:11], 0 offen sc0 sc1
    s_waitcnt vmcnt(0)
    v_readlane_b32 s69, v2, 33
    v_readlane_b32 s76, v2, 32
    s_add_u32 s69, s69, s76
    s_cmp_ge_u32 s69, 512
    s_cbranch_scc1 Lp3gok_175
    s_sleep 16
    s_sub_u32 s54, s54, 1
    s_cbranch_scc0 Lp3g_174
    s_mov_b32 s54, 0
Lp3gok_175:
    s_cmp_eq_u32 s58, 0
    s_cbranch_scc1 Lp3H_176
Lp3o_177:
    s_cmp_lg_u32 s73, 0
    s_cbranch_scc1 Lp3hv_179
    s_lshl_b32 s71, s49, 11
    s_add_u32 s71, s71, 152174592
    v_and_b32 v3, 60, v0
    v_lshlrev_b32 v3, 5, v3
Lpg_182:
    buffer_load_dword v2, v3, s[4:7], s71 offen sc1
    s_waitcnt vmcnt(0)
    s_nop 1
    v_min_u32_dpp v2, v2, v2 row_ror:8 row_mask:0xf bank_mask:0xf
    s_nop 1
    v_min_u32_dpp v2, v2, v2 row_ror:4 row_mask:0xf bank_mask:0xf
    s_nop 1
    v_min_u32_dpp v2, v2, v2 row_ror:2 row_mask:0xf bank_mask:0xf
    s_nop 1
    v_min_u32_dpp v2, v2, v2 row_ror:1 row_mask:0xf bank_mask:0xf
    s_nop 1
    v_readfirstlane_b32 s46, v2
    s_cmp_gt_u32 s46, s64
    s_cbranch_scc1 Lpgok_183
    s_sleep 2
    s_sub_u32 s54, s54, 1
    s_cbranch_scc0 Lpg_182
    s_mov_b32 s54, 0
Lpgok_183:
    s_mul_i32 s77, s64, s66
    s_add_u32 s77, s77, s65
    s_lshl_b32 s78, s64, 7
    s_add_u32 s78, s78, 152305664
    buffer_load_dword v249, v251, s[4:7], s78 offen sc1
    buffer_load_dwordx4 v[164:167], v248, s[4:7], s77 offen offset:0 sc1
    buffer_load_dwordx4 v[168:171], v248, s[4:7], s77 offen offset:1024 sc1
    buffer_load_dwordx4 v[172:175], v248, s[4:7], s77 offen offset:2048 sc1
    buffer_load_dwordx4 v[176:179], v248, s[4:7], s77 offen offset:3072 sc1
    s_add_u32 s77, s77, 4096
    buffer_load_dwordx4 v[180:183], v248, s[4:7], s77 offen offset:0 sc1
    buffer_load_dwordx4 v[184:187], v248, s[4:7], s77 offen offset:1024 sc1
    buffer_load_dwordx4 v[188:191], v248, s[4:7], s77 offen offset:2048 sc1
    buffer_load_dwordx4 v[192:195], v248, s[4:7], s77 offen offset:3072 sc1
Lp3hv_179:
    s_add_u32 s67, s64, 2
    s_mov_b32 s73, 0
    s_cmp_ge_u32 s67, 64
    s_cbranch_scc1 Lp3nn_180
    s_cmp_gt_u32 s46, s67
    s_cbranch_scc1 Lp3kn_184
    s_lshl_b32 s71, s49, 11
    s_add_u32 s71, s71, 152174592
    v_and_b32 v3, 60, v0
    v_lshlrev_b32 v3, 5, v3
Lpg_185:
    buffer_load_dword v2, v3, s[4:7], s71 offen sc1
    s_waitcnt vmcnt(0)
    s_nop 1
    v_min_u32_dpp v2, v2, v2 row_ror:8 row_mask:0xf bank_mask:0xf
    s_nop 1
    v_min_u32_dpp v2, v2, v2 row_ror:4 row_mask:0xf bank_mask:0xf
    s_nop 1
    v_min_u32_dpp v2, v2, v2 row_ror:2 row_mask:0xf bank_mask:0xf
    s_nop 1
    v_min_u32_dpp v2, v2, v2 row_ror:1 row_mask:0xf bank_mask:0xf
    s_nop 1
    v_readfirstlane_b32 s46, v2
    s_cmp_le_u32 s46, s67
    s_cbranch_scc1 Lp3nn_180
Lp3kn_184:
    s_mul_i32 s77, s67, s66
    s_add_u32 s77, s77, s65
    s_lshl_b32 s78, s67, 7
    s_add_u32 s78, s78, 152305664
    buffer_load_dword v250, v251, s[4:7], s78 offen sc1
    buffer_load_dwordx4 v[196:199], v248, s[4:7], s77 offen offset:0 sc1
    buffer_load_dwordx4 v[200:203], v248, s[4:7], s77 offen offset:1024 sc1
    buffer_load_dwordx4 v[204:207], v248, s[4:7], s77 offen offset:2048 sc1
    buffer_load_dwordx4 v[208:211], v248, s[4:7], s77 offen offset:3072 sc1
    s_add_u32 s77, s77, 4096
    buffer_load_dwordx4 v[212:215], v248, s[4:7], s77 offen offset:0 sc1
    buffer_load_dwordx4 v[216:219], v248, s[4:7], s77 offen offset:1024 sc1
    buffer_load_dwordx4 v[220:223], v248, s[4:7], s77 offen offset:2048 sc1
    buffer_load_dwordx4 v[224:227], v248, s[4:7], s77 offen offset:3072 sc1
    s_mov_b32 s73, 1
    s_waitcnt vmcnt(9)
    s_branch Lp3go_181
Lp3nn_180:
    s_waitcnt vmcnt(0)
Lp3go_181:
    v_mfma_f32_16x16x32_bf16 v[228:231], v[4:7], v[164:167], 0
    v_mfma_f32_16x16x32_bf16 v[232:235], v[8:11], v[164:167], 0
    v_mfma_f32_16x16x32_bf16 v[236:239], v[12:15], v[164:167], 0
    v_mfma_f32_16x16x32_bf16 v[240:243], v[16:19], v[164:167], 0
    v_mfma_f32_16x16x32_bf16 v[244:247], v[20:23], v[164:167], 0
    v_mfma_f32_16x16x32_bf16 v[228:231], v[24:27], v[168:171], v[228:231]
    v_mfma_f32_16x16x32_bf16 v[232:235], v[28:31], v[168:171], v[232:235]
    v_mfma_f32_16x16x32_bf16 v[236:239], v[32:35], v[168:171], v[236:239]
    v_mfma_f32_16x16x32_bf16 v[240:243], v[36:39], v[168:171], v[240:243]
    v_mfma_f32_16x16x32_bf16 v[244:247], v[40:43], v[168:171], v[244:247]
    v_mfma_f32_16x16x32_bf16 v[228:231], v[44:47], v[172:175], v[228:231]
    v_mfma_f32_16x16x32_bf16 v[232:235], v[48:51], v[172:175], v[232:235]
    v_mfma_f32_16x16x32_bf16 v[236:239], v[52:55], v[172:175], v[236:239]
    v_mfma_f32_16x16x32_bf16 v[240:243], v[56:59], v[172:175], v[240:243]
    v_mfma_f32_16x16x32_bf16 v[244:247], v[60:63], v[172:175], v[244:247]
    v_mfma_f32_16x16x32_bf16 v[228:231], v[64:67], v[176:179], v[228:231]
    v_mfma_f32_16x16x32_bf16 v[232:235], v[68:71], v[176:179], v[232:235]
    v_mfma_f32_16x16x32_bf16 v[236:239], v[72:75], v[176:179], v[236:239]
    v_mfma_f32_16x16x32_bf16 v[240:243], v[76:79], v[176:179], v[240:243]
    v_mfma_f32_16x16x32_bf16 v[244:247], v[80:83], v[176:179], v[244:247]
    v_mfma_f32_16x16x32_bf16 v[228:231], v[84:87], v[180:183], v[228:231]
    v_mfma_f32_16x16x32_bf16 v[232:235], v[88:91], v[180:183], v[232:235]
    v_mfma_f32_16x16x32_bf16 v[236:239], v[92:95], v[180:183], v[236:239]
    v_mfma_f32_16x16x32_bf16 v[240:243], v[96:99], v[180:183], v[240:243]
    v_mfma_f32_16x16x32_bf16 v[244:247], v[100:103], v[180:183], v[244:247]
    v_mfma_f32_16x16x32_bf16 v[228:231], v[104:107], v[184:187], v[228:231]
    v_mfma_f32_16x16x32_bf16 v[232:235], v[108:111], v[184:187], v[232:235]
    v_mfma_f32_16x16x32_bf16 v[236:239], v[112:115], v[184:187], v[236:239]
    v_mfma_f32_16x16x32_bf16 v[240:243], v[116:119], v[184:187], v[240:243]
    v_mfma_f32_16x16x32_bf16 v[244:247], v[120:123], v[184:187], v[244:247]
    v_mfma_f32_16x16x32_bf16 v[228:231], v[124:127], v[188:191], v[228:231]
    v_mfma_f32_16x16x32_bf16 v[232:235], v[128:131], v[188:191], v[232:235]
    v_mfma_f32_16x16x32_bf16 v[236:239], v[132:135], v[188:191], v[236:239]
    v_mfma_f32_16x16x32_bf16 v[240:243], v[136:139], v[188:191], v[240:243]
    v_mfma_f32_16x16x32_bf16 v[244:247], v[140:143], v[188:191], v[244:247]
    v_mfma_f32_16x16x32_bf16 v[228:231], v[144:147], v[192:195], v[228:231]
    v_mfma_f32_16x16x32_bf16 v[232:235], v[148:151], v[192:195], v[232:235]
    v_mfma_f32_16x16x32_bf16 v[236:239], v[152:155], v[192:195], v[236:239]
    v_mfma_f32_16x16x32_bf16 v[240:243], v[156:159], v[192:195], v[240:243]
    v_mfma_f32_16x16x32_bf16 v[244:247], v[160:163], v[192:195], v[244:247]
    s_nop 3
    v_mul_f32 v228, v228, v249
    v_mul_f32 v229, v229, v249
    v_mul_f32 v230, v230, v249
    v_mul_f32 v231, v231, v249
    ds_write_b128 v252, v[228:231] offset:0
    v_mul_f32 v232, v232, v249
    v_mul_f32 v233, v233, v249
    v_mul_f32 v234, v234, v249
    v_mul_f32 v235, v235, v249
    ds_write_b128 v252, v[232:235] offset:1024
    v_mul_f32 v236, v236, v249
    v_mul_f32 v237, v237, v249
    v_mul_f32 v238, v238, v249
    v_mul_f32 v239, v239, v249
    ds_write_b128 v252, v[236:239] offset:2048
    v_mul_f32 v240, v240, v249
    v_mul_f32 v241, v241, v249
    v_mul_f32 v242, v242, v249
    v_mul_f32 v243, v243, v249
    ds_write_b128 v252, v[240:243] offset:3072
    v_mul_f32 v244, v244, v249
    v_mul_f32 v245, v245, v249
    v_mul_f32 v246, v246, v249
    v_mul_f32 v247, v247, v249
    ds_write_b128 v252, v[244:247] offset:4096
    s_waitcnt lgkmcnt(0)
    s_barrier
    s_sub_u32 s81, s64, 2
    s_lshr_b32 s69, s81, 1
    s_and_b32 s69, s69, 7
    s_cmp_lg_u32 s69, s49
    s_cbranch_scc1 Lp3nf_187
    s_cmp_lt_u32 s48, 3
    s_cbranch_scc1 Lp3nf_187
    s_cmp_ge_u32 s81, 64
    s_cbranch_scc1 Lp3nf_187
    s_lshl_b32 s72, s81, 3
    s_add_u32 s72, s72, s56
    s_mul_i32 s70, s72, 5120
    s_add_u32 s70, s70, 130023424
    s_lshl_b32 s72, s72, 7
    s_add_u32 s72, s72, 152047616
    s_mov_b64 exec, 0xffff
Lpf_188:
    buffer_load_dword v2, v0, s[4:7], s72 offen sc1
    s_waitcnt vmcnt(0)
    v_cmp_eq_u32 vcc, 0, v2
    s_cbranch_vccz Lpfok_189
    s_sleep 2
    s_sub_u32 s54, s54, 1
    s_cbranch_scc0 Lpf_188
    s_mov_b32 s54, 0
Lpfok_189:
    s_mov_b64 exec, -1
    buffer_load_dwordx4 v[164:167], v254, s[4:7], s70 offen sc1
    s_add_u32 s70, s70, 2621440
    buffer_load_dwordx4 v[168:171], v254, s[4:7], s70 offen sc1
    s_add_u32 s70, s70, 2621440
    buffer_load_dwordx4 v[172:175], v254, s[4:7], s70 offen sc1
    s_add_u32 s70, s70, 2621440
    buffer_load_dwordx4 v[176:179], v254, s[4:7], s70 offen sc1
    s_add_u32 s70, s70, 2621440
    buffer_load_dwordx4 v[180:183], v254, s[4:7], s70 offen sc1
    s_add_u32 s70, s70, 2621440
    buffer_load_dwordx4 v[184:187], v254, s[4:7], s70 offen sc1
    s_add_u32 s70, s70, 2621440
    buffer_load_dwordx4 v[188:191], v254, s[4:7], s70 offen sc1
    s_add_u32 s70, s70, 2621440
    buffer_load_dwordx4 v[192:195], v254, s[4:7], s70 offen sc1
    s_waitcnt vmcnt(7)
    v_lshlrev_b32 v228, 16, v164
    v_and_b32 v229, 0xffff0000, v164
    v_lshlrev_b32 v230, 16, v165
    v_and_b32 v231, 0xffff0000, v165
    v_lshlrev_b32 v232, 16, v166
    v_and_b32 v233, 0xffff0000, v166
    v_lshlrev_b32 v234, 16, v167
    v_and_b32 v235, 0xffff0000, v167
    s_waitcnt vmcnt(6)
    v_lshlrev_b32 v2, 16, v168
    v_and_b32 v3, 0xffff0000, v168
    v_add_f32 v228, v228, v2
    v_add_f32 v229, v229, v3
    v_lshlrev_b32 v2, 16, v169
    v_and_b32 v3, 0xffff0000, v169
    v_add_f32 v230, v230, v2
    v_add_f32 v231, v231, v3
    v_lshlrev_b32 v2, 16, v170
    v_and_b32 v3, 0xffff0000, v170
    v_add_f32 v232, v232, v2
    v_add_f32 v233, v233, v3
    v_lshlrev_b32 v2, 16, v171
    v_and_b32 v3, 0xffff0000, v171
    v_add_f32 v234, v234, v2
    v_add_f32 v235, v235, v3
    s_waitcnt vmcnt(5)
    v_lshlrev_b32 v2, 16, v172
    v_and_b32 v3, 0xffff0000, v172
    v_add_f32 v228, v228, v2
    v_add_f32 v229, v229, v3
    v_lshlrev_b32 v2, 16, v173
    v_and_b32 v3, 0xffff0000, v173
    v_add_f32 v230, v230, v2
    v_add_f32 v231, v231, v3
    v_lshlrev_b32 v2, 16, v174
    v_and_b32 v3, 0xffff0000, v174
    v_add_f32 v232, v232, v2
    v_add_f32 v233, v233, v3
    v_lshlrev_b32 v2, 16, v175
    v_and_b32 v3, 0xffff0000, v175
    v_add_f32 v234, v234, v2
    v_add_f32 v235, v235, v3
    s_waitcnt vmcnt(4)
    v_lshlrev_b32 v2, 16, v176
    v_and_b32 v3, 0xffff0000, v176
    v_add_f32 v228, v228, v2
    v_add_f32 v229, v229, v3
    v_lshlrev_b32 v2, 16, v177
    v_and_b32 v3, 0xffff0000, v177
    v_add_f32 v230, v230, v2
    v_add_f32 v231, v231, v3
    v_lshlrev_b32 v2, 16, v178
    v_and_b32 v3, 0xffff0000, v178
    v_add_f32 v232, v232, v2
    v_add_f32 v233, v233, v3
    v_lshlrev_b32 v2, 16, v179
    v_and_b32 v3, 0xffff0000, v179
    v_add_f32 v234, v234, v2
    v_add_f32 v235, v235, v3
    s_waitcnt vmcnt(3)
    v_lshlrev_b32 v2, 16, v180
    v_and_b32 v3, 0xffff0000, v180
    v_add_f32 v228, v228, v2
    v_add_f32 v229, v229, v3
    v_lshlrev_b32 v2, 16, v181
    v_and_b32 v3, 0xffff0000, v181
    v_add_f32 v230, v230, v2
    v_add_f32 v231, v231, v3
    v_lshlrev_b32 v2, 16, v182
    v_and_b32 v3, 0xffff0000, v182
    v_add_f32 v232, v232, v2
    v_add_f32 v233, v233, v3
    v_lshlrev_b32 v2, 16, v183
    v_and_b32 v3, 0xffff0000, v183
    v_add_f32 v234, v234, v2
    v_add_f32 v235, v235, v3
    s_waitcnt vmcnt(2)
    v_lshlrev_b32 v2, 16, v184
    v_and_b32 v3, 0xffff0000, v184
    v_add_f32 v228, v228, v2
    v_add_f32 v229, v229, v3
    v_lshlrev_b32 v2, 16, v185
    v_and_b32 v3, 0xffff0000, v185
    v_add_f32 v230, v230, v2
    v_add_f32 v231, v231, v3
    v_lshlrev_b32 v2, 16, v186
    v_and_b32 v3, 0xffff0000, v186
    v_add_f32 v232, v232, v2
    v_add_f32 v233, v233, v3
    v_lshlrev_b32 v2, 16, v187
    v_and_b32 v3, 0xffff0000, v187
    v_add_f32 v234, v234, v2
    v_add_f32 v235, v235, v3
    s_waitcnt vmcnt(1)
    v_lshlrev_b32 v2, 16, v188
    v_and_b32 v3, 0xffff0000, v188
    v_add_f32 v228, v228, v2
    v_add_f32 v229, v229, v3
    v_lshlrev_b32 v2, 16, v189
    v_and_b32 v3, 0xffff0000, v189
    v_add_f32 v230, v230, v2
    v_add_f32 v231, v231, v3
    v_lshlrev_b32 v2, 16, v190
    v_and_b32 v3, 0xffff0000, v190
    v_add_f32 v232, v232, v2
    v_add_f32 v233, v233, v3
    v_lshlrev_b32 v2, 16, v191
    v_and_b32 v3, 0xffff0000, v191
    v_add_f32 v234, v234, v2
    v_add_f32 v235, v235, v3
    s_waitcnt vmcnt(0)
    v_lshlrev_b32 v2, 16, v192
    v_and_b32 v3, 0xffff0000, v192
    v_add_f32 v228, v228, v2
    v_add_f32 v229, v229, v3
    v_lshlrev_b32 v2, 16, v193
    v_and_b32 v3, 0xffff0000, v193
    v_add_f32 v230, v230, v2
    v_add_f32 v231, v231, v3
    v_lshlrev_b32 v2, 16, v194
    v_and_b32 v3, 0xffff0000, v194
    v_add_f32 v232, v232, v2
    v_add_f32 v233, v233, v3
    v_lshlrev_b32 v2, 16, v195
    v_and_b32 v3, 0xffff0000, v195
    v_add_f32 v234, v234, v2
    v_add_f32 v235, v235, v3
    v_cvt_pk_bf16_f32 v236, v228, v229
    v_cvt_pk_bf16_f32 v237, v230, v231
    v_cvt_pk_bf16_f32 v238, v232, v233
    v_cvt_pk_bf16_f32 v239, v234, v235
    s_mul_i32 s69, s81, 40960
    s_mul_i32 s76, s56, 160
    s_add_u32 s69, s69, s76
    buffer_store_dwordx4 v[236:239], v255, s[60:63], s69 offen
    s_waitcnt vmcnt(0)
Lp3nf_187:
    s_add_u32 s64, s64, 2
    s_cmp_ge_u32 s64, 64
    s_cbranch_scc1 Lp3oe_178
    s_cmp_lg_u32 s73, 0
    s_cbranch_scc1 Lp3hv_190
    s_lshl_b32 s71, s49, 11
    s_add_u32 s71, s71, 152174592
    v_and_b32 v3, 60, v0
    v_lshlrev_b32 v3, 5, v3
Lpg_193:
    buffer_load_dword v2, v3, s[4:7], s71 offen sc1
    s_waitcnt vmcnt(0)
    s_nop 1
    v_min_u32_dpp v2, v2, v2 row_ror:8 row_mask:0xf bank_mask:0xf
    s_nop 1
    v_min_u32_dpp v2, v2, v2 row_ror:4 row_mask:0xf bank_mask:0xf
    s_nop 1
    v_min_u32_dpp v2, v2, v2 row_ror:2 row_mask:0xf bank_mask:0xf
    s_nop 1
    v_min_u32_dpp v2, v2, v2 row_ror:1 row_mask:0xf bank_mask:0xf
    s_nop 1
    v_readfirstlane_b32 s46, v2
    s_cmp_gt_u32 s46, s64
    s_cbranch_scc1 Lpgok_194
    s_sleep 2
    s_sub_u32 s54, s54, 1
    s_cbranch_scc0 Lpg_193
    s_mov_b32 s54, 0
Lpgok_194:
    s_mul_i32 s77, s64, s66
    s_add_u32 s77, s77, s65
    s_lshl_b32 s78, s64, 7
    s_add_u32 s78, s78, 152305664
    buffer_load_dword v250, v251, s[4:7], s78 offen sc1
    buffer_load_dwordx4 v[196:199], v248, s[4:7], s77 offen offset:0 sc1
    buffer_load_dwordx4 v[200:203], v248, s[4:7], s77 offen offset:1024 sc1
    buffer_load_dwordx4 v[204:207], v248, s[4:7], s77 offen offset:2048 sc1
    buffer_load_dwordx4 v[208:211], v248, s[4:7], s77 offen offset:3072 sc1
    s_add_u32 s77, s77, 4096
    buffer_load_dwordx4 v[212:215], v248, s[4:7], s77 offen offset:0 sc1
    buffer_load_dwordx4 v[216:219], v248, s[4:7], s77 offen offset:1024 sc1
    buffer_load_dwordx4 v[220:223], v248, s[4:7], s77 offen offset:2048 sc1
    buffer_load_dwordx4 v[224:227], v248, s[4:7], s77 offen offset:3072 sc1
Lp3hv_190:
    s_add_u32 s67, s64, 2
    s_mov_b32 s73, 0
    s_cmp_ge_u32 s67, 64
    s_cbranch_scc1 Lp3nn_191
    s_cmp_gt_u32 s46, s67
    s_cbranch_scc1 Lp3kn_195
    s_lshl_b32 s71, s49, 11
    s_add_u32 s71, s71, 152174592
    v_and_b32 v3, 60, v0
    v_lshlrev_b32 v3, 5, v3
Lpg_196:
    buffer_load_dword v2, v3, s[4:7], s71 offen sc1
    s_waitcnt vmcnt(0)
    s_nop 1
    v_min_u32_dpp v2, v2, v2 row_ror:8 row_mask:0xf bank_mask:0xf
    s_nop 1
    v_min_u32_dpp v2, v2, v2 row_ror:4 row_mask:0xf bank_mask:0xf
    s_nop 1
    v_min_u32_dpp v2, v2, v2 row_ror:2 row_mask:0xf bank_mask:0xf
    s_nop 1
    v_min_u32_dpp v2, v2, v2 row_ror:1 row_mask:0xf bank_mask:0xf
    s_nop 1
    v_readfirstlane_b32 s46, v2
    s_cmp_le_u32 s46, s67
    s_cbranch_scc1 Lp3nn_191
Lp3kn_195:
    s_mul_i32 s77, s67, s66
    s_add_u32 s77, s77, s65
    s_lshl_b32 s78, s67, 7
    s_add_u32 s78, s78, 152305664
    buffer_load_dword v249, v251, s[4:7], s78 offen sc1
    buffer_load_dwordx4 v[164:167], v248, s[4:7], s77 offen offset:0 sc1
    buffer_load_dwordx4 v[168:171], v248, s[4:7], s77 offen offset:1024 sc1
    buffer_load_dwordx4 v[172:175], v248, s[4:7], s77 offen offset:2048 sc1
    buffer_load_dwordx4 v[176:179], v248, s[4:7], s77 offen offset:3072 sc1
    s_add_u32 s77, s77, 4096
    buffer_load_dwordx4 v[180:183], v248, s[4:7], s77 offen offset:0 sc1
    buffer_load_dwordx4 v[184:187], v248, s[4:7], s77 offen offset:1024 sc1
    buffer_load_dwordx4 v[188:191], v248, s[4:7], s77 offen offset:2048 sc1
    buffer_load_dwordx4 v[192:195], v248, s[4:7], s77 offen offset:3072 sc1
    s_mov_b32 s73, 1
    s_waitcnt vmcnt(9)
    s_branch Lp3go_192
Lp3nn_191:
    s_waitcnt vmcnt(0)
Lp3go_192:
    v_mfma_f32_16x16x32_bf16 v[228:231], v[4:7], v[196:199], 0
    v_mfma_f32_16x16x32_bf16 v[232:235], v[8:11], v[196:199], 0
    v_mfma_f32_16x16x32_bf16 v[236:239], v[12:15], v[196:199], 0
    v_mfma_f32_16x16x32_bf16 v[240:243], v[16:19], v[196:199], 0
    v_mfma_f32_16x16x32_bf16 v[244:247], v[20:23], v[196:199], 0
    v_mfma_f32_16x16x32_bf16 v[228:231], v[24:27], v[200:203], v[228:231]
    v_mfma_f32_16x16x32_bf16 v[232:235], v[28:31], v[200:203], v[232:235]
    v_mfma_f32_16x16x32_bf16 v[236:239], v[32:35], v[200:203], v[236:239]
    v_mfma_f32_16x16x32_bf16 v[240:243], v[36:39], v[200:203], v[240:243]
    v_mfma_f32_16x16x32_bf16 v[244:247], v[40:43], v[200:203], v[244:247]
    v_mfma_f32_16x16x32_bf16 v[228:231], v[44:47], v[204:207], v[228:231]
    v_mfma_f32_16x16x32_bf16 v[232:235], v[48:51], v[204:207], v[232:235]
    v_mfma_f32_16x16x32_bf16 v[236:239], v[52:55], v[204:207], v[236:239]
    v_mfma_f32_16x16x32_bf16 v[240:243], v[56:59], v[204:207], v[240:243]
    v_mfma_f32_16x16x32_bf16 v[244:247], v[60:63], v[204:207], v[244:247]
    v_mfma_f32_16x16x32_bf16 v[228:231], v[64:67], v[208:211], v[228:231]
    v_mfma_f32_16x16x32_bf16 v[232:235], v[68:71], v[208:211], v[232:235]
    v_mfma_f32_16x16x32_bf16 v[236:239], v[72:75], v[208:211], v[236:239]
    v_mfma_f32_16x16x32_bf16 v[240:243], v[76:79], v[208:211], v[240:243]
    v_mfma_f32_16x16x32_bf16 v[244:247], v[80:83], v[208:211], v[244:247]
    v_mfma_f32_16x16x32_bf16 v[228:231], v[84:87], v[212:215], v[228:231]
    v_mfma_f32_16x16x32_bf16 v[232:235], v[88:91], v[212:215], v[232:235]
    v_mfma_f32_16x16x32_bf16 v[236:239], v[92:95], v[212:215], v[236:239]
    v_mfma_f32_16x16x32_bf16 v[240:243], v[96:99], v[212:215], v[240:243]
    v_mfma_f32_16x16x32_bf16 v[244:247], v[100:103], v[212:215], v[244:247]
    v_mfma_f32_16x16x32_bf16 v[228:231], v[104:107], v[216:219], v[228:231]
    v_mfma_f32_16x16x32_bf16 v[232:235], v[108:111], v[216:219], v[232:235]
    v_mfma_f32_16x16x32_bf16 v[236:239], v[112:115], v[216:219], v[236:239]
    v_mfma_f32_16x16x32_bf16 v[240:243], v[116:119], v[216:219], v[240:243]
    v_mfma_f32_16x16x32_bf16 v[244:247], v[120:123], v[216:219], v[244:247]
    v_mfma_f32_16x16x32_bf16 v[228:231], v[124:127], v[220:223], v[228:231]
    v_mfma_f32_16x16x32_bf16 v[232:235], v[128:131], v[220:223], v[232:235]
    v_mfma_f32_16x16x32_bf16 v[236:239], v[132:135], v[220:223], v[236:239]
    v_mfma_f32_16x16x32_bf16 v[240:243], v[136:139], v[220:223], v[240:243]
    v_mfma_f32_16x16x32_bf16 v[244:247], v[140:143], v[220:223], v[244:247]
    v_mfma_f32_16x16x32_bf16 v[228:231], v[144:147], v[224:227], v[228:231]
    v_mfma_f32_16x16x32_bf16 v[232:235], v[148:151], v[224:227], v[232:235]
    v_mfma_f32_16x16x32_bf16 v[236:239], v[152:155], v[224:227], v[236:239]
    v_mfma_f32_16x16x32_bf16 v[240:243], v[156:159], v[224:227], v[240:243]
    v_mfma_f32_16x16x32_bf16 v[244:247], v[160:163], v[224:227], v[244:247]
    s_nop 3
    v_mul_f32 v228, v228, v250
    v_mul_f32 v229, v229, v250
    v_mul_f32 v230, v230, v250
    v_mul_f32 v231, v231, v250
    ds_write_b128 v252, v[228:231] offset:30720
    v_mul_f32 v232, v232, v250
    v_mul_f32 v233, v233, v250
    v_mul_f32 v234, v234, v250
    v_mul_f32 v235, v235, v250
    ds_write_b128 v252, v[232:235] offset:31744
    v_mul_f32 v236, v236, v250
    v_mul_f32 v237, v237, v250
    v_mul_f32 v238, v238, v250
    v_mul_f32 v239, v239, v250
    ds_write_b128 v252, v[236:239] offset:32768
    v_mul_f32 v240, v240, v250
    v_mul_f32 v241, v241, v250
    v_mul_f32 v242, v242, v250
    v_mul_f32 v243, v243, v250
    ds_write_b128 v252, v[240:243] offset:33792
    v_mul_f32 v244, v244, v250
    v_mul_f32 v245, v245, v250
    v_mul_f32 v246, v246, v250
    v_mul_f32 v247, v247, v250
    ds_write_b128 v252, v[244:247] offset:34816
    s_waitcnt lgkmcnt(0)
    s_barrier
    s_sub_u32 s81, s64, 2
    s_lshr_b32 s69, s81, 1
    s_and_b32 s69, s69, 7
    s_cmp_lg_u32 s69, s49
    s_cbranch_scc1 Lp3nf_198
    s_cmp_lt_u32 s48, 3
    s_cbranch_scc1 Lp3nf_198
    s_cmp_ge_u32 s81, 64
    s_cbranch_scc1 Lp3nf_198
    s_lshl_b32 s72, s81, 3
    s_add_u32 s72, s72, s56
    s_mul_i32 s70, s72, 5120
    s_add_u32 s70, s70, 130023424
    s_lshl_b32 s72, s72, 7
    s_add_u32 s72, s72, 152047616
    s_mov_b64 exec, 0xffff
Lpf_199:
    buffer_load_dword v2, v0, s[4:7], s72 offen sc1
    s_waitcnt vmcnt(0)
    v_cmp_eq_u32 vcc, 0, v2
    s_cbranch_vccz Lpfok_200
    s_sleep 2
    s_sub_u32 s54, s54, 1
    s_cbranch_scc0 Lpf_199
    s_mov_b32 s54, 0
Lpfok_200:
    s_mov_b64 exec, -1
    buffer_load_dwordx4 v[196:199], v254, s[4:7], s70 offen sc1
    s_add_u32 s70, s70, 2621440
    buffer_load_dwordx4 v[200:203], v254, s[4:7], s70 offen sc1
    s_add_u32 s70, s70, 2621440
    buffer_load_dwordx4 v[204:207], v254, s[4:7], s70 offen sc1
    s_add_u32 s70, s70, 2621440
    buffer_load_dwordx4 v[208:211], v254, s[4:7], s70 offen sc1
    s_add_u32 s70, s70, 2621440
    buffer_load_dwordx4 v[212:215], v254, s[4:7], s70 offen sc1
    s_add_u32 s70, s70, 2621440
    buffer_load_dwordx4 v[216:219], v254, s[4:7], s70 offen sc1
    s_add_u32 s70, s70, 2621440
    buffer_load_dwordx4 v[220:223], v254, s[4:7], s70 offen sc1
    s_add_u32 s70, s70, 2621440
    buffer_load_dwordx4 v[224:227], v254, s[4:7], s70 offen sc1
    s_waitcnt vmcnt(7)
    v_lshlrev_b32 v228, 16, v196
    v_and_b32 v229, 0xffff0000, v196
    v_lshlrev_b32 v230, 16, v197
    v_and_b32 v231, 0xffff0000, v197
    v_lshlrev_b32 v232, 16, v198
    v_and_b32 v233, 0xffff0000, v198
    v_lshlrev_b32 v234, 16, v199
    v_and_b32 v235, 0xffff0000, v199
    s_waitcnt vmcnt(6)
    v_lshlrev_b32 v2, 16, v200
    v_and_b32 v3, 0xffff0000, v200
    v_add_f32 v228, v228, v2
    v_add_f32 v229, v229, v3
    v_lshlrev_b32 v2, 16, v201
    v_and_b32 v3, 0xffff0000, v201
    v_add_f32 v230, v230, v2
    v_add_f32 v231, v231, v3
    v_lshlrev_b32 v2, 16, v202
    v_and_b32 v3, 0xffff0000, v202
    v_add_f32 v232, v232, v2
    v_add_f32 v233, v233, v3
    v_lshlrev_b32 v2, 16, v203
    v_and_b32 v3, 0xffff0000, v203
    v_add_f32 v234, v234, v2
    v_add_f32 v235, v235, v3
    s_waitcnt vmcnt(5)
    v_lshlrev_b32 v2, 16, v204
    v_and_b32 v3, 0xffff0000, v204
    v_add_f32 v228, v228, v2
    v_add_f32 v229, v229, v3
    v_lshlrev_b32 v2, 16, v205
    v_and_b32 v3, 0xffff0000, v205
    v_add_f32 v230, v230, v2
    v_add_f32 v231, v231, v3
    v_lshlrev_b32 v2, 16, v206
    v_and_b32 v3, 0xffff0000, v206
    v_add_f32 v232, v232, v2
    v_add_f32 v233, v233, v3
    v_lshlrev_b32 v2, 16, v207
    v_and_b32 v3, 0xffff0000, v207
    v_add_f32 v234, v234, v2
    v_add_f32 v235, v235, v3
    s_waitcnt vmcnt(4)
    v_lshlrev_b32 v2, 16, v208
    v_and_b32 v3, 0xffff0000, v208
    v_add_f32 v228, v228, v2
    v_add_f32 v229, v229, v3
    v_lshlrev_b32 v2, 16, v209
    v_and_b32 v3, 0xffff0000, v209
    v_add_f32 v230, v230, v2
    v_add_f32 v231, v231, v3
    v_lshlrev_b32 v2, 16, v210
    v_and_b32 v3, 0xffff0000, v210
    v_add_f32 v232, v232, v2
    v_add_f32 v233, v233, v3
    v_lshlrev_b32 v2, 16, v211
    v_and_b32 v3, 0xffff0000, v211
    v_add_f32 v234, v234, v2
    v_add_f32 v235, v235, v3
    s_waitcnt vmcnt(3)
    v_lshlrev_b32 v2, 16, v212
    v_and_b32 v3, 0xffff0000, v212
    v_add_f32 v228, v228, v2
    v_add_f32 v229, v229, v3
    v_lshlrev_b32 v2, 16, v213
    v_and_b32 v3, 0xffff0000, v213
    v_add_f32 v230, v230, v2
    v_add_f32 v231, v231, v3
    v_lshlrev_b32 v2, 16, v214
    v_and_b32 v3, 0xffff0000, v214
    v_add_f32 v232, v232, v2
    v_add_f32 v233, v233, v3
    v_lshlrev_b32 v2, 16, v215
    v_and_b32 v3, 0xffff0000, v215
    v_add_f32 v234, v234, v2
    v_add_f32 v235, v235, v3
    s_waitcnt vmcnt(2)
    v_lshlrev_b32 v2, 16, v216
    v_and_b32 v3, 0xffff0000, v216
    v_add_f32 v228, v228, v2
    v_add_f32 v229, v229, v3
    v_lshlrev_b32 v2, 16, v217
    v_and_b32 v3, 0xffff0000, v217
    v_add_f32 v230, v230, v2
    v_add_f32 v231, v231, v3
    v_lshlrev_b32 v2, 16, v218
    v_and_b32 v3, 0xffff0000, v218
    v_add_f32 v232, v232, v2
    v_add_f32 v233, v233, v3
    v_lshlrev_b32 v2, 16, v219
    v_and_b32 v3, 0xffff0000, v219
    v_add_f32 v234, v234, v2
    v_add_f32 v235, v235, v3
    s_waitcnt vmcnt(1)
    v_lshlrev_b32 v2, 16, v220
    v_and_b32 v3, 0xffff0000, v220
    v_add_f32 v228, v228, v2
    v_add_f32 v229, v229, v3
    v_lshlrev_b32 v2, 16, v221
    v_and_b32 v3, 0xffff0000, v221
    v_add_f32 v230, v230, v2
    v_add_f32 v231, v231, v3
    v_lshlrev_b32 v2, 16, v222
    v_and_b32 v3, 0xffff0000, v222
    v_add_f32 v232, v232, v2
    v_add_f32 v233, v233, v3
    v_lshlrev_b32 v2, 16, v223
    v_and_b32 v3, 0xffff0000, v223
    v_add_f32 v234, v234, v2
    v_add_f32 v235, v235, v3
    s_waitcnt vmcnt(0)
    v_lshlrev_b32 v2, 16, v224
    v_and_b32 v3, 0xffff0000, v224
    v_add_f32 v228, v228, v2
    v_add_f32 v229, v229, v3
    v_lshlrev_b32 v2, 16, v225
    v_and_b32 v3, 0xffff0000, v225
    v_add_f32 v230, v230, v2
    v_add_f32 v231, v231, v3
    v_lshlrev_b32 v2, 16, v226
    v_and_b32 v3, 0xffff0000, v226
    v_add_f32 v232, v232, v2
    v_add_f32 v233, v233, v3
    v_lshlrev_b32 v2, 16, v227
    v_and_b32 v3, 0xffff0000, v227
    v_add_f32 v234, v234, v2
    v_add_f32 v235, v235, v3
    v_cvt_pk_bf16_f32 v236, v228, v229
    v_cvt_pk_bf16_f32 v237, v230, v231
    v_cvt_pk_bf16_f32 v238, v232, v233
    v_cvt_pk_bf16_f32 v239, v234, v235
    s_mul_i32 s69, s81, 40960
    s_mul_i32 s76, s56, 160
    s_add_u32 s69, s69, s76
    buffer_store_dwordx4 v[236:239], v255, s[60:63], s69 offen
    s_waitcnt vmcnt(0)
Lp3nf_198:
    s_add_u32 s64, s64, 2
    s_cmp_ge_u32 s64, 64
    s_cbranch_scc1 Lp3oe_178
    s_branch Lp3o_177
Lp3oe_178:
    s_sub_u32 s81, s64, 2
    s_lshr_b32 s69, s81, 1
    s_and_b32 s69, s69, 7
    s_cmp_lg_u32 s69, s49
    s_cbranch_scc1 Lp3nf_201
    s_cmp_lt_u32 s48, 3
    s_cbranch_scc1 Lp3nf_201
    s_cmp_ge_u32 s81, 64
    s_cbranch_scc1 Lp3nf_201
    s_lshl_b32 s72, s81, 3
    s_add_u32 s72, s72, s56
    s_mul_i32 s70, s72, 5120
    s_add_u32 s70, s70, 130023424
    s_lshl_b32 s72, s72, 7
    s_add_u32 s72, s72, 152047616
    s_mov_b64 exec, 0xffff
Lpf_202:
    buffer_load_dword v2, v0, s[4:7], s72 offen sc1
    s_waitcnt vmcnt(0)
    v_cmp_eq_u32 vcc, 0, v2
    s_cbranch_vccz Lpfok_203
    s_sleep 2
    s_sub_u32 s54, s54, 1
    s_cbranch_scc0 Lpf_202
    s_mov_b32 s54, 0
Lpfok_203:
    s_mov_b64 exec, -1
    buffer_load_dwordx4 v[164:167], v254, s[4:7], s70 offen sc1
    s_add_u32 s70, s70, 2621440
    buffer_load_dwordx4 v[168:171], v254, s[4:7], s70 offen sc1
    s_add_u32 s70, s70, 2621440
    buffer_load_dwordx4 v[172:175], v254, s[4:7], s70 offen sc1
    s_add_u32 s70, s70, 2621440
    buffer_load_dwordx4 v[176:179], v254, s[4:7], s70 offen sc1
    s_add_u32 s70, s70, 2621440
    buffer_load_dwordx4 v[180:183], v254, s[4:7], s70 offen sc1
    s_add_u32 s70, s70, 2621440
    buffer_load_dwordx4 v[184:187], v254, s[4:7], s70 offen sc1
    s_add_u32 s70, s70, 2621440
    buffer_load_dwordx4 v[188:191], v254, s[4:7], s70 offen sc1
    s_add_u32 s70, s70, 2621440
    buffer_load_dwordx4 v[192:195], v254, s[4:7], s70 offen sc1
    s_waitcnt vmcnt(7)
    v_lshlrev_b32 v228, 16, v164
    v_and_b32 v229, 0xffff0000, v164
    v_lshlrev_b32 v230, 16, v165
    v_and_b32 v231, 0xffff0000, v165
    v_lshlrev_b32 v232, 16, v166
    v_and_b32 v233, 0xffff0000, v166
    v_lshlrev_b32 v234, 16, v167
    v_and_b32 v235, 0xffff0000, v167
    s_waitcnt vmcnt(6)
    v_lshlrev_b32 v2, 16, v168
    v_and_b32 v3, 0xffff0000, v168
    v_add_f32 v228, v228, v2
    v_add_f32 v229, v229, v3
    v_lshlrev_b32 v2, 16, v169
    v_and_b32 v3, 0xffff0000, v169
    v_add_f32 v230, v230, v2
    v_add_f32 v231, v231, v3
    v_lshlrev_b32 v2, 16, v170
    v_and_b32 v3, 0xffff0000, v170
    v_add_f32 v232, v232, v2
    v_add_f32 v233, v233, v3
    v_lshlrev_b32 v2, 16, v171
    v_and_b32 v3, 0xffff0000, v171
    v_add_f32 v234, v234, v2
    v_add_f32 v235, v235, v3
    s_waitcnt vmcnt(5)
    v_lshlrev_b32 v2, 16, v172
    v_and_b32 v3, 0xffff0000, v172
    v_add_f32 v228, v228, v2
    v_add_f32 v229, v229, v3
    v_lshlrev_b32 v2, 16, v173
    v_and_b32 v3, 0xffff0000, v173
    v_add_f32 v230, v230, v2
    v_add_f32 v231, v231, v3
    v_lshlrev_b32 v2, 16, v174
    v_and_b32 v3, 0xffff0000, v174
    v_add_f32 v232, v232, v2
    v_add_f32 v233, v233, v3
    v_lshlrev_b32 v2, 16, v175
    v_and_b32 v3, 0xffff0000, v175
    v_add_f32 v234, v234, v2
    v_add_f32 v235, v235, v3
    s_waitcnt vmcnt(4)
    v_lshlrev_b32 v2, 16, v176
    v_and_b32 v3, 0xffff0000, v176
    v_add_f32 v228, v228, v2
    v_add_f32 v229, v229, v3
    v_lshlrev_b32 v2, 16, v177
    v_and_b32 v3, 0xffff0000, v177
    v_add_f32 v230, v230, v2
    v_add_f32 v231, v231, v3
    v_lshlrev_b32 v2, 16, v178
    v_and_b32 v3, 0xffff0000, v178
    v_add_f32 v232, v232, v2
    v_add_f32 v233, v233, v3
    v_lshlrev_b32 v2, 16, v179
    v_and_b32 v3, 0xffff0000, v179
    v_add_f32 v234, v234, v2
    v_add_f32 v235, v235, v3
    s_waitcnt vmcnt(3)
    v_lshlrev_b32 v2, 16, v180
    v_and_b32 v3, 0xffff0000, v180
    v_add_f32 v228, v228, v2
    v_add_f32 v229, v229, v3
    v_lshlrev_b32 v2, 16, v181
    v_and_b32 v3, 0xffff0000, v181
    v_add_f32 v230, v230, v2
    v_add_f32 v231, v231, v3
    v_lshlrev_b32 v2, 16, v182
    v_and_b32 v3, 0xffff0000, v182
    v_add_f32 v232, v232, v2
    v_add_f32 v233, v233, v3
    v_lshlrev_b32 v2, 16, v183
    v_and_b32 v3, 0xffff0000, v183
    v_add_f32 v234, v234, v2
    v_add_f32 v235, v235, v3
    s_waitcnt vmcnt(2)
    v_lshlrev_b32 v2, 16, v184
    v_and_b32 v3, 0xffff0000, v184
    v_add_f32 v228, v228, v2
    v_add_f32 v229, v229, v3
    v_lshlrev_b32 v2, 16, v185
    v_and_b32 v3, 0xffff0000, v185
    v_add_f32 v230, v230, v2
    v_add_f32 v231, v231, v3
    v_lshlrev_b32 v2, 16, v186
    v_and_b32 v3, 0xffff0000, v186
    v_add_f32 v232, v232, v2
    v_add_f32 v233, v233, v3
    v_lshlrev_b32 v2, 16, v187
    v_and_b32 v3, 0xffff0000, v187
    v_add_f32 v234, v234, v2
    v_add_f32 v235, v235, v3
    s_waitcnt vmcnt(1)
    v_lshlrev_b32 v2, 16, v188
    v_and_b32 v3, 0xffff0000, v188
    v_add_f32 v228, v228, v2
    v_add_f32 v229, v229, v3
    v_lshlrev_b32 v2, 16, v189
    v_and_b32 v3, 0xffff0000, v189
    v_add_f32 v230, v230, v2
    v_add_f32 v231, v231, v3
    v_lshlrev_b32 v2, 16, v190
    v_and_b32 v3, 0xffff0000, v190
    v_add_f32 v232, v232, v2
    v_add_f32 v233, v233, v3
    v_lshlrev_b32 v2, 16, v191
    v_and_b32 v3, 0xffff0000, v191
    v_add_f32 v234, v234, v2
    v_add_f32 v235, v235, v3
    s_waitcnt vmcnt(0)
    v_lshlrev_b32 v2, 16, v192
    v_and_b32 v3, 0xffff0000, v192
    v_add_f32 v228, v228, v2
    v_add_f32 v229, v229, v3
    v_lshlrev_b32 v2, 16, v193
    v_and_b32 v3, 0xffff0000, v193
    v_add_f32 v230, v230, v2
    v_add_f32 v231, v231, v3
    v_lshlrev_b32 v2, 16, v194
    v_and_b32 v3, 0xffff0000, v194
    v_add_f32 v232, v232, v2
    v_add_f32 v233, v233, v3
    v_lshlrev_b32 v2, 16, v195
    v_and_b32 v3, 0xffff0000, v195
    v_add_f32 v234, v234, v2
    v_add_f32 v235, v235, v3
    v_cvt_pk_bf16_f32 v236, v228, v229
    v_cvt_pk_bf16_f32 v237, v230, v231
    v_cvt_pk_bf16_f32 v238, v232, v233
    v_cvt_pk_bf16_f32 v239, v234, v235
    s_mul_i32 s69, s81, 40960
    s_mul_i32 s76, s56, 160
    s_add_u32 s69, s69, s76
    buffer_store_dwordx4 v[236:239], v255, s[60:63], s69 offen
    s_waitcnt vmcnt(0)
Lp3nf_201:
    s_branch Lexit
Lp3H_176:
    s_lshl_b32 s71, s49, 9
    s_add_u32 s71, s71, 152043904
    s_mov_b64 exec, 0xffff
Lpf_206:
    buffer_load_dword v2, v0, s[4:7], s71 offen sc1
    s_waitcnt vmcnt(0)
    v_cmp_eq_u32 vcc, 0, v2
    s_cbranch_vccz Lpfok_207
    s_sleep 2
    s_sub_u32 s54, s54, 1
    s_cbranch_scc0 Lpf_206
    s_mov_b32 s54, 0
Lpfok_207:
    s_mov_b64 exec, -1
Lp3hl_204:
    s_cmp_lg_u32 s73, 0
    s_cbranch_scc1 Lp3hv_208
    s_mul_i32 s77, s64, s66
    s_add_u32 s77, s77, s65
    s_lshl_b32 s78, s64, 7
    s_add_u32 s78, s78, 152305664
    buffer_load_dword v249, v251, s[4:7], s78 offen sc1
    buffer_load_dwordx4 v[164:167], v248, s[4:7], s77 offen offset:0 sc1
    buffer_load_dwordx4 v[168:171], v248, s[4:7], s77 offen offset:1024 sc1
    buffer_load_dwordx4 v[172:175], v248, s[4:7], s77 offen offset:2048 sc1
    buffer_load_dwordx4 v[176:179], v248, s[4:7], s77 offen offset:3072 sc1
    s_add_u32 s77, s77, 4096
    buffer_load_dwordx4 v[180:183], v248, s[4:7], s77 offen offset:0 sc1
    buffer_load_dwordx4 v[184:187], v248, s[4:7], s77 offen offset:1024 sc1
Lp3hv_208:
    s_add_u32 s67, s64, 2
    s_mov_b32 s73, 0
    s_cmp_ge_u32 s67, 64
    s_cbranch_scc1 Lp3nn_209
    s_mul_i32 s77, s67, s66
    s_add_u32 s77, s77, s65
    s_lshl_b32 s78, s67, 7
    s_add_u32 s78, s78, 152305664
    buffer_load_dword v250, v251, s[4:7], s78 offen sc1
    buffer_load_dwordx4 v[196:199], v248, s[4:7], s77 offen offset:0 sc1
    buffer_load_dwordx4 v[200:203], v248, s[4:7], s77 offen offset:1024 sc1
    buffer_load_dwordx4 v[204:207], v248, s[4:7], s77 offen offset:2048 sc1
    buffer_load_dwordx4 v[208:211], v248, s[4:7], s77 offen offset:3072 sc1
    s_add_u32 s77, s77, 4096
    buffer_load_dwordx4 v[212:215], v248, s[4:7], s77 offen offset:0 sc1
    buffer_load_dwordx4 v[216:219], v248, s[4:7], s77 offen offset:1024 sc1
    s_mov_b32 s73, 1
    s_waitcnt vmcnt(10)
    s_cmp_lg_u32 s80, 0
    s_cbranch_scc1 Lp3go_210
    s_waitcnt vmcnt(7)
    s_branch Lp3go_210
Lp3nn_209:
    s_waitcnt vmcnt(0)
Lp3go_210:
    v_mfma_f32_16x16x32_bf16 v[228:231], v[4:7], v[164:167], 0
    v_mfma_f32_16x16x32_bf16 v[232:235], v[8:11], v[164:167], 0
    v_mfma_f32_16x16x32_bf16 v[236:239], v[12:15], v[164:167], 0
    v_mfma_f32_16x16x32_bf16 v[240:243], v[16:19], v[164:167], 0
    v_mfma_f32_16x16x32_bf16 v[244:247], v[20:23], v[164:167], 0
    v_mfma_f32_16x16x32_bf16 v[228:231], v[24:27], v[168:171], v[228:231]
    v_mfma_f32_16x16x32_bf16 v[232:235], v[28:31], v[168:171], v[232:235]
    v_mfma_f32_16x16x32_bf16 v[236:239], v[32:35], v[168:171], v[236:239]
    v_mfma_f32_16x16x32_bf16 v[240:243], v[36:39], v[168:171], v[240:243]
    v_mfma_f32_16x16x32_bf16 v[244:247], v[40:43], v[168:171], v[244:247]
    v_mfma_f32_16x16x32_bf16 v[228:231], v[44:47], v[172:175], v[228:231]
    v_mfma_f32_16x16x32_bf16 v[232:235], v[48:51], v[172:175], v[232:235]
    v_mfma_f32_16x16x32_bf16 v[236:239], v[52:55], v[172:175], v[236:239]
    v_mfma_f32_16x16x32_bf16 v[240:243], v[56:59], v[172:175], v[240:243]
    v_mfma_f32_16x16x32_bf16 v[244:247], v[60:63], v[172:175], v[244:247]
    v_mfma_f32_16x16x32_bf16 v[228:231], v[64:67], v[176:179], v[228:231]
    v_mfma_f32_16x16x32_bf16 v[232:235], v[68:71], v[176:179], v[232:235]
    v_mfma_f32_16x16x32_bf16 v[236:239], v[72:75], v[176:179], v[236:239]
    v_mfma_f32_16x16x32_bf16 v[240:243], v[76:79], v[176:179], v[240:243]
    v_mfma_f32_16x16x32_bf16 v[244:247], v[80:83], v[176:179], v[244:247]
    v_mfma_f32_16x16x32_bf16 v[228:231], v[84:87], v[180:183], v[228:231]
    v_mfma_f32_16x16x32_bf16 v[232:235], v[88:91], v[180:183], v[232:235]
    v_mfma_f32_16x16x32_bf16 v[236:239], v[92:95], v[180:183], v[236:239]
    v_mfma_f32_16x16x32_bf16 v[240:243], v[96:99], v[180:183], v[240:243]
    v_mfma_f32_16x16x32_bf16 v[244:247], v[100:103], v[180:183], v[244:247]
    v_mfma_f32_16x16x32_bf16 v[228:231], v[104:107], v[184:187], v[228:231]
    v_mfma_f32_16x16x32_bf16 v[232:235], v[108:111], v[184:187], v[232:235]
    v_mfma_f32_16x16x32_bf16 v[236:239], v[112:115], v[184:187], v[236:239]
    v_mfma_f32_16x16x32_bf16 v[240:243], v[116:119], v[184:187], v[240:243]
    v_mfma_f32_16x16x32_bf16 v[244:247], v[120:123], v[184:187], v[244:247]
    v_sub_f32 v249, 1.0, v249
    s_lshl_b32 s70, s49, 6
    s_add_u32 s70, s70, s64
    s_lshl_b32 s70, s70, 3
    s_add_u32 s70, s70, s56
    s_mul_i32 s70, s70, 5120
    s_add_u32 s70, s70, 130023424
    v_mul_f32 v228, v228, v249
    v_mul_f32 v229, v229, v249
    v_mul_f32 v230, v230, v249
    v_mul_f32 v231, v231, v249
    v_mul_f32 v232, v232, v249
    v_mul_f32 v233, v233, v249
    v_mul_f32 v234, v234, v249
    v_mul_f32 v235, v235, v249
    v_mul_f32 v236, v236, v249
    v_mul_f32 v237, v237, v249
    v_mul_f32 v238, v238, v249
    v_mul_f32 v239, v239, v249
    v_mul_f32 v240, v240, v249
    v_mul_f32 v241, v241, v249
    v_mul_f32 v242, v242, v249
    v_mul_f32 v243, v243, v249
    v_mul_f32 v244, v244, v249
    v_mul_f32 v245, v245, v249
    v_mul_f32 v246, v246, v249
    v_mul_f32 v247, v247, v249
    s_waitcnt vmcnt(7)
    s_cmp_eq_u32 s80, 0
    s_cbranch_scc1 Lp3pf_211
    v_mov_b32 v2, 0
    v_mov_b32 v3, 1
    s_mov_b64 exec, 1
    buffer_store_dword v3, v2, s[4:7], s80 offen sc1
    s_mov_b64 exec, -1
    s_mov_b32 s80, 0
Lp3pf_211:
    s_barrier
    ds_read_b128 v[124:127], v252 offset:0
    ds_read_b128 v[128:131], v252 offset:1024
    ds_read_b128 v[132:135], v252 offset:2048
    ds_read_b128 v[136:139], v252 offset:3072
    ds_read_b128 v[140:143], v252 offset:4096
    ds_read_b128 v[144:147], v252 offset:10240
    ds_read_b128 v[148:151], v252 offset:11264
    ds_read_b128 v[152:155], v252 offset:12288
    ds_read_b128 v[156:159], v252 offset:13312
    ds_read_b128 v[160:163], v252 offset:14336
    s_waitcnt lgkmcnt(5)
    v_add_f32 v228, v228, v124
    v_add_f32 v229, v229, v125
    v_add_f32 v230, v230, v126
    v_add_f32 v231, v231, v127
    v_add_f32 v232, v232, v128
    v_add_f32 v233, v233, v129
    v_add_f32 v234, v234, v130
    v_add_f32 v235, v235, v131
    v_add_f32 v236, v236, v132
    v_add_f32 v237, v237, v133
    v_add_f32 v238, v238, v134
    v_add_f32 v239, v239, v135
    v_add_f32 v240, v240, v136
    v_add_f32 v241, v241, v137
    v_add_f32 v242, v242, v138
    v_add_f32 v243, v243, v139
    v_add_f32 v244, v244, v140
    v_add_f32 v245, v245, v141
    v_add_f32 v246, v246, v142
    v_add_f32 v247, v247, v143
    ds_read_b128 v[124:127], v252 offset:20480
    ds_read_b128 v[128:131], v252 offset:21504
    ds_read_b128 v[132:135], v252 offset:22528
    ds_read_b128 v[136:139], v252 offset:23552
    ds_read_b128 v[140:143], v252 offset:24576
    s_waitcnt lgkmcnt(5)
    v_add_f32 v228, v228, v144
    v_add_f32 v229, v229, v145
    v_add_f32 v230, v230, v146
    v_add_f32 v231, v231, v147
    v_add_f32 v232, v232, v148
    v_add_f32 v233, v233, v149
    v_add_f32 v234, v234, v150
    v_add_f32 v235, v235, v151
    v_add_f32 v236, v236, v152
    v_add_f32 v237, v237, v153
    v_add_f32 v238, v238, v154
    v_add_f32 v239, v239, v155
    v_add_f32 v240, v240, v156
    v_add_f32 v241, v241, v157
    v_add_f32 v242, v242, v158
    v_add_f32 v243, v243, v159
    v_add_f32 v244, v244, v160
    v_add_f32 v245, v245, v161
    v_add_f32 v246, v246, v162
    v_add_f32 v247, v247, v163
    s_waitcnt lgkmcnt(0)
    v_add_f32 v228, v228, v124
    v_add_f32 v229, v229, v125
    v_add_f32 v230, v230, v126
    v_add_f32 v231, v231, v127
    v_add_f32 v232, v232, v128
    v_add_f32 v233, v233, v129
    v_add_f32 v234, v234, v130
    v_add_f32 v235, v235, v131
    v_add_f32 v236, v236, v132
    v_add_f32 v237, v237, v133
    v_add_f32 v238, v238, v134
    v_add_f32 v239, v239, v135
    v_add_f32 v240, v240, v136
    v_add_f32 v241, v241, v137
    v_add_f32 v242, v242, v138
    v_add_f32 v243, v243, v139
    v_add_f32 v244, v244, v140
    v_add_f32 v245, v245, v141
    v_add_f32 v246, v246, v142
    v_add_f32 v247, v247, v143
    v_cvt_pk_bf16_f32 v144, v228, v232
    v_cvt_pk_bf16_f32 v145, v229, v233
    v_cvt_pk_bf16_f32 v146, v230, v234
    v_cvt_pk_bf16_f32 v147, v231, v235
    v_cvt_pk_bf16_f32 v148, v236, v240
    v_cvt_pk_bf16_f32 v149, v237, v241
    v_cvt_pk_bf16_f32 v150, v238, v242
    v_cvt_pk_bf16_f32 v151, v239, v243
    v_cvt_pk_bf16_f32 v152, v244, v245
    v_cvt_pk_bf16_f32 v153, v246, v247
    v_lshl_add_u32 v2, v1, 4, v253
    v_lshl_add_u32 v3, v1, 3, v253
    buffer_store_dwordx4 v[144:147], v2, s[4:7], s70 offen sc1
    buffer_store_dwordx4 v[148:151], v2, s[4:7], s70 offen offset:64 sc1
    buffer_store_dwordx2 v[152:153], v3, s[4:7], s70 offen offset:128 sc1
    s_lshl_b32 s80, s64, 3
    s_add_u32 s80, s80, s56
    s_lshl_b32 s80, s80, 7
    s_lshl_b32 s69, s49, 3
    s_add_u32 s80, s80, s69
    s_lshl_b32 s69, s59, 2
    s_add_u32 s80, s80, s69
    s_add_u32 s80, s80, 152047616
    s_cmp_lg_u32 s73, 0
    s_cbranch_scc1 Lp3nw_212
    s_waitcnt vmcnt(0)
    s_cmp_eq_u32 s80, 0
    s_cbranch_scc1 Lp3pf_213
    v_mov_b32 v2, 0
    v_mov_b32 v3, 1
    s_mov_b64 exec, 1
    buffer_store_dword v3, v2, s[4:7], s80 offen sc1
    s_mov_b64 exec, -1
    s_mov_b32 s80, 0
Lp3pf_213:
Lp3nw_212:
    s_add_u32 s64, s64, 2
    s_cmp_ge_u32 s64, 64
    s_cbranch_scc1 Lp3he_205
    s_cmp_lg_u32 s73, 0
    s_cbranch_scc1 Lp3hv_214
    s_mul_i32 s77, s64, s66
    s_add_u32 s77, s77, s65
    s_lshl_b32 s78, s64, 7
    s_add_u32 s78, s78, 152305664
    buffer_load_dword v250, v251, s[4:7], s78 offen sc1
    buffer_load_dwordx4 v[196:199], v248, s[4:7], s77 offen offset:0 sc1
    buffer_load_dwordx4 v[200:203], v248, s[4:7], s77 offen offset:1024 sc1
    buffer_load_dwordx4 v[204:207], v248, s[4:7], s77 offen offset:2048 sc1
    buffer_load_dwordx4 v[208:211], v248, s[4:7], s77 offen offset:3072 sc1
    s_add_u32 s77, s77, 4096
    buffer_load_dwordx4 v[212:215], v248, s[4:7], s77 offen offset:0 sc1
    buffer_load_dwordx4 v[216:219], v248, s[4:7], s77 offen offset:1024 sc1
Lp3hv_214:
    s_add_u32 s67, s64, 2
    s_mov_b32 s73, 0
    s_cmp_ge_u32 s67, 64
    s_cbranch_scc1 Lp3nn_215
    s_mul_i32 s77, s67, s66
    s_add_u32 s77, s77, s65
    s_lshl_b32 s78, s67, 7
    s_add_u32 s78, s78, 152305664
    buffer_load_dword v249, v251, s[4:7], s78 offen sc1
    buffer_load_dwordx4 v[164:167], v248, s[4:7], s77 offen offset:0 sc1
    buffer_load_dwordx4 v[168:171], v248, s[4:7], s77 offen offset:1024 sc1
    buffer_load_dwordx4 v[172:175], v248, s[4:7], s77 offen offset:2048 sc1
    buffer_load_dwordx4 v[176:179], v248, s[4:7], s77 offen offset:3072 sc1
    s_add_u32 s77, s77, 4096
    buffer_load_dwordx4 v[180:183], v248, s[4:7], s77 offen offset:0 sc1
    buffer_load_dwordx4 v[184:187], v248, s[4:7], s77 offen offset:1024 sc1
    s_mov_b32 s73, 1
    s_waitcnt vmcnt(10)
    s_cmp_lg_u32 s80, 0
    s_cbranch_scc1 Lp3go_216
    s_waitcnt vmcnt(7)
    s_branch Lp3go_216
Lp3nn_215:
    s_waitcnt vmcnt(0)
Lp3go_216:
    v_mfma_f32_16x16x32_bf16 v[228:231], v[4:7], v[196:199], 0
    v_mfma_f32_16x16x32_bf16 v[232:235], v[8:11], v[196:199], 0
    v_mfma_f32_16x16x32_bf16 v[236:239], v[12:15], v[196:199], 0
    v_mfma_f32_16x16x32_bf16 v[240:243], v[16:19], v[196:199], 0
    v_mfma_f32_16x16x32_bf16 v[244:247], v[20:23], v[196:199], 0
    v_mfma_f32_16x16x32_bf16 v[228:231], v[24:27], v[200:203], v[228:231]
    v_mfma_f32_16x16x32_bf16 v[232:235], v[28:31], v[200:203], v[232:235]
    v_mfma_f32_16x16x32_bf16 v[236:239], v[32:35], v[200:203], v[236:239]
    v_mfma_f32_16x16x32_bf16 v[240:243], v[36:39], v[200:203], v[240:243]
    v_mfma_f32_16x16x32_bf16 v[244:247], v[40:43], v[200:203], v[244:247]
    v_mfma_f32_16x16x32_bf16 v[228:231], v[44:47], v[204:207], v[228:231]
    v_mfma_f32_16x16x32_bf16 v[232:235], v[48:51], v[204:207], v[232:235]
    v_mfma_f32_16x16x32_bf16 v[236:239], v[52:55], v[204:207], v[236:239]
    v_mfma_f32_16x16x32_bf16 v[240:243], v[56:59], v[204:207], v[240:243]
    v_mfma_f32_16x16x32_bf16 v[244:247], v[60:63], v[204:207], v[244:247]
    v_mfma_f32_16x16x32_bf16 v[228:231], v[64:67], v[208:211], v[228:231]
    v_mfma_f32_16x16x32_bf16 v[232:235], v[68:71], v[208:211], v[232:235]
    v_mfma_f32_16x16x32_bf16 v[236:239], v[72:75], v[208:211], v[236:239]
    v_mfma_f32_16x16x32_bf16 v[240:243], v[76:79], v[208:211], v[240:243]
    v_mfma_f32_16x16x32_bf16 v[244:247], v[80:83], v[208:211], v[244:247]
    v_mfma_f32_16x16x32_bf16 v[228:231], v[84:87], v[212:215], v[228:231]
    v_mfma_f32_16x16x32_bf16 v[232:235], v[88:91], v[212:215], v[232:235]
    v_mfma_f32_16x16x32_bf16 v[236:239], v[92:95], v[212:215], v[236:239]
    v_mfma_f32_16x16x32_bf16 v[240:243], v[96:99], v[212:215], v[240:243]
    v_mfma_f32_16x16x32_bf16 v[244:247], v[100:103], v[212:215], v[244:247]
    v_mfma_f32_16x16x32_bf16 v[228:231], v[104:107], v[216:219], v[228:231]
    v_mfma_f32_16x16x32_bf16 v[232:235], v[108:111], v[216:219], v[232:235]
    v_mfma_f32_16x16x32_bf16 v[236:239], v[112:115], v[216:219], v[236:239]
    v_mfma_f32_16x16x32_bf16 v[240:243], v[116:119], v[216:219], v[240:243]
    v_mfma_f32_16x16x32_bf16 v[244:247], v[120:123], v[216:219], v[244:247]
    v_sub_f32 v250, 1.0, v250
    s_lshl_b32 s70, s49, 6
    s_add_u32 s70, s70, s64
    s_lshl_b32 s70, s70, 3
    s_add_u32 s70, s70, s56
    s_mul_i32 s70, s70, 5120
    s_add_u32 s70, s70, 130023424
    v_mul_f32 v228, v228, v250
    v_mul_f32 v229, v229, v250
    v_mul_f32 v230, v230, v250
    v_mul_f32 v231, v231, v250
    v_mul_f32 v232, v232, v250
    v_mul_f32 v233, v233, v250
    v_mul_f32 v234, v234, v250
    v_mul_f32 v235, v235, v250
    v_mul_f32 v236, v236, v250
    v_mul_f32 v237, v237, v250
    v_mul_f32 v238, v238, v250
    v_mul_f32 v239, v239, v250
    v_mul_f32 v240, v240, v250
    v_mul_f32 v241, v241, v250
    v_mul_f32 v242, v242, v250
    v_mul_f32 v243, v243, v250
    v_mul_f32 v244, v244, v250
    v_mul_f32 v245, v245, v250
    v_mul_f32 v246, v246, v250
    v_mul_f32 v247, v247, v250
    s_waitcnt vmcnt(7)
    s_cmp_eq_u32 s80, 0
    s_cbranch_scc1 Lp3pf_217
    v_mov_b32 v2, 0
    v_mov_b32 v3, 1
    s_mov_b64 exec, 1
    buffer_store_dword v3, v2, s[4:7], s80 offen sc1
    s_mov_b64 exec, -1
    s_mov_b32 s80, 0
Lp3pf_217:
    s_barrier
    ds_read_b128 v[124:127], v252 offset:30720
    ds_read_b128 v[128:131], v252 offset:31744
    ds_read_b128 v[132:135], v252 offset:32768
    ds_read_b128 v[136:139], v252 offset:33792
    ds_read_b128 v[140:143], v252 offset:34816
    ds_read_b128 v[144:147], v252 offset:40960
    ds_read_b128 v[148:151], v252 offset:41984
    ds_read_b128 v[152:155], v252 offset:43008
    ds_read_b128 v[156:159], v252 offset:44032
    ds_read_b128 v[160:163], v252 offset:45056
    s_waitcnt lgkmcnt(5)
    v_add_f32 v228, v228, v124
    v_add_f32 v229, v229, v125
    v_add_f32 v230, v230, v126
    v_add_f32 v231, v231, v127
    v_add_f32 v232, v232, v128
    v_add_f32 v233, v233, v129
    v_add_f32 v234, v234, v130
    v_add_f32 v235, v235, v131
    v_add_f32 v236, v236, v132
    v_add_f32 v237, v237, v133
    v_add_f32 v238, v238, v134
    v_add_f32 v239, v239, v135
    v_add_f32 v240, v240, v136
    v_add_f32 v241, v241, v137
    v_add_f32 v242, v242, v138
    v_add_f32 v243, v243, v139
    v_add_f32 v244, v244, v140
    v_add_f32 v245, v245, v141
    v_add_f32 v246, v246, v142
    v_add_f32 v247, v247, v143
    ds_read_b128 v[124:127], v252 offset:51200
    ds_read_b128 v[128:131], v252 offset:52224
    ds_read_b128 v[132:135], v252 offset:53248
    ds_read_b128 v[136:139], v252 offset:54272
    ds_read_b128 v[140:143], v252 offset:55296
    s_waitcnt lgkmcnt(5)
    v_add_f32 v228, v228, v144
    v_add_f32 v229, v229, v145
    v_add_f32 v230, v230, v146
    v_add_f32 v231, v231, v147
    v_add_f32 v232, v232, v148
    v_add_f32 v233, v233, v149
    v_add_f32 v234, v234, v150
    v_add_f32 v235, v235, v151
    v_add_f32 v236, v236, v152
    v_add_f32 v237, v237, v153
    v_add_f32 v238, v238, v154
    v_add_f32 v239, v239, v155
    v_add_f32 v240, v240, v156
    v_add_f32 v241, v241, v157
    v_add_f32 v242, v242, v158
    v_add_f32 v243, v243, v159
    v_add_f32 v244, v244, v160
    v_add_f32 v245, v245, v161
    v_add_f32 v246, v246, v162
    v_add_f32 v247, v247, v163
    s_waitcnt lgkmcnt(0)
    v_add_f32 v228, v228, v124
    v_add_f32 v229, v229, v125
    v_add_f32 v230, v230, v126
    v_add_f32 v231, v231, v127
    v_add_f32 v232, v232, v128
    v_add_f32 v233, v233, v129
    v_add_f32 v234, v234, v130
    v_add_f32 v235, v235, v131
    v_add_f32 v236, v236, v132
    v_add_f32 v237, v237, v133
    v_add_f32 v238, v238, v134
    v_add_f32 v239, v239, v135
    v_add_f32 v240, v240, v136
    v_add_f32 v241, v241, v137
    v_add_f32 v242, v242, v138
    v_add_f32 v243, v243, v139
    v_add_f32 v244, v244, v140
    v_add_f32 v245, v245, v141
    v_add_f32 v246, v246, v142
    v_add_f32 v247, v247, v143
    v_cvt_pk_bf16_f32 v144, v228, v232
    v_cvt_pk_bf16_f32 v145, v229, v233
    v_cvt_pk_bf16_f32 v146, v230, v234
    v_cvt_pk_bf16_f32 v147, v231, v235
    v_cvt_pk_bf16_f32 v148, v236, v240
    v_cvt_pk_bf16_f32 v149, v237, v241
    v_cvt_pk_bf16_f32 v150, v238, v242
    v_cvt_pk_bf16_f32 v151, v239, v243
    v_cvt_pk_bf16_f32 v152, v244, v245
    v_cvt_pk_bf16_f32 v153, v246, v247
    v_lshl_add_u32 v2, v1, 4, v253
    v_lshl_add_u32 v3, v1, 3, v253
    buffer_store_dwordx4 v[144:147], v2, s[4:7], s70 offen sc1
    buffer_store_dwordx4 v[148:151], v2, s[4:7], s70 offen offset:64 sc1
    buffer_store_dwordx2 v[152:153], v3, s[4:7], s70 offen offset:128 sc1
    s_lshl_b32 s80, s64, 3
    s_add_u32 s80, s80, s56
    s_lshl_b32 s80, s80, 7
    s_lshl_b32 s69, s49, 3
    s_add_u32 s80, s80, s69
    s_lshl_b32 s69, s59, 2
    s_add_u32 s80, s80, s69
    s_add_u32 s80, s80, 152047616
    s_cmp_lg_u32 s73, 0
    s_cbranch_scc1 Lp3nw_218
    s_waitcnt vmcnt(0)
    s_cmp_eq_u32 s80, 0
    s_cbranch_scc1 Lp3pf_219
    v_mov_b32 v2, 0
    v_mov_b32 v3, 1
    s_mov_b64 exec, 1
    buffer_store_dword v3, v2, s[4:7], s80 offen sc1
    s_mov_b64 exec, -1
    s_mov_b32 s80, 0
Lp3pf_219:
Lp3nw_218:
    s_add_u32 s64, s64, 2
    s_cmp_ge_u32 s64, 64
    s_cbranch_scc1 Lp3he_205
    s_branch Lp3hl_204
Lp3he_205:
    s_branch Lexit
Lexit:
    s_endpgm
.section .rodata,"a"
.p2align 6
.amdhsa_kernel gated_mix__memory_aug_recurrent_mem_tr__glu_gated_geglu__prompt_kernel
  .amdhsa_next_free_vgpr 256
  .amdhsa_next_free_sgpr 102
  .amdhsa_accum_offset 256
  .amdhsa_group_segment_fixed_size 0
  .amdhsa_kernarg_size 120
  .amdhsa_user_sgpr_count 2
  .amdhsa_user_sgpr_kernarg_segment_ptr 1
  .amdhsa_system_sgpr_workgroup_id_x 1
  .amdhsa_float_denorm_mode_32 3
.end_amdhsa_kernel
.text
```
